```python
import torch

def _softmax(x, axis=-1):
    return torch.softmax(x, dim=axis)
def _gelu(x):
    return torch.nn.functional.gelu(x, approximate="tanh")
def _silu(x):
    return torch.nn.functional.silu(x)
def _sigmoid(x):
    return torch.sigmoid(x)
def _layernorm(x, axis=-1, eps=1e-5):
    m = x.mean(dim=axis, keepdim=True)
    v = x.var(dim=axis, keepdim=True, unbiased=False)
    return (x - m) / torch.sqrt(v + eps)
def _scatter_add(tgt, idx, src, axis=0):
    return tgt.clone().index_add_(axis, idx, src)
def _segment_sum(src, seg, n):
    out = torch.zeros((n,) + src.shape[1:], dtype=src.dtype)
    return out.index_add_(0, seg, src)
def _pad(x, pw):
    flat = tuple(v for pair in reversed(pw) for v in pair)
    return torch.nn.functional.pad(x, flat)

kernel_name = 'parallel_sum__ssm_conv_s4d__dense_activation_silu__prompt'

def setup_inputs():

    _w = (lambda a: (lambda t: t.to(torch.bfloat16) if t.is_floating_point() else t)(torch.as_tensor(a)))
    def _A_setup():
        Bsz, L, D, N = 1, 2048, 576, 128
        return {
            "u": _w((lambda *s: torch.randn(*s, dtype=torch.bfloat16) * 0.05)(Bsz, L, D)),
            "log_A_real": _w((lambda *s: torch.randn(*s, dtype=torch.bfloat16) * 3.2)(D, N) * 0.5),
            "A_imag": _w((lambda *s: torch.randn(*s, dtype=torch.bfloat16) * 0.05)(D, N) * 3.14),
            "C_real": _w((lambda *s: torch.randn(*s, dtype=torch.bfloat16) * 0.2)(D, N) / N ** 0.5),
            "C_imag": _w((lambda *s: torch.randn(*s, dtype=torch.bfloat16) * 0.2)(D, N) / N ** 0.5),
            "log_dt": _w((lambda *s: torch.randn(*s, dtype=torch.bfloat16) * 0.05)(D) * 0.5 - 4.0),
            "D_skip": _w((lambda *s: torch.randn(*s, dtype=torch.bfloat16) * 0.05)(D)),
        }
    _A_in = _A_setup()

    def _B_setup():
        B, S, D, F = 1, 2048, 576, 4608
        return {
            "x": _w((lambda *s: torch.randn(*s, dtype=torch.bfloat16) * 0.05)(B, S, D)),
            "w1": _w((lambda *s: torch.randn(*s, dtype=torch.bfloat16) * 0.8)(D, F) * (D ** -0.5)),
            "w2": _w((lambda *s: torch.randn(*s, dtype=torch.bfloat16) * 0.2)(F, D) * (F ** -0.5)),
        }
    _B_in = _B_setup()

    return {
        "A_u": _A_in["u"],
        "A_log_A_real": _A_in["log_A_real"],
        "A_A_imag": _A_in["A_imag"],
        "A_C_real": _A_in["C_real"],
        "A_C_imag": _A_in["C_imag"],
        "A_log_dt": _A_in["log_dt"],
        "A_D_skip": _A_in["D_skip"],
        "B_x": _B_in["x"],
        "B_w1": _B_in["w1"],
        "B_w2": _B_in["w2"],
    }

def reference(A_u, A_log_A_real, A_A_imag, A_C_real, A_C_imag, A_log_dt, A_D_skip, B_x, B_w1, B_w2):
    def _A_ref(u, log_A_real, A_imag, C_real, C_imag, log_dt, D_skip):
        L = u.shape[1]
        dt = torch.exp(log_dt)
        A = -torch.exp(log_A_real) + 1j * A_imag
        C = (C_real + 1j * C_imag) * dt[:, None]
        pos = (lambda x, dt: x.to(dt))(torch.arange(L), log_dt.dtype)
        P = torch.exp((A * dt[:, None])[:, :, None] * pos[None, None, :])
        K = 2.0 * torch.einsum("dn,dnl->dl", C, P).real
        L2 = 2 * L
        u_t = (lambda x, *d: x.permute(*d))(u, 0, 2, 1)
        Kf = (lambda x, *a, **k: torch.fft.rfft(x.float(), *a, **k))(K, L2)
        Uf = (lambda x, *a, **k: torch.fft.rfft(x.float(), *a, **k))(u_t, L2)
        y = (lambda x, *a, **k: torch.fft.irfft(x, *a, **k).to(torch.bfloat16))(Uf * Kf[None, :, :], L2)[:, :, :L]
        y = (lambda x, *d: x.permute(*d))(y, 0, 2, 1)
        return y + u * D_skip[None, None, :]

    def _B_ref(x, w1, w2):
        h = torch.einsum("bsd,df->bsf", x, w1)
        h = _silu(h)
        out = torch.einsum("bsf,fd->bsd", h, w2)
        return out

    x = A_u
    xn = _layernorm(x, axis=-1)
    return x + _A_ref(xn, A_log_A_real, A_A_imag, A_C_real, A_C_imag, A_log_dt, A_D_skip) + _B_ref(xn, B_w1, B_w2)
```

```asm
; @launch grid=(256,1,1) block=(256,1,1) lds=163840
.amdgcn_target "amdgcn-amd-amdhsa--gfx950"
.text
.p2align 8
lane_tables:
.long 0,0,512,73728
.long 4,16,528,73744
.long 8,32,544,73760
.long 12,48,560,73776
.long 1040,64,576,73792
.long 1044,80,592,73808
.long 1048,96,608,73824
.long 1052,112,624,73840
.long 2080,128,640,73856
.long 2084,144,656,73872
.long 2088,160,672,73888
.long 2092,176,688,73904
.long 3120,192,704,73920
.long 3124,208,720,73936
.long 3128,224,736,73952
.long 3132,240,752,73968
.long 4160,1040,1552,73736
.long 4164,1056,1568,73752
.long 4168,1072,1584,73768
.long 4172,1088,1600,73784
.long 5200,1104,1616,73800
.long 5204,1120,1632,73816
.long 5208,1136,1648,73832
.long 5212,1152,1664,73848
.long 6240,1168,1680,73864
.long 6244,1184,1696,73880
.long 6248,1200,1712,73896
.long 6252,1216,1728,73912
.long 7280,1232,1744,73928
.long 7284,1248,1760,73944
.long 7288,1264,1776,73960
.long 7292,1280,1792,73976
.long 8320,2080,2592,74240
.long 8324,2096,2608,74248
.long 8328,2112,2624,74256
.long 8332,2128,2640,74264
.long 9360,2144,2656,74272
.long 9364,2160,2672,74280
.long 9368,2176,2688,74288
.long 9372,2192,2704,74296
.long 10400,2208,2720,74304
.long 10404,2224,2736,74312
.long 10408,2240,2752,74320
.long 10412,2256,2768,74328
.long 11440,2272,2784,74336
.long 11444,2288,2800,74344
.long 11448,2304,2816,74352
.long 11452,2320,2832,74360
.long 12480,3120,3632,74496
.long 12484,3136,3648,74500
.long 12488,3152,3664,74504
.long 12492,3168,3680,74508
.long 13520,3184,3696,74512
.long 13524,3200,3712,74516
.long 13528,3216,3728,74520
.long 13532,3232,3744,74524
.long 14560,3248,3760,74528
.long 14564,3264,3776,74532
.long 14568,3280,3792,74536
.long 14572,3296,3808,74540
.long 15600,3312,3824,74544
.long 15604,3328,3840,74548
.long 15608,3344,3856,74552
.long 15612,3360,3872,74556
.long 16640,0,768,73984
.long 16644,16,784,74000
.long 16648,32,800,74016
.long 16652,48,816,74032
.long 17680,64,832,74048
.long 17684,80,848,74064
.long 17688,96,864,74080
.long 17692,112,880,74096
.long 18720,128,896,74112
.long 18724,144,912,74128
.long 18728,160,928,74144
.long 18732,176,944,74160
.long 19760,192,960,74176
.long 19764,208,976,74192
.long 19768,224,992,74208
.long 19772,240,1008,74224
.long 20800,1040,1808,73992
.long 20804,1056,1824,74008
.long 20808,1072,1840,74024
.long 20812,1088,1856,74040
.long 21840,1104,1872,74056
.long 21844,1120,1888,74072
.long 21848,1136,1904,74088
.long 21852,1152,1920,74104
.long 22880,1168,1936,74120
.long 22884,1184,1952,74136
.long 22888,1200,1968,74152
.long 22892,1216,1984,74168
.long 23920,1232,2000,74184
.long 23924,1248,2016,74200
.long 23928,1264,2032,74216
.long 23932,1280,2048,74232
.long 24960,2080,2848,74368
.long 24964,2096,2864,74376
.long 24968,2112,2880,74384
.long 24972,2128,2896,74392
.long 26000,2144,2912,74400
.long 26004,2160,2928,74408
.long 26008,2176,2944,74416
.long 26012,2192,2960,74424
.long 27040,2208,2976,74432
.long 27044,2224,2992,74440
.long 27048,2240,3008,74448
.long 27052,2256,3024,74456
.long 28080,2272,3040,74464
.long 28084,2288,3056,74472
.long 28088,2304,3072,74480
.long 28092,2320,3088,74488
.long 29120,3120,3888,74560
.long 29124,3136,3904,74564
.long 29128,3152,3920,74568
.long 29132,3168,3936,74572
.long 30160,3184,3952,74576
.long 30164,3200,3968,74580
.long 30168,3216,3984,74584
.long 30172,3232,4000,74588
.long 31200,3248,4016,74592
.long 31204,3264,4032,74596
.long 31208,3280,4048,74600
.long 31212,3296,4064,74604
.long 32240,3312,4080,74608
.long 32244,3328,4096,74612
.long 32248,3344,4112,74616
.long 32252,3360,4128,74620
.long 33280,33280,33792,75776
.long 33284,33296,33808,75792
.long 33288,33312,33824,75808
.long 33292,33328,33840,75824
.long 34320,33344,33856,75840
.long 34324,33360,33872,75856
.long 34328,33376,33888,75872
.long 34332,33392,33904,75888
.long 35360,33408,33920,75904
.long 35364,33424,33936,75920
.long 35368,33440,33952,75936
.long 35372,33456,33968,75952
.long 36400,33472,33984,75968
.long 36404,33488,34000,75984
.long 36408,33504,34016,76000
.long 36412,33520,34032,76016
.long 37440,34320,34832,75784
.long 37444,34336,34848,75800
.long 37448,34352,34864,75816
.long 37452,34368,34880,75832
.long 38480,34384,34896,75848
.long 38484,34400,34912,75864
.long 38488,34416,34928,75880
.long 38492,34432,34944,75896
.long 39520,34448,34960,75912
.long 39524,34464,34976,75928
.long 39528,34480,34992,75944
.long 39532,34496,35008,75960
.long 40560,34512,35024,75976
.long 40564,34528,35040,75992
.long 40568,34544,35056,76008
.long 40572,34560,35072,76024
.long 41600,35360,35872,76288
.long 41604,35376,35888,76296
.long 41608,35392,35904,76304
.long 41612,35408,35920,76312
.long 42640,35424,35936,76320
.long 42644,35440,35952,76328
.long 42648,35456,35968,76336
.long 42652,35472,35984,76344
.long 43680,35488,36000,76352
.long 43684,35504,36016,76360
.long 43688,35520,36032,76368
.long 43692,35536,36048,76376
.long 44720,35552,36064,76384
.long 44724,35568,36080,76392
.long 44728,35584,36096,76400
.long 44732,35600,36112,76408
.long 45760,36400,36912,76544
.long 45764,36416,36928,76548
.long 45768,36432,36944,76552
.long 45772,36448,36960,76556
.long 46800,36464,36976,76560
.long 46804,36480,36992,76564
.long 46808,36496,37008,76568
.long 46812,36512,37024,76572
.long 47840,36528,37040,76576
.long 47844,36544,37056,76580
.long 47848,36560,37072,76584
.long 47852,36576,37088,76588
.long 48880,36592,37104,76592
.long 48884,36608,37120,76596
.long 48888,36624,37136,76600
.long 48892,36640,37152,76604
.long 49920,33280,34048,76032
.long 49924,33296,34064,76048
.long 49928,33312,34080,76064
.long 49932,33328,34096,76080
.long 50960,33344,34112,76096
.long 50964,33360,34128,76112
.long 50968,33376,34144,76128
.long 50972,33392,34160,76144
.long 52000,33408,34176,76160
.long 52004,33424,34192,76176
.long 52008,33440,34208,76192
.long 52012,33456,34224,76208
.long 53040,33472,34240,76224
.long 53044,33488,34256,76240
.long 53048,33504,34272,76256
.long 53052,33520,34288,76272
.long 54080,34320,35088,76040
.long 54084,34336,35104,76056
.long 54088,34352,35120,76072
.long 54092,34368,35136,76088
.long 55120,34384,35152,76104
.long 55124,34400,35168,76120
.long 55128,34416,35184,76136
.long 55132,34432,35200,76152
.long 56160,34448,35216,76168
.long 56164,34464,35232,76184
.long 56168,34480,35248,76200
.long 56172,34496,35264,76216
.long 57200,34512,35280,76232
.long 57204,34528,35296,76248
.long 57208,34544,35312,76264
.long 57212,34560,35328,76280
.long 58240,35360,36128,76416
.long 58244,35376,36144,76424
.long 58248,35392,36160,76432
.long 58252,35408,36176,76440
.long 59280,35424,36192,76448
.long 59284,35440,36208,76456
.long 59288,35456,36224,76464
.long 59292,35472,36240,76472
.long 60320,35488,36256,76480
.long 60324,35504,36272,76488
.long 60328,35520,36288,76496
.long 60332,35536,36304,76504
.long 61360,35552,36320,76512
.long 61364,35568,36336,76520
.long 61368,35584,36352,76528
.long 61372,35600,36368,76536
.long 62400,36400,37168,76608
.long 62404,36416,37184,76612
.long 62408,36432,37200,76616
.long 62412,36448,37216,76620
.long 63440,36464,37232,76624
.long 63444,36480,37248,76628
.long 63448,36496,37264,76632
.long 63452,36512,37280,76636
.long 64480,36528,37296,76640
.long 64484,36544,37312,76644
.long 64488,36560,37328,76648
.long 64492,36576,37344,76652
.long 65520,36592,37360,76656
.long 65524,36608,37376,76660
.long 65528,36624,37392,76664
.long 65532,36640,37408,76668
.long 73732,74752,74752,4294967295
.long 73748,74754,74752,0
.long 73764,74756,74756,0
.long 73780,74758,74756,0
.long 73796,74760,74760,0
.long 73812,74762,74760,0
.long 73828,74764,74764,0
.long 73844,74766,74764,0
.long 73860,74768,74768,0
.long 73876,74770,74768,0
.long 73892,74772,74772,0
.long 73908,74774,74772,0
.long 73924,74776,74776,0
.long 73940,74778,74776,0
.long 73956,74780,74780,0
.long 73972,74782,74780,0
.long 73740,75008,74784,0
.long 73756,75136,74784,0
.long 73772,75136,74788,0
.long 73788,75136,74788,0
.long 73804,75136,74792,0
.long 73820,75136,74792,0
.long 73836,75136,74796,0
.long 73852,75136,74796,0
.long 73868,75136,74800,0
.long 73884,75136,74800,0
.long 73900,75136,74804,0
.long 73916,75136,74804,0
.long 73932,75136,74808,0
.long 73948,75136,74808,0
.long 73964,75136,74812,0
.long 73980,75136,74812,0
.long 74244,75136,74816,0
.long 74252,75136,74816,0
.long 74260,75136,74820,0
.long 74268,75136,74820,0
.long 74276,75136,74824,0
.long 74284,75136,74824,0
.long 74292,75136,74828,0
.long 74300,75136,74828,0
.long 74308,75136,74832,0
.long 74316,75136,74832,0
.long 74324,75136,74836,0
.long 74332,75136,74836,0
.long 74340,75136,74840,0
.long 74348,75136,74840,0
.long 74356,75136,74844,0
.long 74364,75136,74844,0
.long 74624,75136,74848,0
.long 74628,75136,74848,0
.long 74632,75136,74852,0
.long 74636,75136,74852,0
.long 74640,75136,74856,0
.long 74644,75136,74856,0
.long 74648,75136,74860,0
.long 74652,75136,74860,0
.long 74656,75136,74864,0
.long 74660,75136,74864,0
.long 74664,75136,74868,0
.long 74668,75136,74868,0
.long 74672,75136,74872,0
.long 74676,75136,74872,0
.long 74680,75136,74876,0
.long 74684,75136,74876,0
.long 73988,74784,74880,0
.long 74004,74786,74880,0
.long 74020,74788,74884,0
.long 74036,74790,74884,0
.long 74052,74792,74888,0
.long 74068,74794,74888,0
.long 74084,74796,74892,0
.long 74100,74798,74892,0
.long 74116,74800,74896,0
.long 74132,74802,74896,0
.long 74148,74804,74900,0
.long 74164,74806,74900,0
.long 74180,74808,74904,0
.long 74196,74810,74904,0
.long 74212,74812,74908,0
.long 74228,74814,74908,0
.long 73996,75136,74912,0
.long 74012,75136,74912,0
.long 74028,75136,74916,0
.long 74044,75136,74916,0
.long 74060,75136,74920,0
.long 74076,75136,74920,0
.long 74092,75136,74924,0
.long 74108,75136,74924,0
.long 74124,75136,74928,0
.long 74140,75136,74928,0
.long 74156,75136,74932,0
.long 74172,75136,74932,0
.long 74188,75136,74936,0
.long 74204,75136,74936,0
.long 74220,75136,74940,0
.long 74236,75136,74940,0
.long 74372,75136,74944,0
.long 74380,75136,74944,0
.long 74388,75136,74948,0
.long 74396,75136,74948,0
.long 74404,75136,74952,0
.long 74412,75136,74952,0
.long 74420,75136,74956,0
.long 74428,75136,74956,0
.long 74436,75136,74960,0
.long 74444,75136,74960,0
.long 74452,75136,74964,0
.long 74460,75136,74964,0
.long 74468,75136,74968,0
.long 74476,75136,74968,0
.long 74484,75136,74972,0
.long 74492,75136,74972,0
.long 74688,75136,74976,0
.long 74692,75136,74976,0
.long 74696,75136,74980,0
.long 74700,75136,74980,0
.long 74704,75136,74984,0
.long 74708,75136,74984,0
.long 74712,75136,74988,0
.long 74716,75136,74988,0
.long 74720,75136,74992,0
.long 74724,75136,74992,0
.long 74728,75136,74996,0
.long 74732,75136,74996,0
.long 74736,75136,75000,0
.long 74740,75136,75000,0
.long 74744,75136,75004,0
.long 74748,75136,75004,0
.long 75780,76800,76800,4294967295
.long 75796,76802,76800,0
.long 75812,76804,76804,0
.long 75828,76806,76804,0
.long 75844,76808,76808,0
.long 75860,76810,76808,0
.long 75876,76812,76812,0
.long 75892,76814,76812,0
.long 75908,76816,76816,0
.long 75924,76818,76816,0
.long 75940,76820,76820,0
.long 75956,76822,76820,0
.long 75972,76824,76824,0
.long 75988,76826,76824,0
.long 76004,76828,76828,0
.long 76020,76830,76828,0
.long 75788,77056,76832,0
.long 75804,77184,76832,0
.long 75820,77184,76836,0
.long 75836,77184,76836,0
.long 75852,77184,76840,0
.long 75868,77184,76840,0
.long 75884,77184,76844,0
.long 75900,77184,76844,0
.long 75916,77184,76848,0
.long 75932,77184,76848,0
.long 75948,77184,76852,0
.long 75964,77184,76852,0
.long 75980,77184,76856,0
.long 75996,77184,76856,0
.long 76012,77184,76860,0
.long 76028,77184,76860,0
.long 76292,77184,76864,0
.long 76300,77184,76864,0
.long 76308,77184,76868,0
.long 76316,77184,76868,0
.long 76324,77184,76872,0
.long 76332,77184,76872,0
.long 76340,77184,76876,0
.long 76348,77184,76876,0
.long 76356,77184,76880,0
.long 76364,77184,76880,0
.long 76372,77184,76884,0
.long 76380,77184,76884,0
.long 76388,77184,76888,0
.long 76396,77184,76888,0
.long 76404,77184,76892,0
.long 76412,77184,76892,0
.long 76672,77184,76896,0
.long 76676,77184,76896,0
.long 76680,77184,76900,0
.long 76684,77184,76900,0
.long 76688,77184,76904,0
.long 76692,77184,76904,0
.long 76696,77184,76908,0
.long 76700,77184,76908,0
.long 76704,77184,76912,0
.long 76708,77184,76912,0
.long 76712,77184,76916,0
.long 76716,77184,76916,0
.long 76720,77184,76920,0
.long 76724,77184,76920,0
.long 76728,77184,76924,0
.long 76732,77184,76924,0
.long 76036,76832,76928,0
.long 76052,76834,76928,0
.long 76068,76836,76932,0
.long 76084,76838,76932,0
.long 76100,76840,76936,0
.long 76116,76842,76936,0
.long 76132,76844,76940,0
.long 76148,76846,76940,0
.long 76164,76848,76944,0
.long 76180,76850,76944,0
.long 76196,76852,76948,0
.long 76212,76854,76948,0
.long 76228,76856,76952,0
.long 76244,76858,76952,0
.long 76260,76860,76956,0
.long 76276,76862,76956,0
.long 76044,77184,76960,0
.long 76060,77184,76960,0
.long 76076,77184,76964,0
.long 76092,77184,76964,0
.long 76108,77184,76968,0
.long 76124,77184,76968,0
.long 76140,77184,76972,0
.long 76156,77184,76972,0
.long 76172,77184,76976,0
.long 76188,77184,76976,0
.long 76204,77184,76980,0
.long 76220,77184,76980,0
.long 76236,77184,76984,0
.long 76252,77184,76984,0
.long 76268,77184,76988,0
.long 76284,77184,76988,0
.long 76420,77184,76992,0
.long 76428,77184,76992,0
.long 76436,77184,76996,0
.long 76444,77184,76996,0
.long 76452,77184,77000,0
.long 76460,77184,77000,0
.long 76468,77184,77004,0
.long 76476,77184,77004,0
.long 76484,77184,77008,0
.long 76492,77184,77008,0
.long 76500,77184,77012,0
.long 76508,77184,77012,0
.long 76516,77184,77016,0
.long 76524,77184,77016,0
.long 76532,77184,77020,0
.long 76540,77184,77020,0
.long 76736,77184,77024,0
.long 76740,77184,77024,0
.long 76744,77184,77028,0
.long 76748,77184,77028,0
.long 76752,77184,77032,0
.long 76756,77184,77032,0
.long 76760,77184,77036,0
.long 76764,77184,77036,0
.long 76768,77184,77040,0
.long 76772,77184,77040,0
.long 76776,77184,77044,0
.long 76780,77184,77044,0
.long 76784,77184,77048,0
.long 76788,77184,77048,0
.long 76792,77184,77052,0
.long 76796,77184,77052,0
.long 73728,16777472,50462976,50463490
.long 73744,50463490,84149508,84149508
.long 73760,16777472,50462976,50463490
.long 73776,50463490,84149508,84149508
.long 73792,16777472,50462976,50463490
.long 73808,50463490,84149508,84149508
.long 73824,16777472,50462976,50463490
.long 73840,50463490,84149508,84149508
.long 73856,16777472,50462976,50463490
.long 73872,50463490,84149508,84149508
.long 73888,16777472,50462976,50463490
.long 73904,50463490,84149508,84149508
.long 73920,16777472,50462976,50463490
.long 73936,50463490,84149508,84149508
.long 73952,16777472,50462976,50463490
.long 73968,50463490,84149508,84149508
.long 73984,16777472,50462976,50463490
.long 74000,50463490,84149508,84149508
.long 74016,16777472,50462976,50463490
.long 74032,50463490,84149508,84149508
.long 74048,16777472,50462976,50463490
.long 74064,50463490,84149508,84149508
.long 74080,16777472,50462976,50463490
.long 74096,50463490,84149508,84149508
.long 74112,16777472,50462976,50463490
.long 74128,50463490,84149508,84149508
.long 74144,16777472,50462976,50463490
.long 74160,50463490,84149508,84149508
.long 74176,16777472,50462976,50463490
.long 74192,50463490,84149508,84149508
.long 74208,16777472,50462976,50463490
.long 74224,50463490,84149508,84149508
.long 74240,16777472,50462976,50463490
.long 74248,50463490,84149508,84149508
.long 74256,16777472,50462976,50463490
.long 74264,50463490,84149508,84149508
.long 74272,16777472,50462976,50463490
.long 74280,50463490,84149508,84149508
.long 74288,16777472,50462976,50463490
.long 74296,50463490,84149508,84149508
.long 74304,16777472,50462976,50463490
.long 74312,50463490,84149508,84149508
.long 74320,16777472,50462976,50463490
.long 74328,50463490,84149508,84149508
.long 74336,16777472,50462976,50463490
.long 74344,50463490,84149508,84149508
.long 74352,16777472,50462976,50463490
.long 74360,50463490,84149508,84149508
.long 74368,16777472,50462976,50463490
.long 74376,50463490,84149508,84149508
.long 74384,16777472,50462976,50463490
.long 74392,50463490,84149508,84149508
.long 74400,16777472,50462976,50463490
.long 74408,50463490,84149508,84149508
.long 74416,16777472,50462976,50463490
.long 74424,50463490,84149508,84149508
.long 74432,16777472,50462976,50463490
.long 74440,50463490,84149508,84149508
.long 74448,16777472,50462976,50463490
.long 74456,50463490,84149508,84149508
.long 74464,16777472,50462976,50463490
.long 74472,50463490,84149508,84149508
.long 74480,16777472,50462976,50463490
.long 74488,50463490,84149508,84149508
.long 74496,16777472,50462976,50463490
.long 74500,50463490,84149508,84149508
.long 74504,16777472,50462976,50463490
.long 74508,50463490,84149508,84149508
.long 74512,16777472,50462976,50463490
.long 74516,50463490,84149508,84149508
.long 74520,16777472,50462976,50463490
.long 74524,50463490,84149508,84149508
.long 74528,16777472,50462976,50463490
.long 74532,50463490,84149508,84149508
.long 74536,16777472,50462976,50463490
.long 74540,50463490,84149508,84149508
.long 74544,16777472,50462976,50463490
.long 74548,50463490,84149508,84149508
.long 74552,16777472,50462976,50463490
.long 74556,50463490,84149508,84149508
.long 74560,16777472,50462976,50463490
.long 74564,50463490,84149508,84149508
.long 74568,16777472,50462976,50463490
.long 74572,50463490,84149508,84149508
.long 74576,16777472,50462976,50463490
.long 74580,50463490,84149508,84149508
.long 74584,16777472,50462976,50463490
.long 74588,50463490,84149508,84149508
.long 74592,16777472,50462976,50463490
.long 74596,50463490,84149508,84149508
.long 74600,16777472,50462976,50463490
.long 74604,50463490,84149508,84149508
.long 74608,16777472,50462976,50463490
.long 74612,50463490,84149508,84149508
.long 74616,16777472,50462976,50463490
.long 74620,50463490,84149508,84149508
.long 74624,16777472,50462976,50463490
.long 74628,50463490,84149508,84149508
.long 74632,16777472,50462976,50463490
.long 74636,50463490,84149508,84149508
.long 74640,16777472,50462976,50463490
.long 74644,50463490,84149508,84149508
.long 74648,16777472,50462976,50463490
.long 74652,50463490,84149508,84149508
.long 74656,16777472,50462976,50463490
.long 74660,50463490,84149508,84149508
.long 74664,16777472,50462976,50463490
.long 74668,50463490,84149508,84149508
.long 74672,16777472,50462976,50463490
.long 74676,50463490,84149508,84149508
.long 74680,16777472,50462976,50463490
.long 74684,50463490,84149508,84149508
.long 74688,16777472,50462976,50463490
.long 74692,50463490,84149508,84149508
.long 74696,16777472,50462976,50463490
.long 74700,50463490,84149508,84149508
.long 74704,16777472,50462976,50463490
.long 74708,50463490,84149508,84149508
.long 74712,16777472,50462976,50463490
.long 74716,50463490,84149508,84149508
.long 74720,16777472,50462976,50463490
.long 74724,50463490,84149508,84149508
.long 74728,16777472,50462976,50463490
.long 74732,50463490,84149508,84149508
.long 74736,16777472,50462976,50463490
.long 74740,50463490,84149508,84149508
.long 74744,16777472,50462976,50463490
.long 74748,50463490,84149508,84149508
.long 75776,16777472,50462976,50463490
.long 75792,50463490,84149508,84149508
.long 75808,16777472,50462976,50463490
.long 75824,50463490,84149508,84149508
.long 75840,16777472,50462976,50463490
.long 75856,50463490,84149508,84149508
.long 75872,16777472,50462976,50463490
.long 75888,50463490,84149508,84149508
.long 75904,16777472,50462976,50463490
.long 75920,50463490,84149508,84149508
.long 75936,16777472,50462976,50463490
.long 75952,50463490,84149508,84149508
.long 75968,16777472,50462976,50463490
.long 75984,50463490,84149508,84149508
.long 76000,16777472,50462976,50463490
.long 76016,50463490,84149508,84149508
.long 76032,16777472,50462976,50463490
.long 76048,50463490,84149508,84149508
.long 76064,16777472,50462976,50463490
.long 76080,50463490,84149508,84149508
.long 76096,16777472,50462976,50463490
.long 76112,50463490,84149508,84149508
.long 76128,16777472,50462976,50463490
.long 76144,50463490,84149508,84149508
.long 76160,16777472,50462976,50463490
.long 76176,50463490,84149508,84149508
.long 76192,16777472,50462976,50463490
.long 76208,50463490,84149508,84149508
.long 76224,16777472,50462976,50463490
.long 76240,50463490,84149508,84149508
.long 76256,16777472,50462976,50463490
.long 76272,50463490,84149508,84149508
.long 76288,16777472,50462976,50463490
.long 76296,50463490,84149508,84149508
.long 76304,16777472,50462976,50463490
.long 76312,50463490,84149508,84149508
.long 76320,16777472,50462976,50463490
.long 76328,50463490,84149508,84149508
.long 76336,16777472,50462976,50463490
.long 76344,50463490,84149508,84149508
.long 76352,16777472,50462976,50463490
.long 76360,50463490,84149508,84149508
.long 76368,16777472,50462976,50463490
.long 76376,50463490,84149508,84149508
.long 76384,16777472,50462976,50463490
.long 76392,50463490,84149508,84149508
.long 76400,16777472,50462976,50463490
.long 76408,50463490,84149508,84149508
.long 76416,16777472,50462976,50463490
.long 76424,50463490,84149508,84149508
.long 76432,16777472,50462976,50463490
.long 76440,50463490,84149508,84149508
.long 76448,16777472,50462976,50463490
.long 76456,50463490,84149508,84149508
.long 76464,16777472,50462976,50463490
.long 76472,50463490,84149508,84149508
.long 76480,16777472,50462976,50463490
.long 76488,50463490,84149508,84149508
.long 76496,16777472,50462976,50463490
.long 76504,50463490,84149508,84149508
.long 76512,16777472,50462976,50463490
.long 76520,50463490,84149508,84149508
.long 76528,16777472,50462976,50463490
.long 76536,50463490,84149508,84149508
.long 76544,16777472,50462976,50463490
.long 76548,50463490,84149508,84149508
.long 76552,16777472,50462976,50463490
.long 76556,50463490,84149508,84149508
.long 76560,16777472,50462976,50463490
.long 76564,50463490,84149508,84149508
.long 76568,16777472,50462976,50463490
.long 76572,50463490,84149508,84149508
.long 76576,16777472,50462976,50463490
.long 76580,50463490,84149508,84149508
.long 76584,16777472,50462976,50463490
.long 76588,50463490,84149508,84149508
.long 76592,16777472,50462976,50463490
.long 76596,50463490,84149508,84149508
.long 76600,16777472,50462976,50463490
.long 76604,50463490,84149508,84149508
.long 76608,16777472,50462976,50463490
.long 76612,50463490,84149508,84149508
.long 76616,16777472,50462976,50463490
.long 76620,50463490,84149508,84149508
.long 76624,16777472,50462976,50463490
.long 76628,50463490,84149508,84149508
.long 76632,16777472,50462976,50463490
.long 76636,50463490,84149508,84149508
.long 76640,16777472,50462976,50463490
.long 76644,50463490,84149508,84149508
.long 76648,16777472,50462976,50463490
.long 76652,50463490,84149508,84149508
.long 76656,16777472,50462976,50463490
.long 76660,50463490,84149508,84149508
.long 76664,16777472,50462976,50463490
.long 76668,50463490,84149508,84149508
.long 76672,16777472,50462976,50463490
.long 76676,50463490,84149508,84149508
.long 76680,16777472,50462976,50463490
.long 76684,50463490,84149508,84149508
.long 76688,16777472,50462976,50463490
.long 76692,50463490,84149508,84149508
.long 76696,16777472,50462976,50463490
.long 76700,50463490,84149508,84149508
.long 76704,16777472,50462976,50463490
.long 76708,50463490,84149508,84149508
.long 76712,16777472,50462976,50463490
.long 76716,50463490,84149508,84149508
.long 76720,16777472,50462976,50463490
.long 76724,50463490,84149508,84149508
.long 76728,16777472,50462976,50463490
.long 76732,50463490,84149508,84149508
.long 76736,16777472,50462976,50463490
.long 76740,50463490,84149508,84149508
.long 76744,16777472,50462976,50463490
.long 76748,50463490,84149508,84149508
.long 76752,16777472,50462976,50463490
.long 76756,50463490,84149508,84149508
.long 76760,16777472,50462976,50463490
.long 76764,50463490,84149508,84149508
.long 76768,16777472,50462976,50463490
.long 76772,50463490,84149508,84149508
.long 76776,16777472,50462976,50463490
.long 76780,50463490,84149508,84149508
.long 76784,16777472,50462976,50463490
.long 76788,50463490,84149508,84149508
.long 76792,16777472,50462976,50463490
.long 76796,50463490,84149508,84149508
.long 0,0,90112,0
.long 16,16,90120,16
.long 32,32,90128,32
.long 48,48,90136,48
.long 64,64,90240,64
.long 80,80,90248,80
.long 96,96,90256,96
.long 112,112,90264,112
.long 9216,1152,90400,128
.long 9232,1168,90408,144
.long 9248,1184,90416,160
.long 9264,1200,90424,176
.long 9280,1216,90528,192
.long 9296,1232,90536,208
.long 9312,1248,90544,224
.long 9328,1264,90552,240
.long 18464,2336,90688,256
.long 18480,2352,90696,272
.long 18432,2304,90704,288
.long 18448,2320,90712,304
.long 18528,2400,90816,320
.long 18544,2416,90824,336
.long 18496,2368,90832,352
.long 18512,2384,90840,368
.long 27680,3488,90976,384
.long 27696,3504,90984,400
.long 27648,3456,90992,416
.long 27664,3472,91000,432
.long 27744,3552,91104,448
.long 27760,3568,91112,464
.long 27712,3520,91120,480
.long 27728,3536,91128,496
.long 36928,4672,91136,544
.long 36944,4688,91144,560
.long 36960,4704,91152,512
.long 36976,4720,91160,528
.long 36864,4608,91264,608
.long 36880,4624,91272,624
.long 36896,4640,91280,576
.long 36912,4656,91288,592
.long 46144,5824,91424,672
.long 46160,5840,91432,688
.long 46176,5856,91440,640
.long 46192,5872,91448,656
.long 46080,5760,91552,736
.long 46096,5776,91560,752
.long 46112,5792,91568,704
.long 46128,5808,91576,720
.long 55392,7008,91712,800
.long 55408,7024,91720,816
.long 55360,6976,91728,768
.long 55376,6992,91736,784
.long 55328,6944,91840,864
.long 55344,6960,91848,880
.long 55296,6912,91856,832
.long 55312,6928,91864,848
.long 64608,8160,92000,928
.long 64624,8176,92008,944
.long 64576,8128,92016,896
.long 64592,8144,92024,912
.long 64544,8096,92128,992
.long 64560,8112,92136,1008
.long 64512,8064,92144,960
.long 64528,8080,92152,976
.long 73728,9216,90144,0
.long 73744,9232,90152,16
.long 73760,9248,90160,32
.long 73776,9264,90168,48
.long 73792,9280,90272,64
.long 73808,9296,90280,80
.long 73824,9312,90288,96
.long 73840,9328,90296,112
.long 82944,10368,90368,128
.long 82960,10384,90376,144
.long 82976,10400,90384,160
.long 82992,10416,90392,176
.long 83008,10432,90496,192
.long 83024,10448,90504,208
.long 83040,10464,90512,224
.long 83056,10480,90520,240
.long 92192,11552,90720,256
.long 92208,11568,90728,272
.long 92160,11520,90736,288
.long 92176,11536,90744,304
.long 92256,11616,90848,320
.long 92272,11632,90856,336
.long 92224,11584,90864,352
.long 92240,11600,90872,368
.long 101408,12704,90944,384
.long 101424,12720,90952,400
.long 101376,12672,90960,416
.long 101392,12688,90968,432
.long 101472,12768,91072,448
.long 101488,12784,91080,464
.long 101440,12736,91088,480
.long 101456,12752,91096,496
.long 110656,13888,91168,544
.long 110672,13904,91176,560
.long 110688,13920,91184,512
.long 110704,13936,91192,528
.long 110592,13824,91296,608
.long 110608,13840,91304,624
.long 110624,13856,91312,576
.long 110640,13872,91320,592
.long 119872,15040,91392,672
.long 119888,15056,91400,688
.long 119904,15072,91408,640
.long 119920,15088,91416,656
.long 119808,14976,91520,736
.long 119824,14992,91528,752
.long 119840,15008,91536,704
.long 119856,15024,91544,720
.long 129120,16224,91744,800
.long 129136,16240,91752,816
.long 129088,16192,91760,768
.long 129104,16208,91768,784
.long 129056,16160,91872,864
.long 129072,16176,91880,880
.long 129024,16128,91888,832
.long 129040,16144,91896,848
.long 138336,17376,91968,928
.long 138352,17392,91976,944
.long 138304,17344,91984,896
.long 138320,17360,91992,912
.long 138272,17312,92096,992
.long 138288,17328,92104,1008
.long 138240,17280,92112,960
.long 138256,17296,92120,976
.long 147456,18432,90176,0
.long 147472,18448,90184,16
.long 147488,18464,90192,32
.long 147504,18480,90200,48
.long 147520,18496,90304,64
.long 147536,18512,90312,80
.long 147552,18528,90320,96
.long 147568,18544,90328,112
.long 156672,19584,90464,128
.long 156688,19600,90472,144
.long 156704,19616,90480,160
.long 156720,19632,90488,176
.long 156736,19648,90592,192
.long 156752,19664,90600,208
.long 156768,19680,90608,224
.long 156784,19696,90616,240
.long 165920,20768,90624,256
.long 165936,20784,90632,272
.long 165888,20736,90640,288
.long 165904,20752,90648,304
.long 165984,20832,90752,320
.long 166000,20848,90760,336
.long 165952,20800,90768,352
.long 165968,20816,90776,368
.long 175136,21920,90912,384
.long 175152,21936,90920,400
.long 175104,21888,90928,416
.long 175120,21904,90936,432
.long 175200,21984,91040,448
.long 175216,22000,91048,464
.long 175168,21952,91056,480
.long 175184,21968,91064,496
.long 184384,23104,91200,544
.long 184400,23120,91208,560
.long 184416,23136,91216,512
.long 184432,23152,91224,528
.long 184320,23040,91328,608
.long 184336,23056,91336,624
.long 184352,23072,91344,576
.long 184368,23088,91352,592
.long 193600,24256,91488,672
.long 193616,24272,91496,688
.long 193632,24288,91504,640
.long 193648,24304,91512,656
.long 193536,24192,91616,736
.long 193552,24208,91624,752
.long 193568,24224,91632,704
.long 193584,24240,91640,720
.long 202848,25440,91648,800
.long 202864,25456,91656,816
.long 202816,25408,91664,768
.long 202832,25424,91672,784
.long 202784,25376,91776,864
.long 202800,25392,91784,880
.long 202752,25344,91792,832
.long 202768,25360,91800,848
.long 212064,26592,91936,928
.long 212080,26608,91944,944
.long 212032,26560,91952,896
.long 212048,26576,91960,912
.long 212000,26528,92064,992
.long 212016,26544,92072,1008
.long 211968,26496,92080,960
.long 211984,26512,92088,976
.long 221184,27648,90208,0
.long 221200,27664,90216,16
.long 221216,27680,90224,32
.long 221232,27696,90232,48
.long 221248,27712,90336,64
.long 221264,27728,90344,80
.long 221280,27744,90352,96
.long 221296,27760,90360,112
.long 230400,28800,90432,128
.long 230416,28816,90440,144
.long 230432,28832,90448,160
.long 230448,28848,90456,176
.long 230464,28864,90560,192
.long 230480,28880,90568,208
.long 230496,28896,90576,224
.long 230512,28912,90584,240
.long 239648,29984,90656,256
.long 239664,30000,90664,272
.long 239616,29952,90672,288
.long 239632,29968,90680,304
.long 239712,30048,90784,320
.long 239728,30064,90792,336
.long 239680,30016,90800,352
.long 239696,30032,90808,368
.long 248864,31136,90880,384
.long 248880,31152,90888,400
.long 248832,31104,90896,416
.long 248848,31120,90904,432
.long 248928,31200,91008,448
.long 248944,31216,91016,464
.long 248896,31168,91024,480
.long 248912,31184,91032,496
.long 258112,32320,91232,544
.long 258128,32336,91240,560
.long 258144,32352,91248,512
.long 258160,32368,91256,528
.long 258048,32256,91360,608
.long 258064,32272,91368,624
.long 258080,32288,91376,576
.long 258096,32304,91384,592
.long 267328,33472,91456,672
.long 267344,33488,91464,688
.long 267360,33504,91472,640
.long 267376,33520,91480,656
.long 267264,33408,91584,736
.long 267280,33424,91592,752
.long 267296,33440,91600,704
.long 267312,33456,91608,720
.long 276576,34656,91680,800
.long 276592,34672,91688,816
.long 276544,34624,91696,768
.long 276560,34640,91704,784
.long 276512,34592,91808,864
.long 276528,34608,91816,880
.long 276480,34560,91824,832
.long 276496,34576,91832,848
.long 285792,35808,91904,928
.long 285808,35824,91912,944
.long 285760,35776,91920,896
.long 285776,35792,91928,912
.long 285728,35744,92032,992
.long 285744,35760,92040,1008
.long 285696,35712,92048,960
.long 285712,35728,92056,976
.long 0,8,288,280
.long 16,24,296,288
.long 32,40,304,296
.long 48,56,312,304
.long 64,4168,352,344
.long 80,4184,360,352
.long 96,4200,368,360
.long 112,4216,376,368
.long 128,4,416,408
.long 144,20,424,416
.long 160,36,432,424
.long 176,52,440,432
.long 192,4164,480,472
.long 208,4180,488,480
.long 224,4196,496,488
.long 240,4212,504,496
.long 256,72,272,264
.long 272,88,280,272
.long 288,104,288,280
.long 304,120,296,288
.long 320,4232,336,328
.long 336,4248,344,336
.long 352,4264,352,344
.long 368,4280,360,352
.long 384,68,400,392
.long 400,84,408,400
.long 416,100,416,408
.long 432,116,424,416
.long 448,4228,464,456
.long 464,4244,472,464
.long 480,4260,480,472
.long 496,4276,488,480
.long 544,136,256,56
.long 560,152,264,256
.long 512,168,272,264
.long 528,184,280,272
.long 608,4296,320,120
.long 624,4312,328,320
.long 576,4328,336,328
.long 592,4344,344,336
.long 672,132,384,184
.long 688,148,392,384
.long 640,164,400,392
.long 656,180,408,400
.long 736,4292,448,248
.long 752,4308,456,448
.long 704,4324,464,456
.long 720,4340,472,464
.long 800,200,48,40
.long 816,216,56,48
.long 768,232,256,56
.long 784,248,264,256
.long 864,4360,112,104
.long 880,4376,120,112
.long 832,4392,320,120
.long 848,4408,328,320
.long 928,196,176,168
.long 944,212,184,176
.long 896,228,384,184
.long 912,244,392,384
.long 992,4356,240,232
.long 1008,4372,248,240
.long 960,4388,448,248
.long 976,4404,456,448
.long 8,264,288,280
.long 24,280,296,288
.long 40,296,304,296
.long 56,312,312,304
.long 72,4424,352,344
.long 88,4440,360,352
.long 104,4456,368,360
.long 120,4472,376,368
.long 136,260,416,408
.long 152,276,424,416
.long 168,292,432,424
.long 184,308,440,432
.long 200,4420,480,472
.long 216,4436,488,480
.long 232,4452,496,488
.long 248,4468,504,496
.long 264,328,272,264
.long 280,344,280,272
.long 296,360,288,280
.long 312,376,296,288
.long 328,4488,336,328
.long 344,4504,344,336
.long 360,4520,352,344
.long 376,4536,360,352
.long 392,324,400,392
.long 408,340,408,400
.long 424,356,416,408
.long 440,372,424,416
.long 456,4484,464,456
.long 472,4500,472,464
.long 488,4516,480,472
.long 504,4532,488,480
.long 552,392,256,56
.long 568,408,264,256
.long 520,424,272,264
.long 536,440,280,272
.long 616,4552,320,120
.long 632,4568,328,320
.long 584,4584,336,328
.long 600,4600,344,336
.long 680,388,384,184
.long 696,404,392,384
.long 648,420,400,392
.long 664,436,408,400
.long 744,4548,448,248
.long 760,4564,456,448
.long 712,4580,464,456
.long 728,4596,472,464
.long 808,456,48,40
.long 824,472,56,48
.long 776,488,256,56
.long 792,504,264,256
.long 872,4616,112,104
.long 888,4632,120,112
.long 840,4648,320,120
.long 856,4664,328,320
.long 936,452,176,168
.long 952,468,184,176
.long 904,484,384,184
.long 920,500,392,384
.long 1000,4612,240,232
.long 1016,4628,248,240
.long 968,4644,448,248
.long 984,4660,456,448
.long 4160,520,21536,21528
.long 4176,536,21544,21536
.long 4192,552,21552,21544
.long 4208,568,21560,21552
.long 4096,4680,21600,21592
.long 4112,4696,21608,21600
.long 4128,4712,21616,21608
.long 4144,4728,21624,21616
.long 4288,516,21664,21656
.long 4304,532,21672,21664
.long 4320,548,21680,21672
.long 4336,564,21688,21680
.long 4224,4676,21728,21720
.long 4240,4692,21736,21728
.long 4256,4708,21744,21736
.long 4272,4724,21752,21744
.long 4416,584,21520,21512
.long 4432,600,21528,21520
.long 4448,616,21536,21528
.long 4464,632,21544,21536
.long 4352,4744,21584,21576
.long 4368,4760,21592,21584
.long 4384,4776,21600,21592
.long 4400,4792,21608,21600
.long 4544,580,21648,21640
.long 4560,596,21656,21648
.long 4576,612,21664,21656
.long 4592,628,21672,21664
.long 4480,4740,21712,21704
.long 4496,4756,21720,21712
.long 4512,4772,21728,21720
.long 4528,4788,21736,21728
.long 4704,648,21504,21304
.long 4720,664,21512,21504
.long 4672,680,21520,21512
.long 4688,696,21528,21520
.long 4640,4808,21568,21368
.long 4656,4824,21576,21568
.long 4608,4840,21584,21576
.long 4624,4856,21592,21584
.long 4832,644,21632,21432
.long 4848,660,21640,21632
.long 4800,676,21648,21640
.long 4816,692,21656,21648
.long 4768,4804,21696,21496
.long 4784,4820,21704,21696
.long 4736,4836,21712,21704
.long 4752,4852,21720,21712
.long 4960,712,21296,21288
.long 4976,728,21304,21296
.long 4928,744,21504,21304
.long 4944,760,21512,21504
.long 4896,4872,21360,21352
.long 4912,4888,21368,21360
.long 4864,4904,21568,21368
.long 4880,4920,21576,21568
.long 5088,708,21424,21416
.long 5104,724,21432,21424
.long 5056,740,21632,21432
.long 5072,756,21640,21632
.long 5024,4868,21488,21480
.long 5040,4884,21496,21488
.long 4992,4900,21696,21496
.long 5008,4916,21704,21696
.long 4168,776,21536,21528
.long 4184,792,21544,21536
.long 4200,808,21552,21544
.long 4216,824,21560,21552
.long 4104,4936,21600,21592
.long 4120,4952,21608,21600
.long 4136,4968,21616,21608
.long 4152,4984,21624,21616
.long 4296,772,21664,21656
.long 4312,788,21672,21664
.long 4328,804,21680,21672
.long 4344,820,21688,21680
.long 4232,4932,21728,21720
.long 4248,4948,21736,21728
.long 4264,4964,21744,21736
.long 4280,4980,21752,21744
.long 4424,840,21520,21512
.long 4440,856,21528,21520
.long 4456,872,21536,21528
.long 4472,888,21544,21536
.long 4360,5000,21584,21576
.long 4376,5016,21592,21584
.long 4392,5032,21600,21592
.long 4408,5048,21608,21600
.long 4552,836,21648,21640
.long 4568,852,21656,21648
.long 4584,868,21664,21656
.long 4600,884,21672,21664
.long 4488,4996,21712,21704
.long 4504,5012,21720,21712
.long 4520,5028,21728,21720
.long 4536,5044,21736,21728
.long 4712,904,21504,21304
.long 4728,920,21512,21504
.long 4680,936,21520,21512
.long 4696,952,21528,21520
.long 4648,5064,21568,21368
.long 4664,5080,21576,21568
.long 4616,5096,21584,21576
.long 4632,5112,21592,21584
.long 4840,900,21632,21432
.long 4856,916,21640,21632
.long 4808,932,21648,21640
.long 4824,948,21656,21648
.long 4776,5060,21696,21496
.long 4792,5076,21704,21696
.long 4744,5092,21712,21704
.long 4760,5108,21720,21712
.long 4968,968,21296,21288
.long 4984,984,21304,21296
.long 4936,1000,21504,21304
.long 4952,1016,21512,21504
.long 4904,5128,21360,21352
.long 4920,5144,21368,21360
.long 4872,5160,21568,21368
.long 4888,5176,21576,21568
.long 5096,964,21424,21416
.long 5112,980,21432,21424
.long 5064,996,21632,21432
.long 5080,1012,21640,21632
.long 5032,5124,21488,21480
.long 5048,5140,21496,21488
.long 5000,5156,21696,21496
.long 5016,5172,21704,21696
.long 16672,0,0,0
.long 16704,32,4096,256
.long 16736,64,8192,544
.long 16768,96,12288,800
.long 16800,128,16384,16
.long 16832,160,20480,272
.long 16864,192,24576,560
.long 16896,224,28672,816
.long 16928,256,32768,32
.long 16960,288,36864,288
.long 16992,320,40960,512
.long 17024,352,45056,768
.long 17056,384,49152,48
.long 17088,416,53248,304
.long 17120,448,57344,528
.long 17152,480,61440,784
.long 16688,8,16,128
.long 16720,40,4112,384
.long 16752,72,8208,672
.long 16784,104,12304,928
.long 16816,136,16400,144
.long 16848,168,20496,400
.long 16880,200,24592,688
.long 16912,232,28688,944
.long 16944,264,32784,160
.long 16976,296,36880,416
.long 17008,328,40976,640
.long 17040,360,45072,896
.long 17072,392,49168,176
.long 17104,424,53264,432
.long 17136,456,57360,656
.long 17168,488,61456,912
.long 16704,16,32,1024
.long 16736,48,4128,1280
.long 16768,80,8224,1568
.long 16800,112,12320,1824
.long 16832,144,16416,1040
.long 16864,176,20512,1296
.long 16896,208,24608,1584
.long 16928,240,28704,1840
.long 16960,272,32800,1056
.long 16992,304,36896,1312
.long 17024,336,40992,1536
.long 17056,368,45088,1792
.long 17088,400,49184,1072
.long 17120,432,53280,1328
.long 17152,464,57376,1552
.long 17184,496,61472,1808
.long 16720,24,48,1152
.long 16752,56,4144,1408
.long 16784,88,8240,1696
.long 16816,120,12336,1952
.long 16848,152,16432,1168
.long 16880,184,20528,1424
.long 16912,216,24624,1712
.long 16944,248,28720,1968
.long 16976,280,32816,1184
.long 17008,312,36912,1440
.long 17040,344,41008,1664
.long 17072,376,45104,1920
.long 17104,408,49200,1200
.long 17136,440,53296,1456
.long 17168,472,57392,1680
.long 17200,504,61488,1936
.long 16672,0,0,0
.long 16704,32,4096,256
.long 16736,64,8192,544
.long 16768,96,12288,800
.long 16800,128,16384,16
.long 16832,160,20480,272
.long 16864,192,24576,560
.long 16896,224,28672,816
.long 16928,256,32768,32
.long 16960,288,36864,288
.long 16992,320,40960,512
.long 17024,352,45056,768
.long 17056,384,49152,48
.long 17088,416,53248,304
.long 17120,448,57344,528
.long 17152,480,61440,784
.long 16688,8,16,128
.long 16720,40,4112,384
.long 16752,72,8208,672
.long 16784,104,12304,928
.long 16816,136,16400,144
.long 16848,168,20496,400
.long 16880,200,24592,688
.long 16912,232,28688,944
.long 16944,264,32784,160
.long 16976,296,36880,416
.long 17008,328,40976,640
.long 17040,360,45072,896
.long 17072,392,49168,176
.long 17104,424,53264,432
.long 17136,456,57360,656
.long 17168,488,61456,912
.long 16704,16,32,1024
.long 16736,48,4128,1280
.long 16768,80,8224,1568
.long 16800,112,12320,1824
.long 16832,144,16416,1040
.long 16864,176,20512,1296
.long 16896,208,24608,1584
.long 16928,240,28704,1840
.long 16960,272,32800,1056
.long 16992,304,36896,1312
.long 17024,336,40992,1536
.long 17056,368,45088,1792
.long 17088,400,49184,1072
.long 17120,432,53280,1328
.long 17152,464,57376,1552
.long 17184,496,61472,1808
.long 16720,24,48,1152
.long 16752,56,4144,1408
.long 16784,88,8240,1696
.long 16816,120,12336,1952
.long 16848,152,16432,1168
.long 16880,184,20528,1424
.long 16912,216,24624,1712
.long 16944,248,28720,1968
.long 16976,280,32816,1184
.long 17008,312,36912,1440
.long 17040,344,41008,1664
.long 17072,376,45104,1920
.long 17104,408,49200,1200
.long 17136,440,53296,1456
.long 17168,472,57392,1680
.long 17200,504,61488,1936
.long 37920,4096,0,0
.long 37952,4128,4096,256
.long 37984,4160,8192,544
.long 38016,4192,12288,800
.long 38048,4224,16384,16
.long 38080,4256,20480,272
.long 38112,4288,24576,560
.long 38144,4320,28672,816
.long 38176,4352,32768,32
.long 38208,4384,36864,288
.long 38240,4416,40960,512
.long 38272,4448,45056,768
.long 38304,4480,49152,48
.long 38336,4512,53248,304
.long 38368,4544,57344,528
.long 38400,4576,61440,784
.long 37936,4104,16,128
.long 37968,4136,4112,384
.long 38000,4168,8208,672
.long 38032,4200,12304,928
.long 38064,4232,16400,144
.long 38096,4264,20496,400
.long 38128,4296,24592,688
.long 38160,4328,28688,944
.long 38192,4360,32784,160
.long 38224,4392,36880,416
.long 38256,4424,40976,640
.long 38288,4456,45072,896
.long 38320,4488,49168,176
.long 38352,4520,53264,432
.long 38384,4552,57360,656
.long 38416,4584,61456,912
.long 37952,4112,32,1024
.long 37984,4144,4128,1280
.long 38016,4176,8224,1568
.long 38048,4208,12320,1824
.long 38080,4240,16416,1040
.long 38112,4272,20512,1296
.long 38144,4304,24608,1584
.long 38176,4336,28704,1840
.long 38208,4368,32800,1056
.long 38240,4400,36896,1312
.long 38272,4432,40992,1536
.long 38304,4464,45088,1792
.long 38336,4496,49184,1072
.long 38368,4528,53280,1328
.long 38400,4560,57376,1552
.long 38432,4592,61472,1808
.long 37968,4120,48,1152
.long 38000,4152,4144,1408
.long 38032,4184,8240,1696
.long 38064,4216,12336,1952
.long 38096,4248,16432,1168
.long 38128,4280,20528,1424
.long 38160,4312,24624,1712
.long 38192,4344,28720,1968
.long 38224,4376,32816,1184
.long 38256,4408,36912,1440
.long 38288,4440,41008,1664
.long 38320,4472,45104,1920
.long 38352,4504,49200,1200
.long 38384,4536,53296,1456
.long 38416,4568,57392,1680
.long 38448,4600,61488,1936
.long 37920,4096,0,0
.long 37952,4128,4096,256
.long 37984,4160,8192,544
.long 38016,4192,12288,800
.long 38048,4224,16384,16
.long 38080,4256,20480,272
.long 38112,4288,24576,560
.long 38144,4320,28672,816
.long 38176,4352,32768,32
.long 38208,4384,36864,288
.long 38240,4416,40960,512
.long 38272,4448,45056,768
.long 38304,4480,49152,48
.long 38336,4512,53248,304
.long 38368,4544,57344,528
.long 38400,4576,61440,784
.long 37936,4104,16,128
.long 37968,4136,4112,384
.long 38000,4168,8208,672
.long 38032,4200,12304,928
.long 38064,4232,16400,144
.long 38096,4264,20496,400
.long 38128,4296,24592,688
.long 38160,4328,28688,944
.long 38192,4360,32784,160
.long 38224,4392,36880,416
.long 38256,4424,40976,640
.long 38288,4456,45072,896
.long 38320,4488,49168,176
.long 38352,4520,53264,432
.long 38384,4552,57360,656
.long 38416,4584,61456,912
.long 37952,4112,32,1024
.long 37984,4144,4128,1280
.long 38016,4176,8224,1568
.long 38048,4208,12320,1824
.long 38080,4240,16416,1040
.long 38112,4272,20512,1296
.long 38144,4304,24608,1584
.long 38176,4336,28704,1840
.long 38208,4368,32800,1056
.long 38240,4400,36896,1312
.long 38272,4432,40992,1536
.long 38304,4464,45088,1792
.long 38336,4496,49184,1072
.long 38368,4528,53280,1328
.long 38400,4560,57376,1552
.long 38432,4592,61472,1808
.long 37968,4120,48,1152
.long 38000,4152,4144,1408
.long 38032,4184,8240,1696
.long 38064,4216,12336,1952
.long 38096,4248,16432,1168
.long 38128,4280,20528,1424
.long 38160,4312,24624,1712
.long 38192,4344,28720,1968
.long 38224,4376,32816,1184
.long 38256,4408,36912,1440
.long 38288,4440,41008,1664
.long 38320,4472,45104,1920
.long 38352,4504,49200,1200
.long 38384,4536,53296,1456
.long 38416,4568,57392,1680
.long 38448,4600,61488,1936
.long 0,0,0,9830400
.long 544,268435456,16,9830528
.long 8,268435456,32,9830656
.long 552,268435456,48,9830784
.long 4160,268435456,64,9830912
.long 4704,268435456,80,9831040
.long 4168,268435456,96,9831168
.long 4712,268435456,112,9831296
.long 16,268435456,128,9831424
.long 560,268435456,144,9831552
.long 24,268435456,160,9831680
.long 568,268435456,176,9831808
.long 4176,268435456,192,9831936
.long 4720,268435456,208,9832064
.long 4184,268435456,224,9832192
.long 4728,268435456,240,9832320
.long 32,268435456,16640,9832448
.long 512,268435456,16656,9832576
.long 40,268435456,16672,9832704
.long 520,268435456,16688,9832832
.long 4192,268435456,16704,9832960
.long 4672,268435456,16720,9833088
.long 4200,268435456,16736,9833216
.long 4680,268435456,16752,9833344
.long 48,268435456,16768,9833472
.long 528,268435456,16784,9833600
.long 56,268435456,16800,9833728
.long 536,268435456,16816,9833856
.long 4208,268435456,16832,9833984
.long 4688,268435456,16848,9834112
.long 4216,268435456,16864,9834240
.long 4696,268435456,16880,9834368
.long 64,268435456,16896,9834496
.long 608,268435456,16912,9834624
.long 72,268435456,16928,9834752
.long 616,268435456,16944,9834880
.long 4096,268435456,16960,9835008
.long 4640,268435456,16976,9835136
.long 4104,268435456,16992,9835264
.long 4648,268435456,17008,9835392
.long 80,268435456,17024,9835520
.long 624,268435456,17040,9835648
.long 88,268435456,17056,9835776
.long 632,268435456,17072,9835904
.long 4112,268435456,17088,9836032
.long 4656,268435456,17104,9836160
.long 4120,268435456,17120,9836288
.long 4664,268435456,17136,9836416
.long 96,268435456,16640,9836544
.long 576,268435456,16656,9836672
.long 104,268435456,16672,9836800
.long 584,268435456,16688,9836928
.long 4128,268435456,16704,9837056
.long 4608,268435456,16720,9837184
.long 4136,268435456,16736,9837312
.long 4616,268435456,16752,9837440
.long 112,268435456,16768,9837568
.long 592,268435456,16784,9837696
.long 120,268435456,16800,9837824
.long 600,268435456,16816,9837952
.long 4144,268435456,16832,9838080
.long 4624,268435456,16848,9838208
.long 4152,268435456,16864,9838336
.long 4632,268435456,16880,9838464
.long 1024,268435456,21248,9838592
.long 1568,268435456,21264,9838720
.long 1032,268435456,21280,9838848
.long 1576,268435456,21296,9838976
.long 5184,268435456,21312,9839104
.long 5728,268435456,21328,9839232
.long 5192,268435456,21344,9839360
.long 5736,268435456,21360,9839488
.long 1040,268435456,21376,9839616
.long 1584,268435456,21392,9839744
.long 1048,268435456,21408,9839872
.long 1592,268435456,21424,9840000
.long 5200,268435456,21440,9840128
.long 5744,268435456,21456,9840256
.long 5208,268435456,21472,9840384
.long 5752,268435456,21488,9840512
.long 1056,268435456,37888,9840640
.long 1536,268435456,37904,9840768
.long 1064,268435456,37920,9840896
.long 1544,268435456,37936,9841024
.long 5216,268435456,37952,9841152
.long 5696,268435456,37968,9841280
.long 5224,268435456,37984,9841408
.long 5704,268435456,38000,9841536
.long 1072,268435456,38016,9841664
.long 1552,268435456,38032,9841792
.long 1080,268435456,38048,9841920
.long 1560,268435456,38064,9842048
.long 5232,268435456,38080,9842176
.long 5712,268435456,38096,9842304
.long 5240,268435456,38112,9842432
.long 5720,268435456,38128,9842560
.long 1088,268435456,38144,9842688
.long 1632,268435456,38160,9842816
.long 1096,268435456,38176,9842944
.long 1640,268435456,38192,9843072
.long 5120,268435456,38208,9843200
.long 5664,268435456,38224,9843328
.long 5128,268435456,38240,9843456
.long 5672,268435456,38256,9843584
.long 1104,268435456,38272,9843712
.long 1648,268435456,38288,9843840
.long 1112,268435456,38304,9843968
.long 1656,268435456,38320,9844096
.long 5136,268435456,38336,9844224
.long 5680,268435456,38352,9844352
.long 5144,268435456,38368,9844480
.long 5688,268435456,38384,9844608
.long 1120,268435456,37888,9844736
.long 1600,268435456,37904,9844864
.long 1128,268435456,37920,9844992
.long 1608,268435456,37936,9845120
.long 5152,268435456,37952,9845248
.long 5632,268435456,37968,9845376
.long 5160,268435456,37984,9845504
.long 5640,268435456,38000,9845632
.long 1136,268435456,38016,9845760
.long 1616,268435456,38032,9845888
.long 1144,268435456,38048,9846016
.long 1624,268435456,38064,9846144
.long 5168,268435456,38080,9846272
.long 5648,268435456,38096,9846400
.long 5176,268435456,38112,9846528
.long 5656,268435456,38128,9846656
.long 2048,268435456,42496,9846784
.long 2592,268435456,42512,9846912
.long 2056,268435456,42528,9847040
.long 2600,268435456,42544,9847168
.long 6208,268435456,42560,9847296
.long 6752,268435456,42576,9847424
.long 6216,268435456,42592,9847552
.long 6760,268435456,42608,9847680
.long 2064,268435456,42624,9847808
.long 2608,268435456,42640,9847936
.long 2072,268435456,42656,9848064
.long 2616,268435456,42672,9848192
.long 6224,268435456,42688,9848320
.long 6768,268435456,42704,9848448
.long 6232,268435456,42720,9848576
.long 6776,268435456,42736,9848704
.long 2080,268435456,59136,9848832
.long 2560,268435456,59152,9848960
.long 2088,268435456,59168,9849088
.long 2568,268435456,59184,9849216
.long 6240,268435456,59200,9849344
.long 6720,268435456,59216,9849472
.long 6248,268435456,59232,9849600
.long 6728,268435456,59248,9849728
.long 2096,268435456,59264,9849856
.long 2576,268435456,59280,9849984
.long 2104,268435456,59296,9850112
.long 2584,268435456,59312,9850240
.long 6256,268435456,59328,9850368
.long 6736,268435456,59344,9850496
.long 6264,268435456,59360,9850624
.long 6744,268435456,59376,9850752
.long 2112,268435456,59392,9850880
.long 2656,268435456,59408,9851008
.long 2120,268435456,59424,9851136
.long 2664,268435456,59440,9851264
.long 6144,268435456,59456,9851392
.long 6688,268435456,59472,9851520
.long 6152,268435456,59488,9851648
.long 6696,268435456,59504,9851776
.long 2128,268435456,59520,9851904
.long 2672,268435456,59536,9852032
.long 2136,268435456,59552,9852160
.long 2680,268435456,59568,9852288
.long 6160,268435456,59584,9852416
.long 6704,268435456,59600,9852544
.long 6168,268435456,59616,9852672
.long 6712,268435456,59632,9852800
.long 2144,268435456,59136,9852928
.long 2624,268435456,59152,9853056
.long 2152,268435456,59168,9853184
.long 2632,268435456,59184,9853312
.long 6176,268435456,59200,9853440
.long 6656,268435456,59216,9853568
.long 6184,268435456,59232,9853696
.long 6664,268435456,59248,9853824
.long 2160,268435456,59264,9853952
.long 2640,268435456,59280,9854080
.long 2168,268435456,59296,9854208
.long 2648,268435456,59312,9854336
.long 6192,268435456,59328,9854464
.long 6672,268435456,59344,9854592
.long 6200,268435456,59360,9854720
.long 6680,268435456,59376,9854848
.long 3072,268435456,0,9854976
.long 3616,268435456,16,9855104
.long 3080,268435456,32,9855232
.long 3624,268435456,48,9855360
.long 7232,268435456,64,9855488
.long 7776,268435456,80,9855616
.long 7240,268435456,96,9855744
.long 7784,268435456,112,9855872
.long 3088,268435456,128,9856000
.long 3632,268435456,144,9856128
.long 3096,268435456,160,9856256
.long 3640,268435456,176,9856384
.long 7248,268435456,192,9856512
.long 7792,268435456,208,9856640
.long 7256,268435456,224,9856768
.long 7800,268435456,240,9856896
.long 3104,268435456,16640,9857024
.long 3584,268435456,16656,9857152
.long 3112,268435456,16672,9857280
.long 3592,268435456,16688,9857408
.long 7264,268435456,16704,9857536
.long 7744,268435456,16720,9857664
.long 7272,268435456,16736,9857792
.long 7752,268435456,16752,9857920
.long 3120,268435456,16768,9858048
.long 3600,268435456,16784,9858176
.long 3128,268435456,16800,9858304
.long 3608,268435456,16816,9858432
.long 7280,268435456,16832,9858560
.long 7760,268435456,16848,9858688
.long 7288,268435456,16864,9858816
.long 7768,268435456,16880,9858944
.long 3136,268435456,16896,9859072
.long 3680,268435456,16912,9859200
.long 3144,268435456,16928,9859328
.long 3688,268435456,16944,9859456
.long 7168,268435456,16960,9859584
.long 7712,268435456,16976,9859712
.long 7176,268435456,16992,9859840
.long 7720,268435456,17008,9859968
.long 3152,268435456,17024,9860096
.long 3696,268435456,17040,9860224
.long 3160,268435456,17056,9860352
.long 3704,268435456,17072,9860480
.long 7184,268435456,17088,9860608
.long 7728,268435456,17104,9860736
.long 7192,268435456,17120,9860864
.long 7736,268435456,17136,9860992
.long 3168,268435456,16640,9861120
.long 3648,268435456,16656,9861248
.long 3176,268435456,16672,9861376
.long 3656,268435456,16688,9861504
.long 7200,268435456,16704,9861632
.long 7680,268435456,16720,9861760
.long 7208,268435456,16736,9861888
.long 7688,268435456,16752,9862016
.long 3184,268435456,16768,9862144
.long 3664,268435456,16784,9862272
.long 3192,268435456,16800,9862400
.long 3672,268435456,16816,9862528
.long 7216,268435456,16832,9862656
.long 7696,268435456,16848,9862784
.long 7224,268435456,16864,9862912
.long 7704,268435456,16880,9863040
.long 0,0,90112,0
.long 1152,16,90120,268435456
.long 2304,32,90128,268435456
.long 3456,48,90136,268435456
.long 4608,4096,90176,268435456
.long 5760,4112,90184,268435456
.long 6912,4128,90192,268435456
.long 8064,4144,90200,268435456
.long 9216,8192,90240,268435456
.long 10368,8208,90248,268435456
.long 11520,8224,90256,268435456
.long 12672,8240,90264,268435456
.long 13824,12288,90304,268435456
.long 14976,12304,90312,268435456
.long 16128,12320,90320,268435456
.long 17280,12336,90328,268435456
.long 18432,16384,90144,268435456
.long 19584,16400,90152,268435456
.long 20736,16416,90160,268435456
.long 21888,16432,90168,268435456
.long 23040,20480,90208,268435456
.long 24192,20496,90216,268435456
.long 25344,20512,90224,268435456
.long 26496,20528,90232,268435456
.long 27648,24576,90272,268435456
.long 28800,24592,90280,268435456
.long 29952,24608,90288,268435456
.long 31104,24624,90296,268435456
.long 32256,28672,90336,268435456
.long 33408,28688,90344,268435456
.long 34560,28704,90352,268435456
.long 35712,28720,90360,268435456
.long 16,32768,90624,268435456
.long 1168,32784,90632,268435456
.long 2320,32800,90640,268435456
.long 3472,32816,90648,268435456
.long 4624,36864,90688,268435456
.long 5776,36880,90696,268435456
.long 6928,36896,90704,268435456
.long 8080,36912,90712,268435456
.long 9232,40960,90752,268435456
.long 10384,40976,90760,268435456
.long 11536,40992,90768,268435456
.long 12688,41008,90776,268435456
.long 13840,45056,90816,268435456
.long 14992,45072,90824,268435456
.long 16144,45088,90832,268435456
.long 17296,45104,90840,268435456
.long 18448,49152,90656,268435456
.long 19600,49168,90664,268435456
.long 20752,49184,90672,268435456
.long 21904,49200,90680,268435456
.long 23056,53248,90720,268435456
.long 24208,53264,90728,268435456
.long 25360,53280,90736,268435456
.long 26512,53296,90744,268435456
.long 27664,57344,90784,268435456
.long 28816,57360,90792,268435456
.long 29968,57376,90800,268435456
.long 31120,57392,90808,268435456
.long 32272,61440,90848,268435456
.long 33424,61456,90856,268435456
.long 34576,61472,90864,268435456
.long 35728,61488,90872,268435456
.long 0,0,93184,0
.long 1152,16,93192,268435456
.long 2304,32,93200,268435456
.long 3456,48,93208,268435456
.long 4608,4096,93248,268435456
.long 5760,4112,93256,268435456
.long 6912,4128,93264,268435456
.long 8064,4144,93272,268435456
.long 9216,8192,93312,268435456
.long 10368,8208,93320,268435456
.long 11520,8224,93328,268435456
.long 12672,8240,93336,268435456
.long 13824,12288,93376,268435456
.long 14976,12304,93384,268435456
.long 16128,12320,93392,268435456
.long 17280,12336,93400,268435456
.long 18432,16384,93216,268435456
.long 19584,16400,93224,268435456
.long 20736,16416,93232,268435456
.long 21888,16432,93240,268435456
.long 23040,20480,93280,268435456
.long 24192,20496,93288,268435456
.long 25344,20512,93296,268435456
.long 26496,20528,93304,268435456
.long 27648,24576,93344,268435456
.long 28800,24592,93352,268435456
.long 29952,24608,93360,268435456
.long 31104,24624,93368,268435456
.long 32256,28672,93408,268435456
.long 33408,28688,93416,268435456
.long 34560,28704,93424,268435456
.long 35712,28720,93432,268435456
.long 16,32768,93696,268435456
.long 1168,32784,93704,268435456
.long 2320,32800,93712,268435456
.long 3472,32816,93720,268435456
.long 4624,36864,93760,268435456
.long 5776,36880,93768,268435456
.long 6928,36896,93776,268435456
.long 8080,36912,93784,268435456
.long 9232,40960,93824,268435456
.long 10384,40976,93832,268435456
.long 11536,40992,93840,268435456
.long 12688,41008,93848,268435456
.long 13840,45056,93888,268435456
.long 14992,45072,93896,268435456
.long 16144,45088,93904,268435456
.long 17296,45104,93912,268435456
.long 18448,49152,93728,268435456
.long 19600,49168,93736,268435456
.long 20752,49184,93744,268435456
.long 21904,49200,93752,268435456
.long 23056,53248,93792,268435456
.long 24208,53264,93800,268435456
.long 25360,53280,93808,268435456
.long 26512,53296,93816,268435456
.long 27664,57344,93856,268435456
.long 28816,57360,93864,268435456
.long 29968,57376,93872,268435456
.long 31120,57392,93880,268435456
.long 32272,61440,93920,268435456
.long 33424,61456,93928,268435456
.long 34576,61472,93936,268435456
.long 35728,61488,93944,268435456
.long 0,0,96256,0
.long 1152,16,96264,268435456
.long 2304,32,96272,268435456
.long 3456,48,96280,268435456
.long 4608,4096,96320,268435456
.long 5760,4112,96328,268435456
.long 6912,4128,96336,268435456
.long 8064,4144,96344,268435456
.long 9216,8192,96384,268435456
.long 10368,8208,96392,268435456
.long 11520,8224,96400,268435456
.long 12672,8240,96408,268435456
.long 13824,12288,96448,268435456
.long 14976,12304,96456,268435456
.long 16128,12320,96464,268435456
.long 17280,12336,96472,268435456
.long 18432,16384,96288,268435456
.long 19584,16400,96296,268435456
.long 20736,16416,96304,268435456
.long 21888,16432,96312,268435456
.long 23040,20480,96352,268435456
.long 24192,20496,96360,268435456
.long 25344,20512,96368,268435456
.long 26496,20528,96376,268435456
.long 27648,24576,96416,268435456
.long 28800,24592,96424,268435456
.long 29952,24608,96432,268435456
.long 31104,24624,96440,268435456
.long 32256,28672,96480,268435456
.long 33408,28688,96488,268435456
.long 34560,28704,96496,268435456
.long 35712,28720,96504,268435456
.long 16,32768,96768,268435456
.long 1168,32784,96776,268435456
.long 2320,32800,96784,268435456
.long 3472,32816,96792,268435456
.long 4624,36864,96832,268435456
.long 5776,36880,96840,268435456
.long 6928,36896,96848,268435456
.long 8080,36912,96856,268435456
.long 9232,40960,96896,268435456
.long 10384,40976,96904,268435456
.long 11536,40992,96912,268435456
.long 12688,41008,96920,268435456
.long 13840,45056,96960,268435456
.long 14992,45072,96968,268435456
.long 16144,45088,96976,268435456
.long 17296,45104,96984,268435456
.long 18448,49152,96800,268435456
.long 19600,49168,96808,268435456
.long 20752,49184,96816,268435456
.long 21904,49200,96824,268435456
.long 23056,53248,96864,268435456
.long 24208,53264,96872,268435456
.long 25360,53280,96880,268435456
.long 26512,53296,96888,268435456
.long 27664,57344,96928,268435456
.long 28816,57360,96936,268435456
.long 29968,57376,96944,268435456
.long 31120,57392,96952,268435456
.long 32272,61440,96992,268435456
.long 33424,61456,97000,268435456
.long 34576,61472,97008,268435456
.long 35728,61488,97016,268435456
.long 0,0,99328,0
.long 1152,16,99336,268435456
.long 2304,32,99344,268435456
.long 3456,48,99352,268435456
.long 4608,4096,99392,268435456
.long 5760,4112,99400,268435456
.long 6912,4128,99408,268435456
.long 8064,4144,99416,268435456
.long 9216,8192,99456,268435456
.long 10368,8208,99464,268435456
.long 11520,8224,99472,268435456
.long 12672,8240,99480,268435456
.long 13824,12288,99520,268435456
.long 14976,12304,99528,268435456
.long 16128,12320,99536,268435456
.long 17280,12336,99544,268435456
.long 18432,16384,99360,268435456
.long 19584,16400,99368,268435456
.long 20736,16416,99376,268435456
.long 21888,16432,99384,268435456
.long 23040,20480,99424,268435456
.long 24192,20496,99432,268435456
.long 25344,20512,99440,268435456
.long 26496,20528,99448,268435456
.long 27648,24576,99488,268435456
.long 28800,24592,99496,268435456
.long 29952,24608,99504,268435456
.long 31104,24624,99512,268435456
.long 32256,28672,99552,268435456
.long 33408,28688,99560,268435456
.long 34560,28704,99568,268435456
.long 35712,28720,99576,268435456
.long 16,32768,99840,268435456
.long 1168,32784,99848,268435456
.long 2320,32800,99856,268435456
.long 3472,32816,99864,268435456
.long 4624,36864,99904,268435456
.long 5776,36880,99912,268435456
.long 6928,36896,99920,268435456
.long 8080,36912,99928,268435456
.long 9232,40960,99968,268435456
.long 10384,40976,99976,268435456
.long 11536,40992,99984,268435456
.long 12688,41008,99992,268435456
.long 13840,45056,100032,268435456
.long 14992,45072,100040,268435456
.long 16144,45088,100048,268435456
.long 17296,45104,100056,268435456
.long 18448,49152,99872,268435456
.long 19600,49168,99880,268435456
.long 20752,49184,99888,268435456
.long 21904,49200,99896,268435456
.long 23056,53248,99936,268435456
.long 24208,53264,99944,268435456
.long 25360,53280,99952,268435456
.long 26512,53296,99960,268435456
.long 27664,57344,100000,268435456
.long 28816,57360,100008,268435456
.long 29968,57376,100016,268435456
.long 31120,57392,100024,268435456
.long 32272,61440,100064,268435456
.long 33424,61456,100072,268435456
.long 34576,61472,100080,268435456
.long 35728,61488,100088,268435456
.text
.p2align 12
.text
.globl parallel_sum__ssm_conv_s4d__dense_activation_silu__prompt_kernel
.p2align 8
.type parallel_sum__ssm_conv_s4d__dense_activation_silu__prompt_kernel,@function
parallel_sum__ssm_conv_s4d__dense_activation_silu__prompt_kernel:
    s_cmp_ge_u32 s2, 256
    s_cbranch_scc1 parallel_sum__ssm_conv_s4d__dense_activation_silu__prompt_kernel_end
    s_load_dwordx16 s[56:71], s[0:1], 0
    s_load_dwordx2 s[4:5], s[0:1], 64
    s_load_dwordx2 s[8:9], s[0:1], 72
    s_load_dwordx2 s[12:13], s[0:1], 96
    s_load_dwordx2 s[72:73], s[0:1], 88
    s_getpc_b64 s[16:17]
    s_add_u32 s16, s16, lane_tables@rel32@lo+4
    s_addc_u32 s17, s17, lane_tables@rel32@hi+12
    v_and_b32 v1, 63, v0
    v_lshrrev_b32 v6, 6, v0
    s_bfe_u32 s25, s2, 0x40003
    v_mul_u32_u24 v7, 9, v6
    v_min_u32 v2, 8, v1
    v_readfirstlane_b32 s3, v6
    v_add_u32 v2, v2, v7
    v_lshl_add_u32 v2, v2, 4, s25
    v_lshlrev_b32 v2, 7, v2
    v_min_u32 v2, code_end-lane_tables-4, v2
    v_mov_b32 v3, s17
    v_add_co_u32 v2, vcc, s16, v2
    v_lshlrev_b32 v223, 4, v0
    v_mov_b32 v5, s17
    v_addc_co_u32 v3, vcc, 0, v3, vcc
    global_load_dword v79, v[2:3], off
    v_add_u32 v4, 0x1000, v223
    v_add_co_u32 v4, vcc, s16, v4
    s_lshr_b32 s25, s2, 3
    s_and_b32 s26, s2, 7
    v_addc_co_u32 v5, vcc, 0, v5, vcc
    s_and_b32 s54, s26, 1
    s_lshl_b32 s54, s54, 4
    s_and_b32 s27, s25, 15
    s_add_u32 s54, s54, s27
    s_and_b32 s55, s26, 6
    s_lshr_b32 s27, s25, 4
    s_add_u32 s55, s55, s27
    s_lshr_b32 s27, s3, 1
    s_lshl_b32 s50, s2, 1
    s_add_u32 s50, s50, s27
    s_and_b32 s28, s3, 1
    s_lshl_b32 s28, s28, 7
    v_lshl_add_u32 v11, v1, 1, s28
    s_lshl_b32 s52, s50, 8
    s_lshl_b32 s29, s50, 1
    v_mov_b32 v12, 0
    v_lshrrev_b32 v6, 3, v1
    v_and_b32 v7, 7, v1
    v_mul_u32_u24 v78, 1152, v6
    v_lshl_add_u32 v78, v7, 4, v78
    s_mul_i32 s75, s54, 29
    s_lshr_b32 s75, s75, 8
    s_mul_i32 s74, s75, 9
    s_sub_u32 s74, s54, s74
    s_lshl_b32 s75, s75, 2
    s_sub_u32 s76, s75, 9
    s_cmp_ge_u32 s75, 9
    s_cselect_b32 s75, s76, s75
    s_lshl_b32 s25, s54, 2
    s_add_u32 s25, s25, s3
    s_mul_i32 s25, s25, 18432
    s_movk_i32 s18, 1152
    s_mov_b32 s19, 0x20000
    s_waitcnt lgkmcnt(0)
    s_cmp_lg_u32 s2, 253
    s_cbranch_scc1 parallel_sum__ssm_conv_s4d__dense_activation_silu__prompt_kernel_noseed
    s_and_b32 s13, s13, 0xffff
    s_mov_b32 s14, 0x10000000
    s_mov_b32 s15, 0x20000
    s_mov_b32 s26, 9862784
    buffer_load_dword v74, v12, s[12:15], s26 offen sc1
parallel_sum__ssm_conv_s4d__dense_activation_silu__prompt_kernel_noseed:
    s_mov_b32 s16, s66
    s_and_b32 s17, s67, 0xffff
    buffer_load_ushort v72, v12, s[16:19], s29 offen
    s_mov_b32 s16, s68
    s_and_b32 s17, s69, 0xffff
    buffer_load_ushort v73, v12, s[16:19], s29 offen
    s_mov_b32 s16, s58
    s_and_b32 s17, s59, 0xffff
    s_mov_b32 s18, 147456
    buffer_load_ushort v68, v11, s[16:19], s52 offen
    s_mov_b32 s16, s60
    s_and_b32 s17, s61, 0xffff
    buffer_load_ushort v69, v11, s[16:19], s52 offen
    s_mov_b32 s16, s62
    s_and_b32 s17, s63, 0xffff
    buffer_load_ushort v70, v11, s[16:19], s52 offen
    s_mov_b32 s16, s64
    s_and_b32 s17, s65, 0xffff
    buffer_load_ushort v71, v11, s[16:19], s52 offen
    s_lshr_b32 s51, s2, 3
    s_xor_b32 s53, s51, s2
    s_and_b32 s53, s53, 7
    s_cbranch_scc1 parallel_sum__ssm_conv_s4d__dense_activation_silu__prompt_kernel_nop2
    s_lshl_b32 s51, s51, 1
    s_lshr_b32 s52, s3, 1
    s_add_u32 s51, s51, s52
    s_add_u32 s51, s51, 512
    s_lshl_b32 s52, s51, 8
    s_lshl_b32 s29, s51, 1
    s_sub_u32 s51, s51, s50
    s_mul_i32 s40, s51, 8320
    s_mov_b32 s16, s66
    s_and_b32 s17, s67, 0xffff
    s_movk_i32 s18, 1152
    buffer_load_ushort v200, v12, s[16:19], s29 offen
    s_mov_b32 s16, s68
    s_and_b32 s17, s69, 0xffff
    buffer_load_ushort v201, v12, s[16:19], s29 offen
    s_mov_b32 s16, s58
    s_and_b32 s17, s59, 0xffff
    s_mov_b32 s18, 147456
    buffer_load_ushort v196, v11, s[16:19], s52 offen
    s_mov_b32 s16, s60
    s_and_b32 s17, s61, 0xffff
    buffer_load_ushort v197, v11, s[16:19], s52 offen
    s_mov_b32 s16, s62
    s_and_b32 s17, s63, 0xffff
    buffer_load_ushort v198, v11, s[16:19], s52 offen
    s_mov_b32 s16, s64
    s_and_b32 s17, s65, 0xffff
    buffer_load_ushort v199, v11, s[16:19], s52 offen
parallel_sum__ssm_conv_s4d__dense_activation_silu__prompt_kernel_nop2:
    s_mov_b32 s16, s56
    s_and_b32 s17, s57, 0xffff
    s_mov_b32 s18, 2359296
    s_mov_b32 s19, 0x20000
    s_lshl_b32 s58, s75, 7
    s_add_u32 s58, s58, s25
    s_add_u32 s27, s25, 1152
    buffer_load_dwordx4 v[100:103], v78, s[16:19], s58 offen
    global_load_dwordx4 v[56:59], v[4:5], off offset:-4096
    global_load_dwordx4 v[60:63], v[4:5], off offset:0
    v_add_co_u32 v4, vcc, 0x2000, v4
    s_nop 1
    v_addc_co_u32 v5, vcc, 0, v5, vcc
    global_load_dwordx4 v[64:67], v[4:5], off offset:-4096
    s_add_u32 s59, s58, 128
    s_cmp_eq_u32 s59, s27
    s_cselect_b32 s59, s25, s59
    buffer_load_dwordx4 v[104:107], v78, s[16:19], s59 offen
    s_add_u32 s60, s59, 128
    s_cmp_eq_u32 s60, s27
    s_cselect_b32 s60, s25, s60
    buffer_load_dwordx4 v[108:111], v78, s[16:19], s60 offen
    s_add_u32 s61, s60, 128
    s_cmp_eq_u32 s61, s27
    s_cselect_b32 s61, s25, s61
    buffer_load_dwordx4 v[112:115], v78, s[16:19], s61 offen
    s_add_u32 s62, s61, 128
    s_cmp_eq_u32 s62, s27
    s_cselect_b32 s62, s25, s62
    buffer_load_dwordx4 v[116:119], v78, s[16:19], s62 offen
    s_add_u32 s63, s62, 128
    s_cmp_eq_u32 s63, s27
    s_cselect_b32 s63, s25, s63
    buffer_load_dwordx4 v[120:123], v78, s[16:19], s63 offen
    s_add_u32 s64, s63, 128
    s_cmp_eq_u32 s64, s27
    s_cselect_b32 s64, s25, s64
    buffer_load_dwordx4 v[124:127], v78, s[16:19], s64 offen
    s_add_u32 s65, s64, 128
    s_cmp_eq_u32 s65, s27
    s_cselect_b32 s65, s25, s65
    buffer_load_dwordx4 v[128:131], v78, s[16:19], s65 offen
    s_add_u32 s66, s65, 128
    s_cmp_eq_u32 s66, s27
    s_cselect_b32 s66, s25, s66
    buffer_load_dwordx4 v[132:135], v78, s[16:19], s66 offen
    s_mov_b32 s25, s40
    s_mov_b32 s70, s74
    s_mov_b32 s71, s75
    s_and_b32 s13, s13, 0xffff
    s_mov_b32 s14, 0x10000000
    s_mov_b32 s15, 0x20000
    v_lshlrev_b32 v99, 4, v1
    s_mul_i32 s32, s75, 589824
    s_add_u32 s33, s32, 589824
    s_cmp_eq_u32 s33, 5308416
    s_cselect_b32 s33, 0, s33
    s_add_u32 s34, s33, 589824
    s_cmp_eq_u32 s34, 5308416
    s_cselect_b32 s34, 0, s34
    s_add_u32 s35, s34, 589824
    s_cmp_eq_u32 s35, 5308416
    s_cselect_b32 s35, 0, s35
    s_add_u32 s36, s35, 589824
    s_cmp_eq_u32 s36, 5308416
    s_cselect_b32 s36, 0, s36
    s_add_u32 s37, s36, 589824
    s_cmp_eq_u32 s37, 5308416
    s_cselect_b32 s37, 0, s37
    s_add_u32 s38, s37, 589824
    s_cmp_eq_u32 s38, 5308416
    s_cselect_b32 s38, 0, s38
    s_add_u32 s39, s38, 589824
    s_cmp_eq_u32 s39, 5308416
    s_cselect_b32 s39, 0, s39
    s_add_u32 s40, s39, 589824
    s_cmp_eq_u32 s40, 5308416
    s_cselect_b32 s40, 0, s40
    s_and_b32 s5, s5, 0xffff
    s_mov_b32 s6, 5308416
    s_mov_b32 s7, 0x20000
    s_and_b32 s9, s9, 0xffff
    s_mov_b32 s10, 5308416
    s_mov_b32 s11, 0x20000
    s_mul_i32 s67, s50, 8320
    s_add_u32 s67, s67, 35651840
    s_lshl_b32 s20, s3, 10
    s_mul_i32 s23, s55, 1152
    s_add_u32 s24, s23, 1152
    s_lshl_b32 s26, s70, 7
    s_add_u32 s22, s23, s26
    s_mov_b32 s30, 0x3fb8aa3b
    s_mul_i32 s74, s55, 9
    s_add_u32 s74, s74, s3
    s_lshr_b32 s75, s74, 1
    s_and_b32 s74, s74, 1
    s_lshl_b32 s56, s75, 16
    s_lshl_b32 s76, s74, 6
    s_add_u32 s56, s56, s76
    s_lshl_b32 s76, s54, 7
    s_add_u32 s56, s56, s76
    s_add_u32 s56, s56, 2359296
    s_lshr_b32 s76, s75, 1
    s_add_u32 s76, s76, 18
    s_lshl_b32 s77, s71, 1
    s_sub_u32 s76, s76, s77
    s_sub_u32 s77, s76, 18
    s_cmp_ge_u32 s76, 18
    s_cselect_b32 s76, s77, s76
    s_and_b32 s68, s76, 1
    s_lshl_b32 s68, s68, 6
    s_lshl_b32 s57, s76, 12
    s_lshl_b32 s74, s74, 11
    s_and_b32 s75, s75, 1
    s_lshl_b32 s75, s75, 3
    s_add_u32 s69, s74, s75
    s_mul_i32 s75, s55, 663552
    s_mul_i32 s74, s70, 73728
    s_add_u32 s41, s74, s75
    s_add_u32 s76, s75, 663552
    s_add_u32 s42, s41, 73728
    s_cmp_eq_u32 s42, s76
    s_cselect_b32 s42, s75, s42
    s_add_u32 s43, s42, 73728
    s_cmp_eq_u32 s43, s76
    s_cselect_b32 s43, s75, s43
    s_add_u32 s44, s43, 73728
    s_cmp_eq_u32 s44, s76
    s_cselect_b32 s44, s75, s44
    s_add_u32 s45, s44, 73728
    s_cmp_eq_u32 s45, s76
    s_cselect_b32 s45, s75, s45
    s_add_u32 s46, s45, 73728
    s_cmp_eq_u32 s46, s76
    s_cselect_b32 s46, s75, s46
    s_add_u32 s47, s46, 73728
    s_cmp_eq_u32 s47, s76
    s_cselect_b32 s47, s75, s47
    s_add_u32 s48, s47, 73728
    s_cmp_eq_u32 s48, s76
    s_cselect_b32 s48, s75, s48
    s_add_u32 s49, s48, 73728
    s_cmp_eq_u32 s49, s76
    s_cselect_b32 s49, s75, s49
    s_add_u32 s77, s70, s71
    s_sub_u32 s74, s77, 9
    s_cmp_ge_u32 s77, 9
    s_cselect_b32 s77, s74, s77
    s_lshl_b32 s29, s77, 7
    s_lshl_b32 s74, s55, 5
    s_add_u32 s74, s74, s54
    s_mul_i32 s74, s74, 73728
    s_lshl_b32 s75, s3, 11
    s_add_u32 s74, s74, s75
    s_add_u32 s27, s74, 16777216
    s_add_u32 s28, s27, 73728
    s_lshl_b32 s75, s77, 13
    s_add_u32 s26, s27, s75
    s_mul_i32 s50, s2, 16640
    s_add_u32 s50, s50, 35651896
    s_lshl_b32 s51, s2, 13
    s_add_u32 s51, s51, 2359296
    s_add_u32 s70, s51, 4980736
    s_lshl_b32 s74, s54, 3
    s_add_u32 s74, s74, s55
    s_lshl_b32 s74, s74, 2
    s_add_u32 s74, s74, s3
    s_lshl_b32 s74, s74, 7
    s_add_u32 s71, s74, 9961472
    s_waitcnt vmcnt(12)
    s_cmp_lg_u32 s2, 253
    s_cbranch_scc1 parallel_sum__ssm_conv_s4d__dense_activation_silu__prompt_kernel_nononce
    s_and_b32 s73, s73, 0xffff
    s_movk_i32 s74, 256
    s_mov_b32 s75, 0x20000
    v_add_u32 v74, 32, v74
    v_max_u32 v74, 1, v74
    v_lshlrev_b32 v2, 8, v0
    buffer_store_dword v74, v2, s[72:75], 0 offen sc1
parallel_sum__ssm_conv_s4d__dense_activation_silu__prompt_kernel_nononce:
    global_load_dwordx4 v[80:83], v[4:5], off offset:0
    v_add_co_u32 v4, vcc, 0x2000, v4
    s_nop 1
    v_addc_co_u32 v5, vcc, 0, v5, vcc
    global_load_dwordx4 v[84:87], v[4:5], off offset:-4096
    global_load_dwordx4 v[88:91], v[4:5], off offset:0
    v_add_co_u32 v4, vcc, 0x2000, v4
    s_nop 1
    v_addc_co_u32 v5, vcc, 0, v5, vcc
    global_load_dwordx4 v[92:95], v[4:5], off offset:-4096
    s_cmp_eq_u32 s53, 0
    s_cbranch_scc1 parallel_sum__ssm_conv_s4d__dense_activation_silu__prompt_kernel_k2
parallel_sum__ssm_conv_s4d__dense_activation_silu__prompt_kernel_k2done:
    s_mov_b32 s74, 0x3fb8aa3b
    s_mov_b32 s75, 0x32a5705f
    s_mov_b32 s76, 0x3f317218
    v_lshlrev_b32 v16, 16, v68
    v_lshlrev_b32 v17, 16, v69
    v_lshlrev_b32 v18, 16, v70
    v_lshlrev_b32 v19, 16, v71
    v_lshlrev_b32 v20, 16, v72
    v_lshlrev_b32 v21, 16, v73
    v_mul_f32 v22, s74, v20
    v_fma_f32 v24, v20, s74, -v22
    v_fma_f32 v24, v20, s75, v24
    v_exp_f32 v22, v22
    v_mul_f32 v24, s76, v24
    v_fma_f32 v22, v22, v24, v22
    v_mul_f32 v23, s74, v16
    v_fma_f32 v25, v16, s74, -v23
    v_fma_f32 v25, v16, s75, v25
    v_exp_f32 v23, v23
    v_mul_f32 v25, s76, v25
    v_fma_f32 v23, v23, v25, v23
    global_load_dwordx4 v[216:219], v[4:5], off offset:0
    v_cvt_pk_bf16_f32 v22, v22, v22
    v_and_b32 v22, 0xffff0000, v22
    v_cvt_pk_bf16_f32 v23, v23, v23
    v_and_b32 v23, 0xffff0000, v23
    v_mul_f32 v23, v23, v22
    v_mul_f32 v17, v17, v22
    v_mul_f32 v18, v18, v22
    v_mul_f32 v19, v19, v22
    v_mul_f32 v23, 0xbfb8aa3b, v23
    v_mul_f32 v17, 0.15915494, v17
    v_mul_f32 v18, 0x3fb17218, v18
    v_mul_f32 v19, 0x3fb17218, v19
    v_mul_f32 v21, s76, v21
    v_mul_f32 v24, 1.0, v23
    v_mul_f32 v25, 1.0, v17
    v_exp_f32 v24, v24
    v_fract_f32 v25, v25
    v_cos_f32 v28, v25
    v_sin_f32 v29, v25
    s_nop 0
    v_pk_mul_f32 v[28:29], v[28:29], v[24:25] op_sel_hi:[1,0]
    s_add_u32 s58, s58, 9216
    buffer_load_dwordx4 v[136:139], v78, s[16:19], s58 offen
    v_mul_f32 v24, 0x41000000, v23
    v_mul_f32 v25, 0x41000000, v17
    v_exp_f32 v24, v24
    v_fract_f32 v25, v25
    v_cos_f32 v30, v25
    v_sin_f32 v31, v25
    s_nop 0
    v_pk_mul_f32 v[30:31], v[30:31], v[24:25] op_sel_hi:[1,0]
    v_mul_f32 v24, 0x43800000, v23
    v_mul_f32 v25, 0x43800000, v17
    v_exp_f32 v24, v24
    v_fract_f32 v25, v25
    v_cos_f32 v32, v25
    v_sin_f32 v33, v25
    s_nop 0
    v_pk_mul_f32 v[32:33], v[32:33], v[24:25] op_sel_hi:[1,0]
    s_add_u32 s59, s59, 9216
    buffer_load_dwordx4 v[140:143], v78, s[16:19], s59 offen
    v_pk_mul_f32 v[24:25], v[30:31], v[30:31] op_sel:[1,1] op_sel_hi:[1,0] neg_lo:[1,0]
    v_pk_fma_f32 v[34:35], v[30:31], v[30:31], v[24:25] op_sel_hi:[0,1,1]
    v_mov_b32 v36, 1.0
    v_mov_b32 v37, 0
    s_waitcnt vmcnt(15)
    v_cvt_pk_bf16_f32 v50, v36, v37
    v_cvt_pk_bf16_f32 v51, v30, v31
    v_cvt_pk_bf16_f32 v52, v34, v35
    v_pk_mul_f32 v[24:25], v[30:31], v[34:35] op_sel:[1,1] op_sel_hi:[1,0] neg_lo:[1,0]
    v_pk_fma_f32 v[40:41], v[30:31], v[34:35], v[24:25] op_sel_hi:[0,1,1]
    v_cvt_pk_bf16_f32 v53, v40, v41
    ds_write2_b32 v56, v50, v51 offset0:128 offset1:132
    ds_write2_b32 v56, v52, v53 offset0:136 offset1:140
    v_pk_mul_f32 v[24:25], v[34:35], v[34:35] op_sel:[1,1] op_sel_hi:[1,0] neg_lo:[1,0]
    v_pk_fma_f32 v[36:37], v[34:35], v[34:35], v[24:25] op_sel_hi:[0,1,1]
    v_cvt_pk_bf16_f32 v50, v36, v37
    v_pk_mul_f32 v[24:25], v[40:41], v[34:35] op_sel:[1,1] op_sel_hi:[1,0] neg_lo:[1,0]
    v_pk_fma_f32 v[40:41], v[40:41], v[34:35], v[24:25] op_sel_hi:[0,1,1]
    v_cvt_pk_bf16_f32 v51, v40, v41
    v_pk_mul_f32 v[24:25], v[36:37], v[34:35] op_sel:[1,1] op_sel_hi:[1,0] neg_lo:[1,0]
    v_pk_fma_f32 v[36:37], v[36:37], v[34:35], v[24:25] op_sel_hi:[0,1,1]
    v_cvt_pk_bf16_f32 v52, v36, v37
    v_pk_mul_f32 v[24:25], v[40:41], v[34:35] op_sel:[1,1] op_sel_hi:[1,0] neg_lo:[1,0]
    v_pk_fma_f32 v[40:41], v[40:41], v[34:35], v[24:25] op_sel_hi:[0,1,1]
    v_cvt_pk_bf16_f32 v53, v40, v41
    ds_write2_b32 v56, v50, v51 offset0:144 offset1:148
    ds_write2_b32 v56, v52, v53 offset0:152 offset1:156
    s_add_u32 s60, s60, 9216
    buffer_load_dwordx4 v[144:147], v78, s[16:19], s60 offen
    v_pk_mul_f32 v[24:25], v[36:37], v[34:35] op_sel:[1,1] op_sel_hi:[1,0] neg_lo:[1,0]
    v_pk_fma_f32 v[36:37], v[36:37], v[34:35], v[24:25] op_sel_hi:[0,1,1]
    v_cvt_pk_bf16_f32 v50, v36, v37
    v_pk_mul_f32 v[24:25], v[40:41], v[34:35] op_sel:[1,1] op_sel_hi:[1,0] neg_lo:[1,0]
    v_pk_fma_f32 v[40:41], v[40:41], v[34:35], v[24:25] op_sel_hi:[0,1,1]
    v_cvt_pk_bf16_f32 v51, v40, v41
    v_pk_mul_f32 v[24:25], v[36:37], v[34:35] op_sel:[1,1] op_sel_hi:[1,0] neg_lo:[1,0]
    v_pk_fma_f32 v[36:37], v[36:37], v[34:35], v[24:25] op_sel_hi:[0,1,1]
    v_cvt_pk_bf16_f32 v52, v36, v37
    v_pk_mul_f32 v[24:25], v[40:41], v[34:35] op_sel:[1,1] op_sel_hi:[1,0] neg_lo:[1,0]
    v_pk_fma_f32 v[40:41], v[40:41], v[34:35], v[24:25] op_sel_hi:[0,1,1]
    v_cvt_pk_bf16_f32 v53, v40, v41
    ds_write2_b32 v56, v50, v51 offset0:160 offset1:164
    ds_write2_b32 v56, v52, v53 offset0:168 offset1:172
    v_pk_mul_f32 v[24:25], v[36:37], v[34:35] op_sel:[1,1] op_sel_hi:[1,0] neg_lo:[1,0]
    v_pk_fma_f32 v[36:37], v[36:37], v[34:35], v[24:25] op_sel_hi:[0,1,1]
    v_cvt_pk_bf16_f32 v50, v36, v37
    v_pk_mul_f32 v[24:25], v[40:41], v[34:35] op_sel:[1,1] op_sel_hi:[1,0] neg_lo:[1,0]
    v_pk_fma_f32 v[40:41], v[40:41], v[34:35], v[24:25] op_sel_hi:[0,1,1]
    v_cvt_pk_bf16_f32 v51, v40, v41
    v_pk_mul_f32 v[24:25], v[36:37], v[34:35] op_sel:[1,1] op_sel_hi:[1,0] neg_lo:[1,0]
    v_pk_fma_f32 v[36:37], v[36:37], v[34:35], v[24:25] op_sel_hi:[0,1,1]
    v_cvt_pk_bf16_f32 v52, v36, v37
    v_pk_mul_f32 v[24:25], v[40:41], v[34:35] op_sel:[1,1] op_sel_hi:[1,0] neg_lo:[1,0]
    v_pk_fma_f32 v[40:41], v[40:41], v[34:35], v[24:25] op_sel_hi:[0,1,1]
    v_cvt_pk_bf16_f32 v53, v40, v41
    ds_write2_b32 v56, v50, v51 offset0:176 offset1:180
    ds_write2_b32 v56, v52, v53 offset0:184 offset1:188
    s_add_u32 s61, s61, 9216
    buffer_load_dwordx4 v[148:151], v78, s[16:19], s61 offen
    v_pk_mul_f32 v[24:25], v[36:37], v[34:35] op_sel:[1,1] op_sel_hi:[1,0] neg_lo:[1,0]
    v_pk_fma_f32 v[36:37], v[36:37], v[34:35], v[24:25] op_sel_hi:[0,1,1]
    v_cvt_pk_bf16_f32 v50, v36, v37
    v_pk_mul_f32 v[24:25], v[40:41], v[34:35] op_sel:[1,1] op_sel_hi:[1,0] neg_lo:[1,0]
    v_pk_fma_f32 v[40:41], v[40:41], v[34:35], v[24:25] op_sel_hi:[0,1,1]
    v_cvt_pk_bf16_f32 v51, v40, v41
    v_pk_mul_f32 v[24:25], v[36:37], v[34:35] op_sel:[1,1] op_sel_hi:[1,0] neg_lo:[1,0]
    v_pk_fma_f32 v[36:37], v[36:37], v[34:35], v[24:25] op_sel_hi:[0,1,1]
    v_cvt_pk_bf16_f32 v52, v36, v37
    v_pk_mul_f32 v[24:25], v[40:41], v[34:35] op_sel:[1,1] op_sel_hi:[1,0] neg_lo:[1,0]
    v_pk_fma_f32 v[40:41], v[40:41], v[34:35], v[24:25] op_sel_hi:[0,1,1]
    v_cvt_pk_bf16_f32 v53, v40, v41
    ds_write2_b32 v56, v50, v51 offset0:192 offset1:196
    ds_write2_b32 v56, v52, v53 offset0:200 offset1:204
    v_pk_mul_f32 v[24:25], v[36:37], v[34:35] op_sel:[1,1] op_sel_hi:[1,0] neg_lo:[1,0]
    v_pk_fma_f32 v[36:37], v[36:37], v[34:35], v[24:25] op_sel_hi:[0,1,1]
    v_cvt_pk_bf16_f32 v50, v36, v37
    v_pk_mul_f32 v[24:25], v[40:41], v[34:35] op_sel:[1,1] op_sel_hi:[1,0] neg_lo:[1,0]
    v_pk_fma_f32 v[40:41], v[40:41], v[34:35], v[24:25] op_sel_hi:[0,1,1]
    v_cvt_pk_bf16_f32 v51, v40, v41
    v_pk_mul_f32 v[24:25], v[36:37], v[34:35] op_sel:[1,1] op_sel_hi:[1,0] neg_lo:[1,0]
    v_pk_fma_f32 v[36:37], v[36:37], v[34:35], v[24:25] op_sel_hi:[0,1,1]
    v_cvt_pk_bf16_f32 v52, v36, v37
    v_pk_mul_f32 v[24:25], v[40:41], v[34:35] op_sel:[1,1] op_sel_hi:[1,0] neg_lo:[1,0]
    v_pk_fma_f32 v[40:41], v[40:41], v[34:35], v[24:25] op_sel_hi:[0,1,1]
    v_cvt_pk_bf16_f32 v53, v40, v41
    ds_write2_b32 v56, v50, v51 offset0:208 offset1:212
    ds_write2_b32 v56, v52, v53 offset0:216 offset1:220
    s_add_u32 s62, s62, 9216
    buffer_load_dwordx4 v[152:155], v78, s[16:19], s62 offen
    v_pk_mul_f32 v[24:25], v[36:37], v[34:35] op_sel:[1,1] op_sel_hi:[1,0] neg_lo:[1,0]
    v_pk_fma_f32 v[36:37], v[36:37], v[34:35], v[24:25] op_sel_hi:[0,1,1]
    v_cvt_pk_bf16_f32 v50, v36, v37
    v_pk_mul_f32 v[24:25], v[40:41], v[34:35] op_sel:[1,1] op_sel_hi:[1,0] neg_lo:[1,0]
    v_pk_fma_f32 v[40:41], v[40:41], v[34:35], v[24:25] op_sel_hi:[0,1,1]
    v_cvt_pk_bf16_f32 v51, v40, v41
    v_pk_mul_f32 v[24:25], v[36:37], v[34:35] op_sel:[1,1] op_sel_hi:[1,0] neg_lo:[1,0]
    v_pk_fma_f32 v[36:37], v[36:37], v[34:35], v[24:25] op_sel_hi:[0,1,1]
    v_cvt_pk_bf16_f32 v52, v36, v37
    v_pk_mul_f32 v[24:25], v[40:41], v[34:35] op_sel:[1,1] op_sel_hi:[1,0] neg_lo:[1,0]
    v_pk_fma_f32 v[40:41], v[40:41], v[34:35], v[24:25] op_sel_hi:[0,1,1]
    v_cvt_pk_bf16_f32 v53, v40, v41
    ds_write2_b32 v56, v50, v51 offset0:224 offset1:228
    ds_write2_b32 v56, v52, v53 offset0:232 offset1:236
    v_pk_mul_f32 v[24:25], v[36:37], v[34:35] op_sel:[1,1] op_sel_hi:[1,0] neg_lo:[1,0]
    v_pk_fma_f32 v[36:37], v[36:37], v[34:35], v[24:25] op_sel_hi:[0,1,1]
    v_cvt_pk_bf16_f32 v50, v36, v37
    v_pk_mul_f32 v[24:25], v[40:41], v[34:35] op_sel:[1,1] op_sel_hi:[1,0] neg_lo:[1,0]
    v_pk_fma_f32 v[40:41], v[40:41], v[34:35], v[24:25] op_sel_hi:[0,1,1]
    v_cvt_pk_bf16_f32 v51, v40, v41
    v_pk_mul_f32 v[24:25], v[36:37], v[34:35] op_sel:[1,1] op_sel_hi:[1,0] neg_lo:[1,0]
    v_pk_fma_f32 v[36:37], v[36:37], v[34:35], v[24:25] op_sel_hi:[0,1,1]
    v_cvt_pk_bf16_f32 v52, v36, v37
    v_pk_mul_f32 v[24:25], v[40:41], v[34:35] op_sel:[1,1] op_sel_hi:[1,0] neg_lo:[1,0]
    v_pk_fma_f32 v[40:41], v[40:41], v[34:35], v[24:25] op_sel_hi:[0,1,1]
    v_cvt_pk_bf16_f32 v53, v40, v41
    ds_write2_b32 v56, v50, v51 offset0:240 offset1:244
    s_waitcnt lgkmcnt(9)
    ds_write2_b32 v56, v52, v53 offset0:248 offset1:252
    s_add_u32 s63, s63, 9216
    buffer_load_dwordx4 v[156:159], v78, s[16:19], s63 offen
    v_cvt_pk_bf16_f32 v50, v18, -v19
    v_pk_mul_f32 v[24:25], v[18:19], v[28:29] op_sel:[1,1] op_sel_hi:[1,0] neg_lo:[1,0]
    v_pk_fma_f32 v[36:37], v[18:19], v[28:29], v[24:25] op_sel_hi:[0,1,1]
    v_cvt_pk_bf16_f32 v51, v36, -v37
    v_pk_mul_f32 v[24:25], v[36:37], v[28:29] op_sel:[1,1] op_sel_hi:[1,0] neg_lo:[1,0]
    v_pk_fma_f32 v[44:45], v[36:37], v[28:29], v[24:25] op_sel_hi:[0,1,1]
    v_cvt_pk_bf16_f32 v52, v44, -v45
    v_pk_mul_f32 v[24:25], v[44:45], v[28:29] op_sel:[1,1] op_sel_hi:[1,0] neg_lo:[1,0]
    v_pk_fma_f32 v[36:37], v[44:45], v[28:29], v[24:25] op_sel_hi:[0,1,1]
    v_cvt_pk_bf16_f32 v53, v36, -v37
    ds_write2_b32 v56, v50, v51 offset0:0 offset1:4
    ds_write2_b32 v56, v52, v53 offset0:8 offset1:12
    v_pk_mul_f32 v[24:25], v[36:37], v[28:29] op_sel:[1,1] op_sel_hi:[1,0] neg_lo:[1,0]
    v_pk_fma_f32 v[46:47], v[36:37], v[28:29], v[24:25] op_sel_hi:[0,1,1]
    v_cvt_pk_bf16_f32 v50, v46, -v47
    v_pk_mul_f32 v[24:25], v[46:47], v[28:29] op_sel:[1,1] op_sel_hi:[1,0] neg_lo:[1,0]
    v_pk_fma_f32 v[36:37], v[46:47], v[28:29], v[24:25] op_sel_hi:[0,1,1]
    v_cvt_pk_bf16_f32 v51, v36, -v37
    v_pk_mul_f32 v[24:25], v[36:37], v[28:29] op_sel:[1,1] op_sel_hi:[1,0] neg_lo:[1,0]
    v_pk_fma_f32 v[48:49], v[36:37], v[28:29], v[24:25] op_sel_hi:[0,1,1]
    v_cvt_pk_bf16_f32 v52, v48, -v49
    v_pk_mul_f32 v[24:25], v[48:49], v[28:29] op_sel:[1,1] op_sel_hi:[1,0] neg_lo:[1,0]
    v_pk_fma_f32 v[36:37], v[48:49], v[28:29], v[24:25] op_sel_hi:[0,1,1]
    v_cvt_pk_bf16_f32 v53, v36, -v37
    ds_write2_b32 v56, v50, v51 offset0:16 offset1:20
    ds_write2_b32 v56, v52, v53 offset0:24 offset1:28
    s_add_u32 s64, s64, 9216
    buffer_load_dwordx4 v[160:163], v78, s[16:19], s64 offen
    v_pk_mul_f32 v[24:25], v[18:19], v[32:33] op_sel:[1,1] op_sel_hi:[1,0] neg_lo:[1,0]
    v_pk_fma_f32 v[36:37], v[18:19], v[32:33], v[24:25] op_sel_hi:[0,1,1]
    v_cvt_pk_bf16_f32 v50, v36, -v37
    v_pk_mul_f32 v[24:25], v[44:45], v[32:33] op_sel:[1,1] op_sel_hi:[1,0] neg_lo:[1,0]
    v_pk_fma_f32 v[40:41], v[44:45], v[32:33], v[24:25] op_sel_hi:[0,1,1]
    v_cvt_pk_bf16_f32 v51, v40, -v41
    v_pk_mul_f32 v[24:25], v[36:37], v[32:33] op_sel:[1,1] op_sel_hi:[1,0] neg_lo:[1,0]
    v_pk_fma_f32 v[36:37], v[36:37], v[32:33], v[24:25] op_sel_hi:[0,1,1]
    v_cvt_pk_bf16_f32 v52, v36, -v37
    v_pk_mul_f32 v[24:25], v[46:47], v[32:33] op_sel:[1,1] op_sel_hi:[1,0] neg_lo:[1,0]
    v_pk_fma_f32 v[42:43], v[46:47], v[32:33], v[24:25] op_sel_hi:[0,1,1]
    v_cvt_pk_bf16_f32 v53, v42, -v43
    ds_write2_b32 v56, v50, v51 offset0:32 offset1:36
    s_waitcnt lgkmcnt(9)
    ds_write2_b32 v56, v52, v53 offset0:48 offset1:40
    v_pk_mul_f32 v[24:25], v[36:37], v[32:33] op_sel:[1,1] op_sel_hi:[1,0] neg_lo:[1,0]
    v_pk_fma_f32 v[36:37], v[36:37], v[32:33], v[24:25] op_sel_hi:[0,1,1]
    v_cvt_pk_bf16_f32 v50, v36, -v37
    v_pk_mul_f32 v[24:25], v[48:49], v[32:33] op_sel:[1,1] op_sel_hi:[1,0] neg_lo:[1,0]
    v_pk_fma_f32 v[40:41], v[48:49], v[32:33], v[24:25] op_sel_hi:[0,1,1]
    v_cvt_pk_bf16_f32 v51, v40, -v41
    v_pk_mul_f32 v[24:25], v[36:37], v[32:33] op_sel:[1,1] op_sel_hi:[1,0] neg_lo:[1,0]
    v_pk_fma_f32 v[36:37], v[36:37], v[32:33], v[24:25] op_sel_hi:[0,1,1]
    v_cvt_pk_bf16_f32 v52, v36, -v37
    v_pk_mul_f32 v[24:25], v[42:43], v[32:33] op_sel:[1,1] op_sel_hi:[1,0] neg_lo:[1,0]
    v_pk_fma_f32 v[42:43], v[42:43], v[32:33], v[24:25] op_sel_hi:[0,1,1]
    v_cvt_pk_bf16_f32 v53, v42, -v43
    ds_write2_b32 v56, v50, v51 offset0:56 offset1:44
    ds_write2_b32 v56, v52, v53 offset0:64 offset1:52
    s_add_u32 s65, s65, 9216
    buffer_load_dwordx4 v[164:167], v78, s[16:19], s65 offen
    v_pk_mul_f32 v[24:25], v[36:37], v[32:33] op_sel:[1,1] op_sel_hi:[1,0] neg_lo:[1,0]
    v_pk_fma_f32 v[36:37], v[36:37], v[32:33], v[24:25] op_sel_hi:[0,1,1]
    v_cvt_pk_bf16_f32 v50, v36, -v37
    v_pk_mul_f32 v[24:25], v[42:43], v[32:33] op_sel:[1,1] op_sel_hi:[1,0] neg_lo:[1,0]
    v_pk_fma_f32 v[42:43], v[42:43], v[32:33], v[24:25] op_sel_hi:[0,1,1]
    v_cvt_pk_bf16_f32 v51, v42, -v43
    v_pk_mul_f32 v[24:25], v[36:37], v[32:33] op_sel:[1,1] op_sel_hi:[1,0] neg_lo:[1,0]
    v_pk_fma_f32 v[36:37], v[36:37], v[32:33], v[24:25] op_sel_hi:[0,1,1]
    v_cvt_pk_bf16_f32 v52, v36, -v37
    v_pk_mul_f32 v[24:25], v[36:37], v[32:33] op_sel:[1,1] op_sel_hi:[1,0] neg_lo:[1,0]
    v_pk_fma_f32 v[36:37], v[36:37], v[32:33], v[24:25] op_sel_hi:[0,1,1]
    v_cvt_pk_bf16_f32 v53, v36, -v37
    ds_write2_b32 v56, v50, v51 offset0:68 offset1:60
    ds_write2_b32 v56, v52, v53 offset0:72 offset1:76
    v_pk_mul_f32 v[24:25], v[36:37], v[32:33] op_sel:[1,1] op_sel_hi:[1,0] neg_lo:[1,0]
    v_pk_fma_f32 v[36:37], v[36:37], v[32:33], v[24:25] op_sel_hi:[0,1,1]
    v_cvt_pk_bf16_f32 v50, v36, -v37
    ds_write_b32 v56, v50 offset:320
    s_add_u32 s66, s66, 9216
    buffer_load_dwordx4 v[168:171], v78, s[16:19], s66 offen
    s_waitcnt lgkmcnt(0)
    s_barrier
    ds_read_b128 a[0:3], v57 offset:0
    ds_read_b128 a[4:7], v57 offset:256
    ds_read_b128 a[8:11], v58 offset:0
    ds_read_b128 a[12:15], v57 offset:4160
    ds_read_b128 a[16:19], v57 offset:4416
    ds_read_b128 a[20:23], v58 offset:4160
    ds_read_b128 a[24:27], v57 offset:8320
    ds_read_b128 a[28:31], v57 offset:8576
    ds_read_b128 a[32:35], v58 offset:8320
    ds_read_b128 a[36:39], v57 offset:12480
    ds_read_b128 a[40:43], v57 offset:12736
    ds_read_b128 a[44:47], v58 offset:12480
    s_waitcnt vmcnt(9)
    s_mov_b32 s16, s72
    s_and_b32 s17, s73, 0xffff
    s_mov_b32 s18, 256
    s_mov_b32 s19, 0x20000
    v_add_u32 v97, 36864, v81
    v_add_u32 v98, 36864, v82
    v_xor_b32 v220, 64, v83
    v_add_u32 v221, 40960, v83
    v_add_u32 v222, 40960, v220
    v_add_u32 v251, 57344, v92
    v_mov_b32 v77, 0
    s_mov_b32 s74, 0x3f803f80
    s_mov_b32 s75, 0x00003f80
    s_mov_b32 s76, 0x3f800000
    v_mov_b32 v244, 0
    v_mov_b32 v245, 0
    v_dot2c_f32_bf16 v244, s74, v100
    v_dot2c_f32_bf16 v245, s74, v101
    v_dot2c_f32_bf16 v244, s74, v102
    v_dot2c_f32_bf16 v245, s74, v103
    v_dot2c_f32_bf16 v244, s74, v104
    v_dot2c_f32_bf16 v245, s74, v105
    v_dot2c_f32_bf16 v244, s74, v106
    v_dot2c_f32_bf16 v245, s74, v107
    v_dot2c_f32_bf16 v244, s74, v108
    v_dot2c_f32_bf16 v245, s74, v109
    v_dot2c_f32_bf16 v244, s74, v110
    v_dot2c_f32_bf16 v245, s74, v111
    v_dot2c_f32_bf16 v244, s74, v112
    v_dot2c_f32_bf16 v245, s74, v113
    v_dot2c_f32_bf16 v244, s74, v114
    v_dot2c_f32_bf16 v245, s74, v115
    v_dot2c_f32_bf16 v244, s74, v116
    v_dot2c_f32_bf16 v245, s74, v117
    v_dot2c_f32_bf16 v244, s74, v118
    v_dot2c_f32_bf16 v245, s74, v119
    v_dot2c_f32_bf16 v244, s74, v120
    v_dot2c_f32_bf16 v245, s74, v121
    v_dot2c_f32_bf16 v244, s74, v122
    v_dot2c_f32_bf16 v245, s74, v123
    v_dot2c_f32_bf16 v244, s74, v124
    v_dot2c_f32_bf16 v245, s74, v125
    v_dot2c_f32_bf16 v244, s74, v126
    v_dot2c_f32_bf16 v245, s74, v127
    v_dot2c_f32_bf16 v244, s74, v128
    v_dot2c_f32_bf16 v245, s74, v129
    v_dot2c_f32_bf16 v244, s74, v130
    v_dot2c_f32_bf16 v245, s74, v131
    v_dot2c_f32_bf16 v244, s74, v132
    v_dot2c_f32_bf16 v245, s74, v133
    v_dot2c_f32_bf16 v244, s74, v134
    v_dot2c_f32_bf16 v245, s74, v135
    s_nop 2
    v_add_f32 v244, v244, v245
    s_nop 1
    v_add_f32_dpp v244, v244, v244 quad_perm:[1,0,3,2] row_mask:0xf bank_mask:0xf
    s_nop 1
    v_add_f32_dpp v244, v244, v244 quad_perm:[2,3,0,1] row_mask:0xf bank_mask:0xf
    s_nop 1
    v_add_f32_dpp v244, v244, v244 row_half_mirror row_mask:0xf bank_mask:0xf
    v_mul_f32 v244, 0x3ae38e39, v244
    v_mov_b32 v245, v244
    v_cvt_pk_bf16_f32 v245, v245, v245
    v_and_b32 v245, 0xffff0000, v245
    v_sub_f32 v244, v244, v245
    v_xor_b32 v245, 0x80000000, v245
    s_waitcnt lgkmcnt(9)
    v_mfma_f32_16x16x32_bf16 v[28:31], a[0:3], a[8:11], 0
    v_mfma_f32_16x16x32_bf16 v[32:35], a[4:7], a[8:11], 0
    ds_read_b128 a[48:51], v57 offset:16640
    ds_read_b128 a[52:55], v57 offset:16896
    ds_read_b128 a[56:59], v58 offset:16640
    s_waitcnt lgkmcnt(9)
    v_mfma_f32_16x16x32_bf16 v[28:31], a[12:15], a[20:23], v[28:31]
    v_mfma_f32_16x16x32_bf16 v[32:35], a[16:19], a[20:23], v[32:35]
    ds_read_b128 a[60:63], v57 offset:20800
    ds_read_b128 a[64:67], v57 offset:21056
    ds_read_b128 a[68:71], v58 offset:20800
    s_waitcnt lgkmcnt(9)
    v_mfma_f32_16x16x32_bf16 v[28:31], a[24:27], a[32:35], v[28:31]
    v_mfma_f32_16x16x32_bf16 v[32:35], a[28:31], a[32:35], v[32:35]
    ds_read_b128 a[72:75], v57 offset:24960
    ds_read_b128 a[76:79], v57 offset:25216
    ds_read_b128 a[80:83], v58 offset:24960
    s_waitcnt lgkmcnt(9)
    v_mfma_f32_16x16x32_bf16 v[28:31], a[36:39], a[44:47], v[28:31]
    v_mfma_f32_16x16x32_bf16 v[32:35], a[40:43], a[44:47], v[32:35]
    ds_read_b128 a[84:87], v57 offset:29120
    ds_read_b128 a[88:91], v57 offset:29376
    ds_read_b128 a[92:95], v58 offset:29120
    v_dot2_f32_bf16 v172, v100, s75, v245
    v_dot2_f32_bf16 v173, v100, s76, v245
    v_add_u32 v96, 294912, v80
    s_add_u32 m0, s20, 90112
    s_add_u32 s21, s32, s22
    buffer_load_dwordx4 v80, s[4:7], s21 offen lds
    v_dot2_f32_bf16 v174, v101, s75, v245
    v_dot2_f32_bf16 v175, v101, s76, v245
    v_dot2_f32_bf16 v176, v102, s75, v245
    v_dot2_f32_bf16 v177, v102, s76, v245
    v_dot2_f32_bf16 v178, v103, s75, v245
    v_dot2_f32_bf16 v179, v103, s76, v245
    v_dot2_f32_bf16 v180, v104, s75, v245
    v_dot2_f32_bf16 v181, v104, s76, v245
    v_dot2_f32_bf16 v182, v105, s75, v245
    v_dot2_f32_bf16 v183, v105, s76, v245
    v_dot2_f32_bf16 v184, v106, s75, v245
    v_dot2_f32_bf16 v185, v106, s76, v245
    v_dot2_f32_bf16 v186, v107, s75, v245
    v_dot2_f32_bf16 v187, v107, s76, v245
    v_dot2_f32_bf16 v188, v108, s75, v245
    v_dot2_f32_bf16 v189, v108, s76, v245
    v_dot2_f32_bf16 v190, v109, s75, v245
    v_dot2_f32_bf16 v191, v109, s76, v245
    v_dot2_f32_bf16 v192, v110, s75, v245
    v_dot2_f32_bf16 v193, v110, s76, v245
    v_dot2_f32_bf16 v194, v111, s75, v245
    v_dot2_f32_bf16 v195, v111, s76, v245
    v_dot2_f32_bf16 v196, v112, s75, v245
    v_dot2_f32_bf16 v197, v112, s76, v245
    v_dot2_f32_bf16 v198, v113, s75, v245
    v_dot2_f32_bf16 v199, v113, s76, v245
    v_dot2_f32_bf16 v200, v114, s75, v245
    v_dot2_f32_bf16 v201, v114, s76, v245
    v_dot2_f32_bf16 v202, v115, s75, v245
    v_dot2_f32_bf16 v203, v115, s76, v245
    v_dot2_f32_bf16 v204, v116, s75, v245
    v_dot2_f32_bf16 v205, v116, s76, v245
    v_dot2_f32_bf16 v206, v117, s75, v245
    v_dot2_f32_bf16 v207, v117, s76, v245
    s_waitcnt lgkmcnt(9)
    v_mfma_f32_16x16x32_bf16 v[28:31], a[48:51], a[56:59], v[28:31]
    v_mfma_f32_16x16x32_bf16 v[32:35], a[52:55], a[56:59], v[32:35]
    s_waitcnt lgkmcnt(6)
    v_mfma_f32_16x16x32_bf16 v[28:31], a[60:63], a[68:71], v[28:31]
    v_mfma_f32_16x16x32_bf16 v[32:35], a[64:67], a[68:71], v[32:35]
    s_waitcnt lgkmcnt(3)
    v_mfma_f32_16x16x32_bf16 v[28:31], a[72:75], a[80:83], v[28:31]
    v_mfma_f32_16x16x32_bf16 v[32:35], a[76:79], a[80:83], v[32:35]
    s_waitcnt lgkmcnt(0)
    v_mfma_f32_16x16x32_bf16 v[28:31], a[84:87], a[92:95], v[28:31]
    v_mfma_f32_16x16x32_bf16 v[32:35], a[88:91], a[92:95], v[32:35]
    s_add_u32 m0, s20, 94208
    s_nop 0
    buffer_load_dwordx4 v96, s[4:7], s21 offen lds
    v_dot2_f32_bf16 v208, v118, s75, v245
    v_dot2_f32_bf16 v209, v118, s76, v245
    v_dot2_f32_bf16 v210, v119, s75, v245
    v_dot2_f32_bf16 v211, v119, s76, v245
    v_dot2_f32_bf16 v212, v120, s75, v245
    v_dot2_f32_bf16 v213, v120, s76, v245
    v_dot2_f32_bf16 v214, v121, s75, v245
    v_dot2_f32_bf16 v215, v121, s76, v245
    v_dot2_f32_bf16 v224, v122, s75, v245
    v_dot2_f32_bf16 v225, v122, s76, v245
    v_dot2_f32_bf16 v226, v123, s75, v245
    v_dot2_f32_bf16 v227, v123, s76, v245
    v_dot2_f32_bf16 v228, v124, s75, v245
    v_dot2_f32_bf16 v229, v124, s76, v245
    v_dot2_f32_bf16 v230, v125, s75, v245
    v_dot2_f32_bf16 v231, v125, s76, v245
    v_dot2_f32_bf16 v232, v126, s75, v245
    v_dot2_f32_bf16 v233, v126, s76, v245
    v_dot2_f32_bf16 v234, v127, s75, v245
    v_dot2_f32_bf16 v235, v127, s76, v245
    v_dot2_f32_bf16 v236, v128, s75, v245
    v_dot2_f32_bf16 v237, v128, s76, v245
    v_dot2_f32_bf16 v238, v129, s75, v245
    v_dot2_f32_bf16 v239, v129, s76, v245
    v_dot2_f32_bf16 v240, v130, s75, v245
    v_dot2_f32_bf16 v241, v130, s76, v245
    v_dot2_f32_bf16 v242, v131, s75, v245
    v_dot2_f32_bf16 v243, v131, s76, v245
    v_dot2_f32_bf16 v252, v132, s75, v245
    v_dot2_f32_bf16 v253, v132, s76, v245
    v_dot2_f32_bf16 v254, v133, s75, v245
    v_dot2_f32_bf16 v255, v133, s76, v245
    v_dot2_f32_bf16 v8, v134, s75, v245
    v_dot2_f32_bf16 v9, v134, s76, v245
    v_dot2_f32_bf16 v10, v135, s75, v245
    v_dot2_f32_bf16 v11, v135, s76, v245
    s_add_u32 m0, s20, 98304
    s_add_u32 s21, s33, s22
    buffer_load_dwordx4 v80, s[4:7], s21 offen lds
    s_add_u32 s77, s67, 0
    s_and_b32 s31, s3, 1
    s_lshl_b32 s31, s31, 10
    s_add_u32 s31, s31, s77
    v_and_b32 v21, v21, v63
    s_mov_b32 s72, 0x01000100
    s_mov_b32 s73, 0x03020302
    s_nop 0
    v_add_f32 v28, v28, v21
    v_cvt_pk_bf16_f32 v28, v28, v29
    v_cvt_pk_bf16_f32 v29, v30, v31
    v_cvt_pk_bf16_f32 v32, v32, v33
    v_cvt_pk_bf16_f32 v33, v34, v35
    ds_write_b32 v59, v28
    ds_write_b32 v60, v29
    ds_write_b16 v61, v32
    ds_write_b16_d16_hi v61, v32 offset:64
    ds_write_b16 v61, v33 offset:128
    ds_write_b16_d16_hi v61, v33 offset:192
    v_pk_mul_f32 v[246:247], v[172:173], v[172:173]
    v_pk_fma_f32 v[246:247], v[174:175], v[174:175], v[246:247]
    v_pk_fma_f32 v[246:247], v[176:177], v[176:177], v[246:247]
    v_pk_fma_f32 v[246:247], v[178:179], v[178:179], v[246:247]
    v_pk_fma_f32 v[246:247], v[180:181], v[180:181], v[246:247]
    v_pk_fma_f32 v[246:247], v[182:183], v[182:183], v[246:247]
    v_pk_fma_f32 v[246:247], v[184:185], v[184:185], v[246:247]
    v_pk_fma_f32 v[246:247], v[186:187], v[186:187], v[246:247]
    v_pk_fma_f32 v[246:247], v[188:189], v[188:189], v[246:247]
    v_pk_fma_f32 v[246:247], v[190:191], v[190:191], v[246:247]
    v_pk_fma_f32 v[246:247], v[192:193], v[192:193], v[246:247]
    v_pk_fma_f32 v[246:247], v[194:195], v[194:195], v[246:247]
    v_pk_fma_f32 v[246:247], v[196:197], v[196:197], v[246:247]
    v_pk_fma_f32 v[246:247], v[198:199], v[198:199], v[246:247]
    v_pk_fma_f32 v[246:247], v[200:201], v[200:201], v[246:247]
    v_pk_fma_f32 v[246:247], v[202:203], v[202:203], v[246:247]
    v_pk_fma_f32 v[246:247], v[204:205], v[204:205], v[246:247]
    s_add_u32 m0, s20, 102400
    s_nop 0
    buffer_load_dwordx4 v96, s[4:7], s21 offen lds
    v_pk_fma_f32 v[246:247], v[206:207], v[206:207], v[246:247]
    v_pk_fma_f32 v[246:247], v[208:209], v[208:209], v[246:247]
    v_pk_fma_f32 v[246:247], v[210:211], v[210:211], v[246:247]
    v_pk_fma_f32 v[246:247], v[212:213], v[212:213], v[246:247]
    v_pk_fma_f32 v[246:247], v[214:215], v[214:215], v[246:247]
    v_pk_fma_f32 v[246:247], v[224:225], v[224:225], v[246:247]
    v_pk_fma_f32 v[246:247], v[226:227], v[226:227], v[246:247]
    v_pk_fma_f32 v[246:247], v[228:229], v[228:229], v[246:247]
    v_pk_fma_f32 v[246:247], v[230:231], v[230:231], v[246:247]
    v_pk_fma_f32 v[246:247], v[232:233], v[232:233], v[246:247]
    v_pk_fma_f32 v[246:247], v[234:235], v[234:235], v[246:247]
    v_pk_fma_f32 v[246:247], v[236:237], v[236:237], v[246:247]
    v_pk_fma_f32 v[246:247], v[238:239], v[238:239], v[246:247]
    v_pk_fma_f32 v[246:247], v[240:241], v[240:241], v[246:247]
    v_pk_fma_f32 v[246:247], v[242:243], v[242:243], v[246:247]
    v_pk_fma_f32 v[246:247], v[252:253], v[252:253], v[246:247]
    v_pk_fma_f32 v[246:247], v[254:255], v[254:255], v[246:247]
    v_pk_fma_f32 v[246:247], v[8:9], v[8:9], v[246:247]
    v_pk_fma_f32 v[246:247], v[10:11], v[10:11], v[246:247]
    v_add_f32 v246, v246, v247
    s_nop 1
    v_add_f32_dpp v246, v246, v246 quad_perm:[1,0,3,2] row_mask:0xf bank_mask:0xf
    s_nop 1
    v_add_f32_dpp v246, v246, v246 quad_perm:[2,3,0,1] row_mask:0xf bank_mask:0xf
    s_nop 1
    v_add_f32_dpp v246, v246, v246 row_half_mirror row_mask:0xf bank_mask:0xf
    v_mul_f32 v244, v244, v244
    v_mov_b32 v247, 0x3ae38e39
    v_fma_f32 v246, v246, v247, -v244
    v_max_f32 v246, 0, v246
    v_cvt_pk_bf16_f32 v246, v246, v246
    v_and_b32 v246, 0xffff0000, v246
    v_add_f32 v246, 0x3727c5ac, v246
    v_cvt_pk_bf16_f32 v246, v246, v246
    v_and_b32 v246, 0xffff0000, v246
    v_sqrt_f32 v246, v246
    s_nop 0
    v_cvt_pk_bf16_f32 v246, v246, v246
    v_and_b32 v246, 0xffff0000, v246
    v_rcp_f32 v248, v246
    s_nop 0
    v_mul_f32 v248, 0x3fb8aa3b, v248
    s_waitcnt lgkmcnt(0)
    s_barrier
    ds_read2_b32 v[28:29], v62 offset0:0 offset1:1
    ds_read2_b32 v[32:33], v64 offset0:0 offset1:1
    ds_read2_b32 v[34:35], v64 offset0:2 offset1:3
    v_add_u32 v30, -4, v64
    ds_read_b32 v30, v30
    v_pk_mul_f32 v[172:173], v[172:173], v[248:249] op_sel_hi:[1,0]
    v_pk_mul_f32 v[174:175], v[174:175], v[248:249] op_sel_hi:[1,0]
    v_pk_mul_f32 v[176:177], v[176:177], v[248:249] op_sel_hi:[1,0]
    v_pk_mul_f32 v[178:179], v[178:179], v[248:249] op_sel_hi:[1,0]
    v_cvt_pk_bf16_f32 v100, v172, v173
    v_cvt_pk_bf16_f32 v101, v174, v175
    v_cvt_pk_bf16_f32 v102, v176, v177
    v_cvt_pk_bf16_f32 v103, v178, v179
    ds_write_b64 v92, v[100:101] offset:0
    ds_write_b64 v92, v[102:103] offset:256
    s_add_u32 m0, s20, 106496
    s_add_u32 s21, s34, s22
    buffer_load_dwordx4 v80, s[4:7], s21 offen lds
    v_pk_mul_f32 v[180:181], v[180:181], v[248:249] op_sel_hi:[1,0]
    v_pk_mul_f32 v[182:183], v[182:183], v[248:249] op_sel_hi:[1,0]
    v_pk_mul_f32 v[184:185], v[184:185], v[248:249] op_sel_hi:[1,0]
    v_pk_mul_f32 v[186:187], v[186:187], v[248:249] op_sel_hi:[1,0]
    v_cvt_pk_bf16_f32 v104, v180, v181
    v_cvt_pk_bf16_f32 v105, v182, v183
    v_cvt_pk_bf16_f32 v106, v184, v185
    v_cvt_pk_bf16_f32 v107, v186, v187
    ds_write_b64 v92, v[104:105] offset:8192
    ds_write_b64 v92, v[106:107] offset:8448
    s_waitcnt lgkmcnt(4)
    s_bitcmp1_b32 s3, 0
    s_cbranch_scc1 parallel_sum__ssm_conv_s4d__dense_activation_silu__prompt_kernel_r1_segc
    v_mov_b32 v52, 0
    v_mov_b32 v53, 0
    v_mov_b32 v54, 0
    v_mov_b32 v55, 0
    v_cmp_gt_u32 vcc, 32, v1
    s_mov_b64 exec, 1
    buffer_store_dwordx4 v[52:55], v99, s[12:15], s77 offen offset:48 sc1
    s_add_u32 s77, s77, 4160
    buffer_store_dwordx4 v[52:55], v99, s[12:15], s77 offen offset:48 sc1
    s_mov_b64 exec, -1
    v_perm_b32 v36, v32, v32, s72
    v_alignbit_b32 v37, v33, v32, 16
    v_perm_b32 v38, v33, v33, s72
    v_alignbit_b32 v39, v34, v33, 16
    v_cndmask_b32 v36, v36, v32, vcc
    v_cndmask_b32 v37, v37, v33, vcc
    v_cndmask_b32 v38, v38, v34, vcc
    v_cndmask_b32 v39, v39, v35, vcc
    v_cmp_lt_u32 vcc, 32, v1
    v_bfi_b32 v30, v63, 0, v30
    s_nop 0
    v_cndmask_b32 v30, v30, v36, vcc
    v_alignbit_b32 v44, v36, v30, 16
    s_branch parallel_sum__ssm_conv_s4d__dense_activation_silu__prompt_kernel_r1_segd
parallel_sum__ssm_conv_s4d__dense_activation_silu__prompt_kernel_r1_segc:
    v_perm_b32 v36, v32, v32, s72
    v_mov_b32 v37, v32
    v_perm_b32 v38, v32, v32, s73
    v_perm_b32 v39, v33, v33, s72
    v_mov_b32 v44, v36
parallel_sum__ssm_conv_s4d__dense_activation_silu__prompt_kernel_r1_segd:
    buffer_store_dwordx4 v[36:39], v99, s[12:15], s31 offen offset:64 sc1
    s_add_u32 s77, s31, 4160
    v_alignbit_b32 v45, v37, v36, 16
    v_alignbit_b32 v46, v38, v37, 16
    v_alignbit_b32 v47, v39, v38, 16
    v_perm_b32 v40, v29, v28, v65
    v_perm_b32 v42, v29, v28, v66
    v_perm_b32 v43, v29, v28, v67
    buffer_store_dwordx4 v[44:47], v99, s[12:15], s77 offen offset:64 sc1
    v_mov_b32 v41, v40
    v_mov_b32 v48, v40
    v_mov_b32 v49, v40
    v_alignbit_b32 v50, v42, v40, 16
    v_alignbit_b32 v51, v43, v42, 16
    buffer_store_dwordx4 v[40:43], v99, s[12:15], s31 offen offset:2112 sc1
    buffer_store_dwordx4 v[48:51], v99, s[12:15], s77 offen offset:2112 sc1
    v_pk_mul_f32 v[188:189], v[188:189], v[248:249] op_sel_hi:[1,0]
    v_pk_mul_f32 v[190:191], v[190:191], v[248:249] op_sel_hi:[1,0]
    v_pk_mul_f32 v[192:193], v[192:193], v[248:249] op_sel_hi:[1,0]
    v_pk_mul_f32 v[194:195], v[194:195], v[248:249] op_sel_hi:[1,0]
    v_cvt_pk_bf16_f32 v108, v188, v189
    v_cvt_pk_bf16_f32 v109, v190, v191
    v_cvt_pk_bf16_f32 v110, v192, v193
    v_cvt_pk_bf16_f32 v111, v194, v195
    ds_write_b64 v92, v[108:109] offset:16384
    ds_write_b64 v92, v[110:111] offset:16640
    s_add_u32 m0, s20, 110592
    s_nop 0
    buffer_load_dwordx4 v96, s[4:7], s21 offen lds
    v_pk_mul_f32 v[196:197], v[196:197], v[248:249] op_sel_hi:[1,0]
    v_pk_mul_f32 v[198:199], v[198:199], v[248:249] op_sel_hi:[1,0]
    v_pk_mul_f32 v[200:201], v[200:201], v[248:249] op_sel_hi:[1,0]
    v_pk_mul_f32 v[202:203], v[202:203], v[248:249] op_sel_hi:[1,0]
    v_cvt_pk_bf16_f32 v112, v196, v197
    v_cvt_pk_bf16_f32 v113, v198, v199
    v_cvt_pk_bf16_f32 v114, v200, v201
    v_cvt_pk_bf16_f32 v115, v202, v203
    ds_write_b64 v92, v[112:113] offset:24576
    ds_write_b64 v92, v[114:115] offset:24832
    v_pk_mul_f32 v[204:205], v[204:205], v[248:249] op_sel_hi:[1,0]
    v_pk_mul_f32 v[206:207], v[206:207], v[248:249] op_sel_hi:[1,0]
    v_pk_mul_f32 v[208:209], v[208:209], v[248:249] op_sel_hi:[1,0]
    v_pk_mul_f32 v[210:211], v[210:211], v[248:249] op_sel_hi:[1,0]
    v_cvt_pk_bf16_f32 v116, v204, v205
    v_cvt_pk_bf16_f32 v117, v206, v207
    v_cvt_pk_bf16_f32 v118, v208, v209
    v_cvt_pk_bf16_f32 v119, v210, v211
    ds_write_b64 v92, v[116:117] offset:32768
    ds_write_b64 v92, v[118:119] offset:33024
    v_pk_mul_f32 v[212:213], v[212:213], v[248:249] op_sel_hi:[1,0]
    v_pk_mul_f32 v[214:215], v[214:215], v[248:249] op_sel_hi:[1,0]
    v_pk_mul_f32 v[224:225], v[224:225], v[248:249] op_sel_hi:[1,0]
    v_pk_mul_f32 v[226:227], v[226:227], v[248:249] op_sel_hi:[1,0]
    v_cvt_pk_bf16_f32 v120, v212, v213
    v_cvt_pk_bf16_f32 v121, v214, v215
    v_cvt_pk_bf16_f32 v122, v224, v225
    v_cvt_pk_bf16_f32 v123, v226, v227
    ds_write_b64 v92, v[120:121] offset:40960
    ds_write_b64 v92, v[122:123] offset:41216
    v_pk_mul_f32 v[228:229], v[228:229], v[248:249] op_sel_hi:[1,0]
    v_pk_mul_f32 v[230:231], v[230:231], v[248:249] op_sel_hi:[1,0]
    v_pk_mul_f32 v[232:233], v[232:233], v[248:249] op_sel_hi:[1,0]
    v_pk_mul_f32 v[234:235], v[234:235], v[248:249] op_sel_hi:[1,0]
    v_cvt_pk_bf16_f32 v124, v228, v229
    v_cvt_pk_bf16_f32 v125, v230, v231
    v_cvt_pk_bf16_f32 v126, v232, v233
    v_cvt_pk_bf16_f32 v127, v234, v235
    ds_write_b64 v92, v[124:125] offset:49152
    ds_write_b64 v92, v[126:127] offset:49408
    s_add_u32 m0, s20, 114688
    s_add_u32 s21, s35, s22
    buffer_load_dwordx4 v80, s[4:7], s21 offen lds
    v_pk_mul_f32 v[236:237], v[236:237], v[248:249] op_sel_hi:[1,0]
    v_pk_mul_f32 v[238:239], v[238:239], v[248:249] op_sel_hi:[1,0]
    v_pk_mul_f32 v[240:241], v[240:241], v[248:249] op_sel_hi:[1,0]
    v_pk_mul_f32 v[242:243], v[242:243], v[248:249] op_sel_hi:[1,0]
    v_cvt_pk_bf16_f32 v128, v236, v237
    v_cvt_pk_bf16_f32 v129, v238, v239
    v_cvt_pk_bf16_f32 v130, v240, v241
    v_cvt_pk_bf16_f32 v131, v242, v243
    ds_write_b64 v251, v[128:129] offset:0
    s_waitcnt lgkmcnt(9)
    ds_write_b64 v251, v[130:131] offset:256
    v_pk_mul_f32 v[252:253], v[252:253], v[248:249] op_sel_hi:[1,0]
    v_pk_mul_f32 v[254:255], v[254:255], v[248:249] op_sel_hi:[1,0]
    v_pk_mul_f32 v[8:9], v[8:9], v[248:249] op_sel_hi:[1,0]
    v_pk_mul_f32 v[10:11], v[10:11], v[248:249] op_sel_hi:[1,0]
    v_cvt_pk_bf16_f32 v132, v252, v253
    v_cvt_pk_bf16_f32 v133, v254, v255
    v_cvt_pk_bf16_f32 v134, v8, v9
    v_cvt_pk_bf16_f32 v135, v10, v11
    ds_write_b64 v251, v[132:133] offset:8192
    ds_write_b64 v251, v[134:135] offset:8448
    buffer_load_dword v75, v77, s[16:19], 0 offen sc1
    s_mov_b32 s74, 0x3f803f80
    s_mov_b32 s75, 0x00003f80
    s_mov_b32 s76, 0x3f800000
    v_mov_b32 v244, 0
    v_mov_b32 v245, 0
    s_waitcnt vmcnt(20)
    v_dot2c_f32_bf16 v244, s74, v136
    v_dot2c_f32_bf16 v245, s74, v137
    v_dot2c_f32_bf16 v244, s74, v138
    v_dot2c_f32_bf16 v245, s74, v139
    s_waitcnt vmcnt(19)
    v_dot2c_f32_bf16 v244, s74, v140
    v_dot2c_f32_bf16 v245, s74, v141
    v_dot2c_f32_bf16 v244, s74, v142
    v_dot2c_f32_bf16 v245, s74, v143
    s_waitcnt vmcnt(18)
    v_dot2c_f32_bf16 v244, s74, v144
    v_dot2c_f32_bf16 v245, s74, v145
    v_dot2c_f32_bf16 v244, s74, v146
    v_dot2c_f32_bf16 v245, s74, v147
    s_waitcnt vmcnt(17)
    v_dot2c_f32_bf16 v244, s74, v148
    v_dot2c_f32_bf16 v245, s74, v149
    v_dot2c_f32_bf16 v244, s74, v150
    v_dot2c_f32_bf16 v245, s74, v151
    s_waitcnt vmcnt(16)
    v_dot2c_f32_bf16 v244, s74, v152
    v_dot2c_f32_bf16 v245, s74, v153
    v_dot2c_f32_bf16 v244, s74, v154
    v_dot2c_f32_bf16 v245, s74, v155
    s_waitcnt vmcnt(15)
    v_dot2c_f32_bf16 v244, s74, v156
    v_dot2c_f32_bf16 v245, s74, v157
    v_dot2c_f32_bf16 v244, s74, v158
    v_dot2c_f32_bf16 v245, s74, v159
    s_waitcnt vmcnt(14)
    v_dot2c_f32_bf16 v244, s74, v160
    v_dot2c_f32_bf16 v245, s74, v161
    v_dot2c_f32_bf16 v244, s74, v162
    v_dot2c_f32_bf16 v245, s74, v163
    s_waitcnt vmcnt(13)
    v_dot2c_f32_bf16 v244, s74, v164
    v_dot2c_f32_bf16 v245, s74, v165
    v_dot2c_f32_bf16 v244, s74, v166
    v_dot2c_f32_bf16 v245, s74, v167
    s_waitcnt vmcnt(12)
    v_dot2c_f32_bf16 v244, s74, v168
    v_dot2c_f32_bf16 v245, s74, v169
    v_dot2c_f32_bf16 v244, s74, v170
    v_dot2c_f32_bf16 v245, s74, v171
    s_nop 2
    v_add_f32 v244, v244, v245
    s_nop 1
    v_add_f32_dpp v244, v244, v244 quad_perm:[1,0,3,2] row_mask:0xf bank_mask:0xf
    s_nop 1
    v_add_f32_dpp v244, v244, v244 quad_perm:[2,3,0,1] row_mask:0xf bank_mask:0xf
    s_nop 1
    v_add_f32_dpp v244, v244, v244 row_half_mirror row_mask:0xf bank_mask:0xf
    v_mul_f32 v244, 0x3ae38e39, v244
    v_mov_b32 v245, v244
    v_cvt_pk_bf16_f32 v245, v245, v245
    v_and_b32 v245, 0xffff0000, v245
    v_sub_f32 v244, v244, v245
    v_xor_b32 v245, 0x80000000, v245
    v_dot2_f32_bf16 v172, v136, s75, v245
    v_dot2_f32_bf16 v173, v136, s76, v245
    s_add_u32 m0, s20, 118784
    s_nop 0
    buffer_load_dwordx4 v96, s[4:7], s21 offen lds
    v_dot2_f32_bf16 v174, v137, s75, v245
    v_dot2_f32_bf16 v175, v137, s76, v245
    v_dot2_f32_bf16 v176, v138, s75, v245
    v_dot2_f32_bf16 v177, v138, s76, v245
    v_dot2_f32_bf16 v178, v139, s75, v245
    v_dot2_f32_bf16 v179, v139, s76, v245
    v_dot2_f32_bf16 v180, v140, s75, v245
    v_dot2_f32_bf16 v181, v140, s76, v245
    v_dot2_f32_bf16 v182, v141, s75, v245
    v_dot2_f32_bf16 v183, v141, s76, v245
    v_dot2_f32_bf16 v184, v142, s75, v245
    v_dot2_f32_bf16 v185, v142, s76, v245
    v_dot2_f32_bf16 v186, v143, s75, v245
    v_dot2_f32_bf16 v187, v143, s76, v245
    v_dot2_f32_bf16 v188, v144, s75, v245
    v_dot2_f32_bf16 v189, v144, s76, v245
    v_dot2_f32_bf16 v190, v145, s75, v245
    v_dot2_f32_bf16 v191, v145, s76, v245
    v_dot2_f32_bf16 v192, v146, s75, v245
    v_dot2_f32_bf16 v193, v146, s76, v245
    v_dot2_f32_bf16 v194, v147, s75, v245
    v_dot2_f32_bf16 v195, v147, s76, v245
    v_dot2_f32_bf16 v196, v148, s75, v245
    v_dot2_f32_bf16 v197, v148, s76, v245
    v_dot2_f32_bf16 v198, v149, s75, v245
    v_dot2_f32_bf16 v199, v149, s76, v245
    v_dot2_f32_bf16 v200, v150, s75, v245
    v_dot2_f32_bf16 v201, v150, s76, v245
    v_dot2_f32_bf16 v202, v151, s75, v245
    v_dot2_f32_bf16 v203, v151, s76, v245
    v_dot2_f32_bf16 v204, v152, s75, v245
    v_dot2_f32_bf16 v205, v152, s76, v245
    v_dot2_f32_bf16 v206, v153, s75, v245
    v_dot2_f32_bf16 v207, v153, s76, v245
    v_dot2_f32_bf16 v208, v154, s75, v245
    v_dot2_f32_bf16 v209, v154, s76, v245
    s_add_u32 m0, s20, 122880
    s_add_u32 s21, s36, s22
    buffer_load_dwordx4 v80, s[4:7], s21 offen lds
    v_dot2_f32_bf16 v210, v155, s75, v245
    v_dot2_f32_bf16 v211, v155, s76, v245
    v_dot2_f32_bf16 v212, v156, s75, v245
    v_dot2_f32_bf16 v213, v156, s76, v245
    v_dot2_f32_bf16 v214, v157, s75, v245
    v_dot2_f32_bf16 v215, v157, s76, v245
    v_dot2_f32_bf16 v224, v158, s75, v245
    v_dot2_f32_bf16 v225, v158, s76, v245
    v_dot2_f32_bf16 v226, v159, s75, v245
    v_dot2_f32_bf16 v227, v159, s76, v245
    v_dot2_f32_bf16 v228, v160, s75, v245
    v_dot2_f32_bf16 v229, v160, s76, v245
    v_dot2_f32_bf16 v230, v161, s75, v245
    v_dot2_f32_bf16 v231, v161, s76, v245
    v_dot2_f32_bf16 v232, v162, s75, v245
    v_dot2_f32_bf16 v233, v162, s76, v245
    v_dot2_f32_bf16 v234, v163, s75, v245
    v_dot2_f32_bf16 v235, v163, s76, v245
    v_dot2_f32_bf16 v236, v164, s75, v245
    v_dot2_f32_bf16 v237, v164, s76, v245
    v_dot2_f32_bf16 v238, v165, s75, v245
    v_dot2_f32_bf16 v239, v165, s76, v245
    v_dot2_f32_bf16 v240, v166, s75, v245
    v_dot2_f32_bf16 v241, v166, s76, v245
    v_dot2_f32_bf16 v242, v167, s75, v245
    v_dot2_f32_bf16 v243, v167, s76, v245
    v_dot2_f32_bf16 v252, v168, s75, v245
    v_dot2_f32_bf16 v253, v168, s76, v245
    v_dot2_f32_bf16 v254, v169, s75, v245
    v_dot2_f32_bf16 v255, v169, s76, v245
    v_dot2_f32_bf16 v8, v170, s75, v245
    v_dot2_f32_bf16 v9, v170, s76, v245
    v_dot2_f32_bf16 v10, v171, s75, v245
    v_dot2_f32_bf16 v11, v171, s76, v245
    v_pk_mul_f32 v[246:247], v[172:173], v[172:173]
    v_pk_fma_f32 v[246:247], v[174:175], v[174:175], v[246:247]
    s_add_u32 m0, s20, 126976
    s_nop 0
    buffer_load_dwordx4 v96, s[4:7], s21 offen lds
    v_pk_fma_f32 v[246:247], v[176:177], v[176:177], v[246:247]
    v_pk_fma_f32 v[246:247], v[178:179], v[178:179], v[246:247]
    v_pk_fma_f32 v[246:247], v[180:181], v[180:181], v[246:247]
    v_pk_fma_f32 v[246:247], v[182:183], v[182:183], v[246:247]
    v_pk_fma_f32 v[246:247], v[184:185], v[184:185], v[246:247]
    v_pk_fma_f32 v[246:247], v[186:187], v[186:187], v[246:247]
    v_pk_fma_f32 v[246:247], v[188:189], v[188:189], v[246:247]
    v_pk_fma_f32 v[246:247], v[190:191], v[190:191], v[246:247]
    v_pk_fma_f32 v[246:247], v[192:193], v[192:193], v[246:247]
    v_pk_fma_f32 v[246:247], v[194:195], v[194:195], v[246:247]
    v_pk_fma_f32 v[246:247], v[196:197], v[196:197], v[246:247]
    v_pk_fma_f32 v[246:247], v[198:199], v[198:199], v[246:247]
    v_pk_fma_f32 v[246:247], v[200:201], v[200:201], v[246:247]
    v_pk_fma_f32 v[246:247], v[202:203], v[202:203], v[246:247]
    v_pk_fma_f32 v[246:247], v[204:205], v[204:205], v[246:247]
    v_pk_fma_f32 v[246:247], v[206:207], v[206:207], v[246:247]
    v_pk_fma_f32 v[246:247], v[208:209], v[208:209], v[246:247]
    v_pk_fma_f32 v[246:247], v[210:211], v[210:211], v[246:247]
    v_pk_fma_f32 v[246:247], v[212:213], v[212:213], v[246:247]
    v_pk_fma_f32 v[246:247], v[214:215], v[214:215], v[246:247]
    v_pk_fma_f32 v[246:247], v[224:225], v[224:225], v[246:247]
    v_pk_fma_f32 v[246:247], v[226:227], v[226:227], v[246:247]
    v_pk_fma_f32 v[246:247], v[228:229], v[228:229], v[246:247]
    v_pk_fma_f32 v[246:247], v[230:231], v[230:231], v[246:247]
    v_pk_fma_f32 v[246:247], v[232:233], v[232:233], v[246:247]
    v_pk_fma_f32 v[246:247], v[234:235], v[234:235], v[246:247]
    v_pk_fma_f32 v[246:247], v[236:237], v[236:237], v[246:247]
    v_pk_fma_f32 v[246:247], v[238:239], v[238:239], v[246:247]
    v_pk_fma_f32 v[246:247], v[240:241], v[240:241], v[246:247]
    v_pk_fma_f32 v[246:247], v[242:243], v[242:243], v[246:247]
    v_pk_fma_f32 v[246:247], v[252:253], v[252:253], v[246:247]
    v_pk_fma_f32 v[246:247], v[254:255], v[254:255], v[246:247]
    v_pk_fma_f32 v[246:247], v[8:9], v[8:9], v[246:247]
    v_pk_fma_f32 v[246:247], v[10:11], v[10:11], v[246:247]
    v_add_f32 v246, v246, v247
    s_nop 1
    v_add_f32_dpp v246, v246, v246 quad_perm:[1,0,3,2] row_mask:0xf bank_mask:0xf
    s_nop 1
    v_add_f32_dpp v246, v246, v246 quad_perm:[2,3,0,1] row_mask:0xf bank_mask:0xf
    s_nop 1
    v_add_f32_dpp v246, v246, v246 row_half_mirror row_mask:0xf bank_mask:0xf
    v_mul_f32 v244, v244, v244
    v_mov_b32 v247, 0x3ae38e39
    v_fma_f32 v246, v246, v247, -v244
    v_max_f32 v246, 0, v246
    v_cvt_pk_bf16_f32 v246, v246, v246
    v_and_b32 v246, 0xffff0000, v246
    v_add_f32 v246, 0x3727c5ac, v246
    v_cvt_pk_bf16_f32 v246, v246, v246
    v_and_b32 v246, 0xffff0000, v246
    v_sqrt_f32 v246, v246
    s_nop 0
    v_cvt_pk_bf16_f32 v246, v246, v246
    v_and_b32 v246, 0xffff0000, v246
    v_rcp_f32 v248, v246
    s_nop 0
    v_mul_f32 v248, 0x3fb8aa3b, v248
    v_pk_mul_f32 v[172:173], v[172:173], v[248:249] op_sel_hi:[1,0]
    v_pk_mul_f32 v[174:175], v[174:175], v[248:249] op_sel_hi:[1,0]
    v_pk_mul_f32 v[176:177], v[176:177], v[248:249] op_sel_hi:[1,0]
    v_pk_mul_f32 v[178:179], v[178:179], v[248:249] op_sel_hi:[1,0]
    v_cvt_pk_bf16_f32 v136, v172, v173
    v_cvt_pk_bf16_f32 v137, v174, v175
    v_cvt_pk_bf16_f32 v138, v176, v177
    v_cvt_pk_bf16_f32 v139, v178, v179
    ds_write_b64 v92, v[136:137] offset:128
    ds_write_b64 v92, v[138:139] offset:384
    s_add_u32 m0, s20, 131072
    s_add_u32 s21, s37, s22
    buffer_load_dwordx4 v80, s[4:7], s21 offen lds
    v_pk_mul_f32 v[180:181], v[180:181], v[248:249] op_sel_hi:[1,0]
    v_pk_mul_f32 v[182:183], v[182:183], v[248:249] op_sel_hi:[1,0]
    v_pk_mul_f32 v[184:185], v[184:185], v[248:249] op_sel_hi:[1,0]
    v_pk_mul_f32 v[186:187], v[186:187], v[248:249] op_sel_hi:[1,0]
    v_cvt_pk_bf16_f32 v140, v180, v181
    v_cvt_pk_bf16_f32 v141, v182, v183
    v_cvt_pk_bf16_f32 v142, v184, v185
    v_cvt_pk_bf16_f32 v143, v186, v187
    ds_write_b64 v92, v[140:141] offset:8320
    s_waitcnt lgkmcnt(9)
    ds_write_b64 v92, v[142:143] offset:8576
    v_pk_mul_f32 v[188:189], v[188:189], v[248:249] op_sel_hi:[1,0]
    v_pk_mul_f32 v[190:191], v[190:191], v[248:249] op_sel_hi:[1,0]
    v_pk_mul_f32 v[192:193], v[192:193], v[248:249] op_sel_hi:[1,0]
    v_pk_mul_f32 v[194:195], v[194:195], v[248:249] op_sel_hi:[1,0]
    v_cvt_pk_bf16_f32 v144, v188, v189
    v_cvt_pk_bf16_f32 v145, v190, v191
    v_cvt_pk_bf16_f32 v146, v192, v193
    v_cvt_pk_bf16_f32 v147, v194, v195
    ds_write_b64 v92, v[144:145] offset:16512
    ds_write_b64 v92, v[146:147] offset:16768
    v_pk_mul_f32 v[196:197], v[196:197], v[248:249] op_sel_hi:[1,0]
    v_pk_mul_f32 v[198:199], v[198:199], v[248:249] op_sel_hi:[1,0]
    v_pk_mul_f32 v[200:201], v[200:201], v[248:249] op_sel_hi:[1,0]
    v_pk_mul_f32 v[202:203], v[202:203], v[248:249] op_sel_hi:[1,0]
    v_cvt_pk_bf16_f32 v148, v196, v197
    v_cvt_pk_bf16_f32 v149, v198, v199
    v_cvt_pk_bf16_f32 v150, v200, v201
    v_cvt_pk_bf16_f32 v151, v202, v203
    ds_write_b64 v92, v[148:149] offset:24704
    ds_write_b64 v92, v[150:151] offset:24960
    v_pk_mul_f32 v[204:205], v[204:205], v[248:249] op_sel_hi:[1,0]
    v_pk_mul_f32 v[206:207], v[206:207], v[248:249] op_sel_hi:[1,0]
    v_pk_mul_f32 v[208:209], v[208:209], v[248:249] op_sel_hi:[1,0]
    v_pk_mul_f32 v[210:211], v[210:211], v[248:249] op_sel_hi:[1,0]
    v_cvt_pk_bf16_f32 v152, v204, v205
    v_cvt_pk_bf16_f32 v153, v206, v207
    v_cvt_pk_bf16_f32 v154, v208, v209
    v_cvt_pk_bf16_f32 v155, v210, v211
    ds_write_b64 v92, v[152:153] offset:32896
    s_waitcnt lgkmcnt(9)
    ds_write_b64 v92, v[154:155] offset:33152
    s_add_u32 m0, s20, 135168
    s_nop 0
    buffer_load_dwordx4 v96, s[4:7], s21 offen lds
    v_pk_mul_f32 v[212:213], v[212:213], v[248:249] op_sel_hi:[1,0]
    v_pk_mul_f32 v[214:215], v[214:215], v[248:249] op_sel_hi:[1,0]
    v_pk_mul_f32 v[224:225], v[224:225], v[248:249] op_sel_hi:[1,0]
    v_pk_mul_f32 v[226:227], v[226:227], v[248:249] op_sel_hi:[1,0]
    v_cvt_pk_bf16_f32 v156, v212, v213
    v_cvt_pk_bf16_f32 v157, v214, v215
    v_cvt_pk_bf16_f32 v158, v224, v225
    v_cvt_pk_bf16_f32 v159, v226, v227
    ds_write_b64 v92, v[156:157] offset:41088
    ds_write_b64 v92, v[158:159] offset:41344
    v_pk_mul_f32 v[228:229], v[228:229], v[248:249] op_sel_hi:[1,0]
    v_pk_mul_f32 v[230:231], v[230:231], v[248:249] op_sel_hi:[1,0]
    v_pk_mul_f32 v[232:233], v[232:233], v[248:249] op_sel_hi:[1,0]
    v_pk_mul_f32 v[234:235], v[234:235], v[248:249] op_sel_hi:[1,0]
    v_cvt_pk_bf16_f32 v160, v228, v229
    v_cvt_pk_bf16_f32 v161, v230, v231
    v_cvt_pk_bf16_f32 v162, v232, v233
    v_cvt_pk_bf16_f32 v163, v234, v235
    ds_write_b64 v92, v[160:161] offset:49280
    ds_write_b64 v92, v[162:163] offset:49536
    v_pk_mul_f32 v[236:237], v[236:237], v[248:249] op_sel_hi:[1,0]
    v_pk_mul_f32 v[238:239], v[238:239], v[248:249] op_sel_hi:[1,0]
    v_pk_mul_f32 v[240:241], v[240:241], v[248:249] op_sel_hi:[1,0]
    v_pk_mul_f32 v[242:243], v[242:243], v[248:249] op_sel_hi:[1,0]
    v_cvt_pk_bf16_f32 v164, v236, v237
    v_cvt_pk_bf16_f32 v165, v238, v239
    v_cvt_pk_bf16_f32 v166, v240, v241
    v_cvt_pk_bf16_f32 v167, v242, v243
    ds_write_b64 v251, v[164:165] offset:128
    s_waitcnt lgkmcnt(9)
    ds_write_b64 v251, v[166:167] offset:384
    v_pk_mul_f32 v[252:253], v[252:253], v[248:249] op_sel_hi:[1,0]
    v_pk_mul_f32 v[254:255], v[254:255], v[248:249] op_sel_hi:[1,0]
    v_pk_mul_f32 v[8:9], v[8:9], v[248:249] op_sel_hi:[1,0]
    v_pk_mul_f32 v[10:11], v[10:11], v[248:249] op_sel_hi:[1,0]
    v_cvt_pk_bf16_f32 v168, v252, v253
    v_cvt_pk_bf16_f32 v169, v254, v255
    v_cvt_pk_bf16_f32 v170, v8, v9
    v_cvt_pk_bf16_f32 v171, v10, v11
    ds_write_b64 v251, v[168:169] offset:8320
    ds_write_b64 v251, v[170:171] offset:8576
    s_add_u32 m0, s20, 139264
    s_add_u32 s21, s38, s22
    buffer_load_dwordx4 v80, s[4:7], s21 offen lds
    s_add_u32 m0, s20, 143360
    s_nop 0
    buffer_load_dwordx4 v96, s[4:7], s21 offen lds
    s_add_u32 m0, s20, 147456
    s_add_u32 s21, s39, s22
    buffer_load_dwordx4 v80, s[4:7], s21 offen lds
    s_add_u32 s74, s57, s69
    v_xor_b32 v252, s68, v91
    v_add_u32 v252, s74, v252
    v_xor_b32 v253, 64, v252
    s_add_u32 s62, s56, 0x20000
    s_add_u32 s57, s57, 0x1000
    s_cmp_eq_u32 s57, 73728
    s_cselect_b32 s57, 0, s57
    s_xor_b32 s68, s68, 64
    s_add_u32 s74, s57, s69
    v_xor_b32 v254, s68, v91
    v_add_u32 v254, s74, v254
    v_xor_b32 v255, 64, v254
    s_add_u32 s63, s62, 0x20000
    s_add_u32 s57, s57, 0x1000
    s_cmp_eq_u32 s57, 73728
    s_cselect_b32 s57, 0, s57
    s_xor_b32 s68, s68, 64
    s_cmp_eq_u32 s3, 0
    s_cselect_b32 s63, s63, 268435456
    s_add_u32 s74, s57, s69
    v_xor_b32 v202, s68, v91
    v_add_u32 v202, s74, v202
    v_xor_b32 v203, 64, v202
    s_lshr_b32 s64, s2, 3
    s_lshl_b32 s64, s64, 7
    s_add_u32 s64, s64, 9953280
    s_and_b32 s74, s2, 7
    s_cselect_b32 s64, 268435456, s64
    s_waitcnt vmcnt(17) lgkmcnt(0)
    s_barrier
    ds_read_b64_tr_b16 v[100:101], v252
    ds_read_b64_tr_b16 v[102:103], v253
    ds_read_b64_tr_b16 v[104:105], v254
    ds_read_b64_tr_b16 v[106:107], v255
    ds_read_b64_tr_b16 v[108:109], v202
    ds_read_b64_tr_b16 v[110:111], v203
    ds_read_b64_tr_b16 v[40:41], v82 offset:0
    ds_read_b64_tr_b16 v[42:43], v82 offset:2048
    ds_read_b128 a[0:3], v83 offset:0
    ds_read_b128 a[4:7], v83 offset:1024
    ds_read_b128 a[8:11], v83 offset:2048
    ds_read_b128 a[12:15], v83 offset:3072
    ds_read_b64_tr_b16 v[44:45], v82 offset:4096
    ds_read_b64_tr_b16 v[46:47], v82 offset:6144
    ds_read_b128 a[16:19], v220 offset:4096
    s_waitcnt lgkmcnt(9)
    ds_read_b128 a[20:23], v220 offset:5120
    ds_read_b128 a[24:27], v220 offset:6144
    ds_read_b128 a[28:31], v220 offset:7168
    buffer_store_dwordx4 v[100:103], v90, s[12:15], s56 offen sc1
    buffer_store_dwordx4 v[104:107], v90, s[12:15], s62 offen sc1
    buffer_store_dwordx4 v[108:111], v90, s[12:15], s63 offen sc1
    buffer_store_dword v77, v93, s[12:15], s64 offen sc1
    s_waitcnt lgkmcnt(6)
    s_mov_b32 s60, s22
    v_mfma_f32_16x16x32_bf16 v[8:11], v[40:43], a[0:3], 0
    ds_read_b64_tr_b16 v[48:49], v82 offset:8192
    ds_read_b64_tr_b16 v[50:51], v82 offset:10240
    v_mfma_f32_16x16x32_bf16 v[12:15], v[40:43], a[4:7], 0
    s_add_u32 m0, s20, 151552
    ds_read_b128 a[32:35], v83 offset:8192
    ds_read_b128 a[36:39], v83 offset:9216
    v_mfma_f32_16x16x32_bf16 v[16:19], v[40:43], a[8:11], 0
    buffer_load_dwordx4 v96, s[4:7], s21 offen lds
    ds_read_b128 a[40:43], v83 offset:10240
    ds_read_b128 a[44:47], v83 offset:11264
    v_mfma_f32_16x16x32_bf16 v[20:23], v[40:43], a[12:15], 0
    s_waitcnt vmcnt(15) lgkmcnt(6)
    s_and_b32 s74, s2, 7
    s_lshl_b32 s74, s74, 2
    s_lshr_b32 s75, s2, 6
    s_add_u32 s74, s74, s75
    v_mfma_f32_16x16x32_bf16 v[8:11], v[44:47], a[16:19], v[8:11]
    s_barrier
    ds_read_b64_tr_b16 v[40:41], v82 offset:12288
    ds_read_b64_tr_b16 v[42:43], v82 offset:14336
    v_mfma_f32_16x16x32_bf16 v[12:15], v[44:47], a[20:23], v[12:15]
    s_add_u32 s21, s40, s22
    s_add_u32 m0, s20, 155648
    ds_read_b128 a[48:51], v220 offset:12288
    ds_read_b128 a[52:55], v220 offset:13312
    v_mfma_f32_16x16x32_bf16 v[16:19], v[44:47], a[24:27], v[16:19]
    buffer_load_dwordx4 v80, s[4:7], s21 offen lds
    ds_read_b128 a[56:59], v220 offset:14336
    ds_read_b128 a[60:63], v220 offset:15360
    v_mfma_f32_16x16x32_bf16 v[20:23], v[44:47], a[28:31], v[20:23]
    s_waitcnt lgkmcnt(6)
    s_bfe_u32 s75, s2, 0x10005
    s_bfe_u32 s69, s2, 0x20003
    v_mfma_f32_16x16x32_bf16 v[8:11], v[48:51], a[32:35], v[8:11]
    ds_read_b64_tr_b16 v[44:45], v82 offset:16384
    ds_read_b64_tr_b16 v[46:47], v82 offset:18432
    v_mfma_f32_16x16x32_bf16 v[12:15], v[48:51], a[36:39], v[12:15]
    s_add_u32 m0, s20, 159744
    ds_read_b128 a[64:67], v83 offset:16384
    ds_read_b128 a[68:71], v83 offset:17408
    v_mfma_f32_16x16x32_bf16 v[16:19], v[48:51], a[40:43], v[16:19]
    buffer_load_dwordx4 v96, s[4:7], s21 offen lds
    ds_read_b128 a[72:75], v83 offset:18432
    ds_read_b128 a[76:79], v83 offset:19456
    v_mfma_f32_16x16x32_bf16 v[20:23], v[48:51], a[44:47], v[20:23]
    s_waitcnt lgkmcnt(6)
    s_mul_i32 s76, s69, 9
    s_mul_i32 s77, s3, 3
    s_add_u32 s77, s77, s76
    s_mul_i32 s64, s74, 73728
    v_mfma_f32_16x16x32_bf16 v[8:11], v[40:43], a[48:51], v[8:11]
    s_add_u32 s22, s22, 128
    s_cmp_eq_u32 s22, s24
    s_cselect_b32 s22, s23, s22
    s_add_u32 s21, s32, s22
    ds_read_b64_tr_b16 v[48:49], v82 offset:20480
    ds_read_b64_tr_b16 v[50:51], v82 offset:22528
    v_mfma_f32_16x16x32_bf16 v[12:15], v[40:43], a[52:55], v[12:15]
    s_add_u32 m0, s20, 90112
    ds_read_b128 a[80:83], v220 offset:20480
    ds_read_b128 a[84:87], v220 offset:21504
    v_mfma_f32_16x16x32_bf16 v[16:19], v[40:43], a[56:59], v[16:19]
    buffer_load_dwordx4 v80, s[4:7], s21 offen lds
    ds_read_b128 a[88:91], v220 offset:22528
    ds_read_b128 a[92:95], v220 offset:23552
    v_mfma_f32_16x16x32_bf16 v[20:23], v[40:43], a[60:63], v[20:23]
    s_waitcnt vmcnt(14) lgkmcnt(6)
    s_add_u32 s64, s64, 16777216
    s_lshl_b32 s65, s77, 11
    v_mfma_f32_16x16x32_bf16 v[8:11], v[44:47], a[64:67], v[8:11]
    s_barrier
    ds_read_b64_tr_b16 v[40:41], v82 offset:24576
    ds_read_b64_tr_b16 v[42:43], v82 offset:26624
    v_mfma_f32_16x16x32_bf16 v[12:15], v[44:47], a[68:71], v[12:15]
    s_add_u32 m0, s20, 94208
    ds_read_b128 a[96:99], v83 offset:24576
    ds_read_b128 a[100:103], v83 offset:25600
    v_mfma_f32_16x16x32_bf16 v[16:19], v[44:47], a[72:75], v[16:19]
    buffer_load_dwordx4 v96, s[4:7], s21 offen lds
    ds_read_b128 a[104:107], v83 offset:26624
    ds_read_b128 a[108:111], v83 offset:27648
    v_mfma_f32_16x16x32_bf16 v[20:23], v[44:47], a[76:79], v[20:23]
    s_waitcnt lgkmcnt(6)
    s_add_u32 s64, s64, s65
    s_lshl_b32 s65, s75, 10
    s_add_u32 s67, s64, s65
    s_lshr_b32 s65, s2, 3
    v_mfma_f32_16x16x32_bf16 v[8:11], v[48:51], a[80:83], v[8:11]
    s_add_u32 s21, s33, s22
    ds_read_b64_tr_b16 v[44:45], v82 offset:28672
    ds_read_b64_tr_b16 v[46:47], v82 offset:30720
    v_mfma_f32_16x16x32_bf16 v[12:15], v[48:51], a[84:87], v[12:15]
    s_add_u32 m0, s20, 98304
    ds_read_b128 a[112:115], v220 offset:28672
    ds_read_b128 a[116:119], v220 offset:29696
    v_mfma_f32_16x16x32_bf16 v[16:19], v[48:51], a[88:91], v[16:19]
    buffer_load_dwordx4 v80, s[4:7], s21 offen lds
    ds_read_b128 a[120:123], v220 offset:30720
    ds_read_b128 a[124:127], v220 offset:31744
    v_mfma_f32_16x16x32_bf16 v[20:23], v[48:51], a[92:95], v[20:23]
    s_waitcnt lgkmcnt(6)
    s_add_u32 s66, s67, 18874368
    s_xor_b32 s65, s65, s2
    v_mfma_f32_16x16x32_bf16 v[8:11], v[40:43], a[96:99], v[8:11]
    ds_read_b64_tr_b16 v[48:49], v82 offset:32768
    ds_read_b64_tr_b16 v[50:51], v82 offset:34816
    v_mfma_f32_16x16x32_bf16 v[12:15], v[40:43], a[100:103], v[12:15]
    s_add_u32 m0, s20, 102400
    ds_read_b128 a[128:131], v83 offset:32768
    ds_read_b128 a[132:135], v83 offset:33792
    v_mfma_f32_16x16x32_bf16 v[16:19], v[40:43], a[104:107], v[16:19]
    buffer_load_dwordx4 v96, s[4:7], s21 offen lds
    ds_read_b128 a[136:139], v83 offset:34816
    ds_read_b128 a[140:143], v83 offset:35840
    v_mfma_f32_16x16x32_bf16 v[20:23], v[40:43], a[108:111], v[20:23]
    s_waitcnt vmcnt(14) lgkmcnt(6)
    s_and_b32 s65, s65, 7
    s_mul_i32 s65, s65, 2359296
    v_mfma_f32_16x16x32_bf16 v[8:11], v[44:47], a[112:115], v[8:11]
    s_barrier
    ds_read_b64_tr_b16 v[40:41], v98 offset:0
    ds_read_b64_tr_b16 v[42:43], v98 offset:2048
    v_mfma_f32_16x16x32_bf16 v[12:15], v[44:47], a[116:119], v[12:15]
    s_add_u32 s21, s34, s22
    s_add_u32 m0, s20, 106496
    ds_read_b128 a[144:147], v220 offset:36864
    ds_read_b128 a[148:151], v220 offset:37888
    v_mfma_f32_16x16x32_bf16 v[16:19], v[44:47], a[120:123], v[16:19]
    buffer_load_dwordx4 v80, s[4:7], s21 offen lds
    ds_read_b128 a[152:155], v220 offset:38912
    ds_read_b128 a[156:159], v220 offset:39936
    v_mfma_f32_16x16x32_bf16 v[20:23], v[44:47], a[124:127], v[20:23]
    s_waitcnt lgkmcnt(6)
    s_add_u32 s64, s67, s65
    s_lshl_b32 s65, s74, 1
    s_add_u32 s65, s65, s75
    s_lshl_b32 s68, s65, 6
    v_mfma_f32_16x16x32_bf16 v[8:11], v[48:51], a[128:131], v[8:11]
    ds_read_b64_tr_b16 v[44:45], v98 offset:4096
    ds_read_b64_tr_b16 v[46:47], v98 offset:6144
    v_mfma_f32_16x16x32_bf16 v[12:15], v[48:51], a[132:135], v[12:15]
    s_add_u32 m0, s20, 110592
    ds_read_b128 a[160:163], v221 offset:0
    ds_read_b128 a[164:167], v221 offset:1024
    v_mfma_f32_16x16x32_bf16 v[16:19], v[48:51], a[136:139], v[16:19]
    buffer_load_dwordx4 v96, s[4:7], s21 offen lds
    ds_read_b128 a[168:171], v221 offset:2048
    ds_read_b128 a[172:175], v221 offset:3072
    v_mfma_f32_16x16x32_bf16 v[20:23], v[48:51], a[140:143], v[20:23]
    s_waitcnt lgkmcnt(6)
    s_mul_i32 s65, s65, 36864
    s_lshl_b32 s77, s77, 5
    v_mfma_f32_16x16x32_bf16 v[8:11], v[40:43], a[144:147], v[8:11]
    s_add_u32 s21, s35, s22
    ds_read_b64_tr_b16 v[48:49], v98 offset:8192
    ds_read_b64_tr_b16 v[50:51], v98 offset:10240
    v_mfma_f32_16x16x32_bf16 v[12:15], v[40:43], a[148:151], v[12:15]
    s_add_u32 m0, s20, 114688
    ds_read_b128 a[176:179], v222 offset:4096
    ds_read_b128 a[180:183], v222 offset:5120
    v_mfma_f32_16x16x32_bf16 v[16:19], v[40:43], a[152:155], v[16:19]
    buffer_load_dwordx4 v80, s[4:7], s21 offen lds
    ds_read_b128 a[184:187], v222 offset:6144
    ds_read_b128 a[188:191], v222 offset:7168
    v_mfma_f32_16x16x32_bf16 v[20:23], v[40:43], a[156:159], v[20:23]
    s_waitcnt vmcnt(14) lgkmcnt(6)
    s_add_u32 s65, s65, s77
    s_lshl_b32 s76, s76, 16
    s_add_u32 s68, s68, s76
    s_add_u32 s68, s68, 7340032
    v_mfma_f32_16x16x32_bf16 v[8:11], v[44:47], a[160:163], v[8:11]
    s_barrier
    ds_read_b64_tr_b16 v[40:41], v98 offset:12288
    ds_read_b64_tr_b16 v[42:43], v98 offset:14336
    v_mfma_f32_16x16x32_bf16 v[12:15], v[44:47], a[164:167], v[12:15]
    s_add_u32 m0, s20, 118784
    ds_read_b128 a[192:195], v221 offset:8192
    ds_read_b128 a[196:199], v221 offset:9216
    v_mfma_f32_16x16x32_bf16 v[16:19], v[44:47], a[168:171], v[16:19]
    buffer_load_dwordx4 v96, s[4:7], s21 offen lds
    ds_read_b128 a[200:203], v221 offset:10240
    ds_read_b128 a[204:207], v221 offset:11264
    v_mfma_f32_16x16x32_bf16 v[20:23], v[44:47], a[172:175], v[20:23]
    s_waitcnt lgkmcnt(6)
    s_lshl_b32 s63, s74, 12
    s_add_u32 s63, s63, 9961472
    v_mfma_f32_16x16x32_bf16 v[8:11], v[48:51], a[176:179], v[8:11]
    s_add_u32 s21, s36, s22
    ds_read_b64_tr_b16 v[44:45], v98 offset:16384
    ds_read_b64_tr_b16 v[46:47], v98 offset:18432
    v_mfma_f32_16x16x32_bf16 v[12:15], v[48:51], a[180:183], v[12:15]
    s_add_u32 m0, s20, 122880
    ds_read_b128 a[208:211], v222 offset:12288
    ds_read_b128 a[212:215], v222 offset:13312
    v_mfma_f32_16x16x32_bf16 v[16:19], v[48:51], a[184:187], v[16:19]
    buffer_load_dwordx4 v80, s[4:7], s21 offen lds
    ds_read_b128 a[216:219], v222 offset:14336
    ds_read_b128 a[220:223], v222 offset:15360
    v_mfma_f32_16x16x32_bf16 v[20:23], v[48:51], a[188:191], v[20:23]
    s_waitcnt lgkmcnt(6)
    s_lshl_b32 s57, s2, 7
    s_add_u32 s57, s57, 9863168
    v_mfma_f32_16x16x32_bf16 v[8:11], v[40:43], a[192:195], v[8:11]
    ds_read_b64_tr_b16 v[48:49], v98 offset:20480
    ds_read_b64_tr_b16 v[50:51], v98 offset:22528
    v_mfma_f32_16x16x32_bf16 v[12:15], v[40:43], a[196:199], v[12:15]
    s_add_u32 m0, s20, 126976
    ds_read_b128 a[224:227], v221 offset:16384
    ds_read_b128 a[228:231], v221 offset:17408
    v_mfma_f32_16x16x32_bf16 v[16:19], v[40:43], a[200:203], v[16:19]
    buffer_load_dwordx4 v96, s[4:7], s21 offen lds
    ds_read_b128 a[232:235], v221 offset:18432
    ds_read_b128 a[236:239], v221 offset:19456
    v_mfma_f32_16x16x32_bf16 v[20:23], v[40:43], a[204:207], v[20:23]
    s_waitcnt vmcnt(10) lgkmcnt(6)
    s_mov_b32 s56, 268435456
    v_and_b32 v71, 31, v1
    v_mfma_f32_16x16x32_bf16 v[8:11], v[44:47], a[208:211], v[8:11]
    s_barrier
    ds_read_b64_tr_b16 v[40:41], v98 offset:24576
    ds_read_b64_tr_b16 v[42:43], v98 offset:26624
    v_mfma_f32_16x16x32_bf16 v[12:15], v[44:47], a[212:215], v[12:15]
    s_add_u32 s21, s37, s22
    s_add_u32 m0, s20, 131072
    ds_read_b128 a[240:243], v222 offset:20480
    ds_read_b128 a[244:247], v222 offset:21504
    v_mfma_f32_16x16x32_bf16 v[16:19], v[44:47], a[216:219], v[16:19]
    buffer_load_dwordx4 v80, s[4:7], s21 offen lds
    ds_read_b128 a[248:251], v222 offset:22528
    ds_read_b128 a[252:255], v222 offset:23552
    v_mfma_f32_16x16x32_bf16 v[20:23], v[44:47], a[220:223], v[20:23]
    s_waitcnt lgkmcnt(6)
    v_lshlrev_b32 v71, 7, v71
    v_mfma_f32_16x16x32_bf16 v[8:11], v[48:51], a[224:227], v[8:11]
    ds_read_b64_tr_b16 v[44:45], v98 offset:28672
    ds_read_b64_tr_b16 v[46:47], v98 offset:30720
    v_mfma_f32_16x16x32_bf16 v[12:15], v[48:51], a[228:231], v[12:15]
    s_add_u32 m0, s20, 135168
    ds_read_b128 v[224:227], v221 offset:24576
    ds_read_b128 v[228:231], v221 offset:25600
    v_mfma_f32_16x16x32_bf16 v[16:19], v[48:51], a[232:235], v[16:19]
    buffer_load_dwordx4 v96, s[4:7], s21 offen lds
    ds_read_b128 v[232:235], v221 offset:26624
    ds_read_b128 v[236:239], v221 offset:27648
    v_mfma_f32_16x16x32_bf16 v[20:23], v[48:51], a[236:239], v[20:23]
    s_waitcnt lgkmcnt(6)
    v_add_u32 v66, 0x1000, v99
    v_mov_b32 v65, -1
    v_mfma_f32_16x16x32_bf16 v[8:11], v[40:43], a[240:243], v[8:11]
    s_add_u32 s21, s38, s22
    ds_read_b64_tr_b16 v[48:49], v98 offset:32768
    ds_read_b64_tr_b16 v[50:51], v98 offset:34816
    v_mfma_f32_16x16x32_bf16 v[12:15], v[40:43], a[244:247], v[12:15]
    s_add_u32 m0, s20, 139264
    ds_read_b128 v[240:243], v222 offset:28672
    ds_read_b128 v[244:247], v222 offset:29696
    v_mfma_f32_16x16x32_bf16 v[16:19], v[40:43], a[248:251], v[16:19]
    buffer_load_dwordx4 v80, s[4:7], s21 offen lds
    ds_read_b128 v[248:251], v222 offset:30720
    ds_read_b128 v[252:255], v222 offset:31744
    v_mfma_f32_16x16x32_bf16 v[20:23], v[40:43], a[252:255], v[20:23]
    s_waitcnt vmcnt(10) lgkmcnt(6)
    v_mov_b32 v64, 81920
    v_mfma_f32_16x16x32_bf16 v[8:11], v[44:47], v[224:227], v[8:11]
    s_barrier
    ds_read_b64_tr_b16 v[40:41], v82 offset:0
    ds_read_b64_tr_b16 v[42:43], v82 offset:2048
    v_mfma_f32_16x16x32_bf16 v[12:15], v[44:47], v[228:231], v[12:15]
    s_add_u32 m0, s20, 143360
    ds_write_b32 v64, v65
    v_mfma_f32_16x16x32_bf16 v[16:19], v[44:47], v[232:235], v[16:19]
    buffer_load_dwordx4 v96, s[4:7], s21 offen lds
    v_mfma_f32_16x16x32_bf16 v[20:23], v[44:47], v[236:239], v[20:23]
    s_waitcnt lgkmcnt(3)
    v_mfma_f32_16x16x32_bf16 v[24:27], v[48:51], v[240:243], v[8:11]
    s_add_u32 s21, s39, s22
    ds_read_b64_tr_b16 v[44:45], v82 offset:4096
    ds_read_b64_tr_b16 v[46:47], v82 offset:6144
    v_mfma_f32_16x16x32_bf16 v[28:31], v[48:51], v[244:247], v[12:15]
    s_add_u32 m0, s20, 147456
    v_mfma_f32_16x16x32_bf16 v[32:35], v[48:51], v[248:251], v[16:19]
    buffer_load_dwordx4 v80, s[4:7], s21 offen lds
    v_mfma_f32_16x16x32_bf16 v[36:39], v[48:51], v[252:255], v[20:23]
    s_waitcnt lgkmcnt(3)
    v_readfirstlane_b32 s61, v75
    s_mov_b32 s25, 0x40000
    s_lshl_b32 s74, s2, 7
    s_add_u32 s74, s74, 9830400
parallel_sum__ssm_conv_s4d__dense_activation_silu__prompt_kernel_np:
    s_cmp_lg_u32 s61, 0
    s_cbranch_scc1 parallel_sum__ssm_conv_s4d__dense_activation_silu__prompt_kernel_nok
    s_sub_u32 s25, s25, 1
    s_cbranch_scc1 parallel_sum__ssm_conv_s4d__dense_activation_silu__prompt_kernel_nok
    buffer_load_dword v75, v77, s[16:19], 0 offen sc1
    s_waitcnt vmcnt(0)
    v_readfirstlane_b32 s61, v75
    s_nop 0
    s_branch parallel_sum__ssm_conv_s4d__dense_activation_silu__prompt_kernel_np
parallel_sum__ssm_conv_s4d__dense_activation_silu__prompt_kernel_nok:
    v_mov_b32 v75, s61
    v_mov_b32 v69, s61
    buffer_store_dword v75, v93, s[12:15], s74 offen sc1
    s_mov_b32 s25, 7
.p2align 5
parallel_sum__ssm_conv_s4d__dense_activation_silu__prompt_kernel_la:
    v_mfma_f32_16x16x32_bf16 v[8:11], v[40:43], a[0:3], 0
    ds_read_b64_tr_b16 v[48:49], v82 offset:8192
    ds_read_b64_tr_b16 v[50:51], v82 offset:10240
    v_mfma_f32_16x16x32_bf16 v[12:15], v[40:43], a[4:7], 0
    s_add_u32 m0, s20, 151552
    v_mfma_f32_16x16x32_bf16 v[16:19], v[40:43], a[8:11], 0
    buffer_load_dwordx4 v96, s[4:7], s21 offen lds
    v_exp_f32 v56, -v24
    v_mfma_f32_16x16x32_bf16 v[20:23], v[40:43], a[12:15], 0
    s_waitcnt vmcnt(10) lgkmcnt(2)
    v_exp_f32 v57, -v25
    v_mfma_f32_16x16x32_bf16 v[8:11], v[44:47], a[16:19], v[8:11]
    s_barrier
    ds_read_b64_tr_b16 v[40:41], v82 offset:12288
    ds_read_b64_tr_b16 v[42:43], v82 offset:14336
    v_mfma_f32_16x16x32_bf16 v[12:15], v[44:47], a[20:23], v[12:15]
    s_add_u32 s21, s40, s22
    s_add_u32 m0, s20, 155648
    v_exp_f32 v58, -v26
    v_mfma_f32_16x16x32_bf16 v[16:19], v[44:47], a[24:27], v[16:19]
    buffer_load_dwordx4 v80, s[4:7], s21 offen lds
    v_exp_f32 v59, -v27
    v_mfma_f32_16x16x32_bf16 v[20:23], v[44:47], a[28:31], v[20:23]
    s_waitcnt lgkmcnt(2)
    v_fma_f32 v56, v56, s30, s30
    v_fma_f32 v57, v57, s30, s30
    v_fma_f32 v58, v58, s30, s30
    v_mfma_f32_16x16x32_bf16 v[8:11], v[48:51], a[32:35], v[8:11]
    ds_read_b64_tr_b16 v[44:45], v82 offset:16384
    ds_read_b64_tr_b16 v[46:47], v82 offset:18432
    v_mfma_f32_16x16x32_bf16 v[12:15], v[48:51], a[36:39], v[12:15]
    s_add_u32 m0, s20, 159744
    v_fma_f32 v59, v59, s30, s30
    v_mfma_f32_16x16x32_bf16 v[16:19], v[48:51], a[40:43], v[16:19]
    buffer_load_dwordx4 v96, s[4:7], s21 offen lds
    v_rcp_f32 v56, v56
    v_mfma_f32_16x16x32_bf16 v[20:23], v[48:51], a[44:47], v[20:23]
    s_waitcnt lgkmcnt(2)
    v_rcp_f32 v57, v57
    v_mfma_f32_16x16x32_bf16 v[8:11], v[40:43], a[48:51], v[8:11]
    s_add_u32 s22, s22, 128
    s_cmp_eq_u32 s22, s24
    s_cselect_b32 s22, s23, s22
    s_add_u32 s21, s32, s22
    ds_read_b64_tr_b16 v[48:49], v82 offset:20480
    ds_read_b64_tr_b16 v[50:51], v82 offset:22528
    v_mfma_f32_16x16x32_bf16 v[12:15], v[40:43], a[52:55], v[12:15]
    s_add_u32 m0, s20, 90112
    v_rcp_f32 v58, v58
    v_mfma_f32_16x16x32_bf16 v[16:19], v[40:43], a[56:59], v[16:19]
    buffer_load_dwordx4 v80, s[4:7], s21 offen lds
    v_rcp_f32 v59, v59
    v_mfma_f32_16x16x32_bf16 v[20:23], v[40:43], a[60:63], v[20:23]
    s_waitcnt vmcnt(10) lgkmcnt(2)
    v_mul_f32 v56, v24, v56
    v_mul_f32 v57, v25, v57
    v_mul_f32 v58, v26, v58
    v_mfma_f32_16x16x32_bf16 v[8:11], v[44:47], a[64:67], v[8:11]
    s_barrier
    ds_read_b64_tr_b16 v[40:41], v82 offset:24576
    ds_read_b64_tr_b16 v[42:43], v82 offset:26624
    v_mfma_f32_16x16x32_bf16 v[12:15], v[44:47], a[68:71], v[12:15]
    s_add_u32 m0, s20, 94208
    v_mul_f32 v59, v27, v59
    v_cvt_pk_bf16_f32 v72, v56, v57
    v_mfma_f32_16x16x32_bf16 v[16:19], v[44:47], a[72:75], v[16:19]
    buffer_load_dwordx4 v96, s[4:7], s21 offen lds
    v_cvt_pk_bf16_f32 v73, v58, v59
    v_mfma_f32_16x16x32_bf16 v[20:23], v[44:47], a[76:79], v[20:23]
    s_waitcnt lgkmcnt(2)
    ds_write_b64 v84, v[72:73] offset:0
    v_exp_f32 v60, -v28
    v_mfma_f32_16x16x32_bf16 v[8:11], v[48:51], a[80:83], v[8:11]
    s_add_u32 s21, s33, s22
    ds_read_b64_tr_b16 v[44:45], v82 offset:28672
    ds_read_b64_tr_b16 v[46:47], v82 offset:30720
    v_mfma_f32_16x16x32_bf16 v[12:15], v[48:51], a[84:87], v[12:15]
    s_add_u32 m0, s20, 98304
    v_exp_f32 v61, -v29
    v_mfma_f32_16x16x32_bf16 v[16:19], v[48:51], a[88:91], v[16:19]
    buffer_load_dwordx4 v80, s[4:7], s21 offen lds
    v_exp_f32 v62, -v30
    v_mfma_f32_16x16x32_bf16 v[20:23], v[48:51], a[92:95], v[20:23]
    s_waitcnt lgkmcnt(3)
    v_exp_f32 v63, -v31
    v_mfma_f32_16x16x32_bf16 v[8:11], v[40:43], a[96:99], v[8:11]
    ds_read_b64_tr_b16 v[48:49], v82 offset:32768
    ds_read_b64_tr_b16 v[50:51], v82 offset:34816
    v_mfma_f32_16x16x32_bf16 v[12:15], v[40:43], a[100:103], v[12:15]
    s_add_u32 m0, s20, 102400
    v_fma_f32 v60, v60, s30, s30
    v_fma_f32 v61, v61, s30, s30
    v_mfma_f32_16x16x32_bf16 v[16:19], v[40:43], a[104:107], v[16:19]
    buffer_load_dwordx4 v96, s[4:7], s21 offen lds
    v_fma_f32 v62, v62, s30, s30
    v_fma_f32 v63, v63, s30, s30
    v_mfma_f32_16x16x32_bf16 v[20:23], v[40:43], a[108:111], v[20:23]
    s_waitcnt vmcnt(10) lgkmcnt(2)
    v_rcp_f32 v60, v60
    v_mfma_f32_16x16x32_bf16 v[8:11], v[44:47], a[112:115], v[8:11]
    s_barrier
    ds_read_b64_tr_b16 v[40:41], v98 offset:0
    ds_read_b64_tr_b16 v[42:43], v98 offset:2048
    v_mfma_f32_16x16x32_bf16 v[12:15], v[44:47], a[116:119], v[12:15]
    s_add_u32 s21, s34, s22
    s_add_u32 m0, s20, 106496
    v_rcp_f32 v61, v61
    v_mfma_f32_16x16x32_bf16 v[16:19], v[44:47], a[120:123], v[16:19]
    buffer_load_dwordx4 v80, s[4:7], s21 offen lds
    v_rcp_f32 v62, v62
    v_mfma_f32_16x16x32_bf16 v[20:23], v[44:47], a[124:127], v[20:23]
    s_waitcnt lgkmcnt(2)
    v_rcp_f32 v63, v63
    v_mfma_f32_16x16x32_bf16 v[8:11], v[48:51], a[128:131], v[8:11]
    ds_read_b64_tr_b16 v[44:45], v98 offset:4096
    ds_read_b64_tr_b16 v[46:47], v98 offset:6144
    v_mfma_f32_16x16x32_bf16 v[12:15], v[48:51], a[132:135], v[12:15]
    s_add_u32 m0, s20, 110592
    v_mul_f32 v60, v28, v60
    v_mul_f32 v61, v29, v61
    v_mfma_f32_16x16x32_bf16 v[16:19], v[48:51], a[136:139], v[16:19]
    buffer_load_dwordx4 v96, s[4:7], s21 offen lds
    v_mul_f32 v62, v30, v62
    v_mul_f32 v63, v31, v63
    v_mfma_f32_16x16x32_bf16 v[20:23], v[48:51], a[140:143], v[20:23]
    s_waitcnt lgkmcnt(2)
    v_cvt_pk_bf16_f32 v74, v60, v61
    v_cvt_pk_bf16_f32 v75, v62, v63
    v_mfma_f32_16x16x32_bf16 v[8:11], v[40:43], a[144:147], v[8:11]
    s_add_u32 s21, s35, s22
    ds_read_b64_tr_b16 v[48:49], v98 offset:8192
    ds_read_b64_tr_b16 v[50:51], v98 offset:10240
    v_mfma_f32_16x16x32_bf16 v[12:15], v[40:43], a[148:151], v[12:15]
    s_add_u32 m0, s20, 114688
    ds_write_b64 v84, v[74:75] offset:1024
    v_mfma_f32_16x16x32_bf16 v[16:19], v[40:43], a[152:155], v[16:19]
    buffer_load_dwordx4 v80, s[4:7], s21 offen lds
    v_exp_f32 v56, -v32
    v_mfma_f32_16x16x32_bf16 v[20:23], v[40:43], a[156:159], v[20:23]
    s_waitcnt vmcnt(10) lgkmcnt(3)
    v_exp_f32 v57, -v33
    v_mfma_f32_16x16x32_bf16 v[8:11], v[44:47], a[160:163], v[8:11]
    s_barrier
    ds_read_b64_tr_b16 v[40:41], v98 offset:12288
    ds_read_b64_tr_b16 v[42:43], v98 offset:14336
    v_mfma_f32_16x16x32_bf16 v[12:15], v[44:47], a[164:167], v[12:15]
    s_add_u32 m0, s20, 118784
    v_exp_f32 v58, -v34
    v_mfma_f32_16x16x32_bf16 v[16:19], v[44:47], a[168:171], v[16:19]
    buffer_load_dwordx4 v96, s[4:7], s21 offen lds
    v_exp_f32 v59, -v35
    v_mfma_f32_16x16x32_bf16 v[20:23], v[44:47], a[172:175], v[20:23]
    s_waitcnt lgkmcnt(3)
    v_fma_f32 v56, v56, s30, s30
    v_fma_f32 v57, v57, s30, s30
    v_fma_f32 v58, v58, s30, s30
    v_mfma_f32_16x16x32_bf16 v[8:11], v[48:51], a[176:179], v[8:11]
    s_add_u32 s21, s36, s22
    ds_read_b64_tr_b16 v[44:45], v98 offset:16384
    ds_read_b64_tr_b16 v[46:47], v98 offset:18432
    v_mfma_f32_16x16x32_bf16 v[12:15], v[48:51], a[180:183], v[12:15]
    s_add_u32 m0, s20, 122880
    v_fma_f32 v59, v59, s30, s30
    v_mfma_f32_16x16x32_bf16 v[16:19], v[48:51], a[184:187], v[16:19]
    buffer_load_dwordx4 v80, s[4:7], s21 offen lds
    v_rcp_f32 v56, v56
    v_mfma_f32_16x16x32_bf16 v[20:23], v[48:51], a[188:191], v[20:23]
    s_waitcnt lgkmcnt(2)
    v_rcp_f32 v57, v57
    v_mfma_f32_16x16x32_bf16 v[8:11], v[40:43], a[192:195], v[8:11]
    ds_read_b64_tr_b16 v[48:49], v98 offset:20480
    ds_read_b64_tr_b16 v[50:51], v98 offset:22528
    v_mfma_f32_16x16x32_bf16 v[12:15], v[40:43], a[196:199], v[12:15]
    s_add_u32 m0, s20, 126976
    v_rcp_f32 v58, v58
    v_mfma_f32_16x16x32_bf16 v[16:19], v[40:43], a[200:203], v[16:19]
    buffer_load_dwordx4 v96, s[4:7], s21 offen lds
    v_rcp_f32 v59, v59
    v_mfma_f32_16x16x32_bf16 v[20:23], v[40:43], a[204:207], v[20:23]
    s_waitcnt vmcnt(10) lgkmcnt(2)
    v_mul_f32 v56, v32, v56
    v_mul_f32 v57, v33, v57
    v_mul_f32 v58, v34, v58
    v_mfma_f32_16x16x32_bf16 v[8:11], v[44:47], a[208:211], v[8:11]
    s_barrier
    ds_read_b64_tr_b16 v[40:41], v98 offset:24576
    ds_read_b64_tr_b16 v[42:43], v98 offset:26624
    v_mfma_f32_16x16x32_bf16 v[12:15], v[44:47], a[212:215], v[12:15]
    s_add_u32 s21, s37, s22
    s_add_u32 m0, s20, 131072
    v_mul_f32 v59, v35, v59
    v_cvt_pk_bf16_f32 v72, v56, v57
    v_mfma_f32_16x16x32_bf16 v[16:19], v[44:47], a[216:219], v[16:19]
    buffer_load_dwordx4 v80, s[4:7], s21 offen lds
    v_cvt_pk_bf16_f32 v73, v58, v59
    v_mfma_f32_16x16x32_bf16 v[20:23], v[44:47], a[220:223], v[20:23]
    s_waitcnt lgkmcnt(2)
    ds_write_b64 v84, v[72:73] offset:2048
    v_exp_f32 v60, -v36
    v_mfma_f32_16x16x32_bf16 v[8:11], v[48:51], a[224:227], v[8:11]
    ds_read_b64_tr_b16 v[44:45], v98 offset:28672
    ds_read_b64_tr_b16 v[46:47], v98 offset:30720
    v_mfma_f32_16x16x32_bf16 v[12:15], v[48:51], a[228:231], v[12:15]
    s_add_u32 m0, s20, 135168
    v_exp_f32 v61, -v37
    v_mfma_f32_16x16x32_bf16 v[16:19], v[48:51], a[232:235], v[16:19]
    buffer_load_dwordx4 v96, s[4:7], s21 offen lds
    v_exp_f32 v62, -v38
    v_mfma_f32_16x16x32_bf16 v[20:23], v[48:51], a[236:239], v[20:23]
    s_waitcnt lgkmcnt(3)
    v_exp_f32 v63, -v39
    v_mfma_f32_16x16x32_bf16 v[8:11], v[40:43], a[240:243], v[8:11]
    s_add_u32 s21, s38, s22
    ds_read_b64_tr_b16 v[48:49], v98 offset:32768
    ds_read_b64_tr_b16 v[50:51], v98 offset:34816
    v_mfma_f32_16x16x32_bf16 v[12:15], v[40:43], a[244:247], v[12:15]
    s_add_u32 m0, s20, 139264
    v_fma_f32 v60, v60, s30, s30
    v_fma_f32 v61, v61, s30, s30
    v_mfma_f32_16x16x32_bf16 v[16:19], v[40:43], a[248:251], v[16:19]
    buffer_load_dwordx4 v80, s[4:7], s21 offen lds
    v_fma_f32 v62, v62, s30, s30
    v_fma_f32 v63, v63, s30, s30
    v_mfma_f32_16x16x32_bf16 v[20:23], v[40:43], a[252:255], v[20:23]
    s_waitcnt vmcnt(10) lgkmcnt(2)
    v_rcp_f32 v60, v60
    v_mfma_f32_16x16x32_bf16 v[8:11], v[44:47], v[224:227], v[8:11]
    s_barrier
    ds_read_b64_tr_b16 v[40:41], v82 offset:0
    ds_read_b64_tr_b16 v[42:43], v82 offset:2048
    v_mfma_f32_16x16x32_bf16 v[12:15], v[44:47], v[228:231], v[12:15]
    s_add_u32 m0, s20, 143360
    v_rcp_f32 v61, v61
    v_mfma_f32_16x16x32_bf16 v[16:19], v[44:47], v[232:235], v[16:19]
    buffer_load_dwordx4 v96, s[4:7], s21 offen lds
    v_rcp_f32 v62, v62
    v_mfma_f32_16x16x32_bf16 v[20:23], v[44:47], v[236:239], v[20:23]
    s_waitcnt lgkmcnt(2)
    v_rcp_f32 v63, v63
    v_mfma_f32_16x16x32_bf16 v[24:27], v[48:51], v[240:243], v[8:11]
    s_add_u32 s21, s39, s22
    ds_read_b64_tr_b16 v[44:45], v82 offset:4096
    ds_read_b64_tr_b16 v[46:47], v82 offset:6144
    v_mfma_f32_16x16x32_bf16 v[28:31], v[48:51], v[244:247], v[12:15]
    s_add_u32 m0, s20, 147456
    v_mul_f32 v60, v36, v60
    v_mul_f32 v61, v37, v61
    v_mfma_f32_16x16x32_bf16 v[32:35], v[48:51], v[248:251], v[16:19]
    buffer_load_dwordx4 v80, s[4:7], s21 offen lds
    v_mul_f32 v62, v38, v62
    v_mul_f32 v63, v39, v63
    v_mfma_f32_16x16x32_bf16 v[36:39], v[48:51], v[252:255], v[20:23]
    s_waitcnt lgkmcnt(2)
    v_cvt_pk_bf16_f32 v74, v60, v61
    v_cvt_pk_bf16_f32 v75, v62, v63
    ds_write_b64 v84, v[74:75] offset:3072
    v_add_u32 v84, 0x2000, v84
    s_sub_u32 s25, s25, 1
    s_cmp_lg_u32 s25, 0
    s_cbranch_scc1 parallel_sum__ssm_conv_s4d__dense_activation_silu__prompt_kernel_la
    v_mfma_f32_16x16x32_bf16 v[8:11], v[40:43], a[0:3], 0
    ds_read_b64_tr_b16 v[48:49], v82 offset:8192
    ds_read_b64_tr_b16 v[50:51], v82 offset:10240
    v_mfma_f32_16x16x32_bf16 v[12:15], v[40:43], a[4:7], 0
    s_add_u32 m0, s20, 151552
    v_mfma_f32_16x16x32_bf16 v[16:19], v[40:43], a[8:11], 0
    buffer_load_dwordx4 v96, s[4:7], s21 offen lds
    v_mfma_f32_16x16x32_bf16 v[20:23], v[40:43], a[12:15], 0
    s_waitcnt vmcnt(10) lgkmcnt(3)
    v_mfma_f32_16x16x32_bf16 v[8:11], v[44:47], a[16:19], v[8:11]
    s_barrier
    ds_read_b64_tr_b16 v[40:41], v82 offset:12288
    ds_read_b64_tr_b16 v[42:43], v82 offset:14336
    v_mfma_f32_16x16x32_bf16 v[12:15], v[44:47], a[20:23], v[12:15]
    s_add_u32 s21, s40, s22
    s_add_u32 m0, s20, 155648
    v_exp_f32 v56, -v24
    v_mfma_f32_16x16x32_bf16 v[16:19], v[44:47], a[24:27], v[16:19]
    buffer_load_dwordx4 v80, s[4:7], s21 offen lds
    v_exp_f32 v57, -v25
    v_mfma_f32_16x16x32_bf16 v[20:23], v[44:47], a[28:31], v[20:23]
    s_waitcnt lgkmcnt(2)
    v_exp_f32 v58, -v26
    v_mfma_f32_16x16x32_bf16 v[8:11], v[48:51], a[32:35], v[8:11]
    ds_read_b64_tr_b16 v[44:45], v82 offset:16384
    ds_read_b64_tr_b16 v[46:47], v82 offset:18432
    v_mfma_f32_16x16x32_bf16 v[12:15], v[48:51], a[36:39], v[12:15]
    s_add_u32 m0, s20, 159744
    v_exp_f32 v59, -v27
    v_mfma_f32_16x16x32_bf16 v[16:19], v[48:51], a[40:43], v[16:19]
    buffer_load_dwordx4 v96, s[4:7], s21 offen lds
    v_fma_f32 v56, v56, s30, s30
    v_fma_f32 v57, v57, s30, s30
    v_mfma_f32_16x16x32_bf16 v[20:23], v[48:51], a[44:47], v[20:23]
    s_waitcnt lgkmcnt(2)
    v_fma_f32 v58, v58, s30, s30
    v_fma_f32 v59, v59, s30, s30
    v_mfma_f32_16x16x32_bf16 v[8:11], v[40:43], a[48:51], v[8:11]
    s_mov_b32 s22, s29
    s_mov_b32 s23, 0
    s_movk_i32 s24, 1152
    s_add_u32 s21, s41, s22
    ds_read_b64_tr_b16 v[48:49], v82 offset:20480
    ds_read_b64_tr_b16 v[50:51], v82 offset:22528
    v_mfma_f32_16x16x32_bf16 v[12:15], v[40:43], a[52:55], v[12:15]
    s_add_u32 m0, s20, 90112
    v_rcp_f32 v56, v56
    v_mfma_f32_16x16x32_bf16 v[16:19], v[40:43], a[56:59], v[16:19]
    buffer_load_dwordx4 v81, s[8:11], s21 offen lds
    v_rcp_f32 v57, v57
    v_mfma_f32_16x16x32_bf16 v[20:23], v[40:43], a[60:63], v[20:23]
    s_waitcnt vmcnt(10) lgkmcnt(2)
    v_rcp_f32 v58, v58
    v_mfma_f32_16x16x32_bf16 v[8:11], v[44:47], a[64:67], v[8:11]
    s_barrier
    ds_read_b64_tr_b16 v[40:41], v82 offset:24576
    ds_read_b64_tr_b16 v[42:43], v82 offset:26624
    v_mfma_f32_16x16x32_bf16 v[12:15], v[44:47], a[68:71], v[12:15]
    s_add_u32 m0, s20, 94208
    v_rcp_f32 v59, v59
    v_mfma_f32_16x16x32_bf16 v[16:19], v[44:47], a[72:75], v[16:19]
    buffer_load_dwordx4 v97, s[8:11], s21 offen lds
    v_mul_f32 v56, v24, v56
    v_mul_f32 v57, v25, v57
    v_mfma_f32_16x16x32_bf16 v[20:23], v[44:47], a[76:79], v[20:23]
    s_waitcnt lgkmcnt(2)
    v_mul_f32 v58, v26, v58
    v_mul_f32 v59, v27, v59
    v_cvt_pk_bf16_f32 v72, v56, v57
    v_cvt_pk_bf16_f32 v73, v58, v59
    v_mfma_f32_16x16x32_bf16 v[8:11], v[48:51], a[80:83], v[8:11]
    s_add_u32 s21, s42, s22
    ds_read_b64_tr_b16 v[44:45], v82 offset:28672
    ds_read_b64_tr_b16 v[46:47], v82 offset:30720
    v_mfma_f32_16x16x32_bf16 v[12:15], v[48:51], a[84:87], v[12:15]
    s_add_u32 m0, s20, 98304
    ds_write_b64 v84, v[72:73] offset:0
    v_mfma_f32_16x16x32_bf16 v[16:19], v[48:51], a[88:91], v[16:19]
    buffer_load_dwordx4 v81, s[8:11], s21 offen lds
    v_exp_f32 v60, -v28
    v_mfma_f32_16x16x32_bf16 v[20:23], v[48:51], a[92:95], v[20:23]
    s_waitcnt lgkmcnt(3)
    v_exp_f32 v61, -v29
    v_exp_f32 v62, -v30
    v_mfma_f32_16x16x32_bf16 v[8:11], v[40:43], a[96:99], v[8:11]
    ds_read_b64_tr_b16 v[48:49], v82 offset:32768
    ds_read_b64_tr_b16 v[50:51], v82 offset:34816
    v_mfma_f32_16x16x32_bf16 v[12:15], v[40:43], a[100:103], v[12:15]
    s_add_u32 m0, s20, 102400
    v_exp_f32 v63, -v31
    v_mfma_f32_16x16x32_bf16 v[16:19], v[40:43], a[104:107], v[16:19]
    buffer_load_dwordx4 v97, s[8:11], s21 offen lds
    v_fma_f32 v60, v60, s30, s30
    v_fma_f32 v61, v61, s30, s30
    v_mfma_f32_16x16x32_bf16 v[20:23], v[40:43], a[108:111], v[20:23]
    s_waitcnt vmcnt(10) lgkmcnt(3)
    v_fma_f32 v62, v62, s30, s30
    v_fma_f32 v63, v63, s30, s30
    v_mfma_f32_16x16x32_bf16 v[8:11], v[44:47], a[112:115], v[8:11]
    s_barrier
    ds_read_b64_tr_b16 v[40:41], v98 offset:0
    ds_read_b64_tr_b16 v[42:43], v98 offset:2048
    v_mfma_f32_16x16x32_bf16 v[12:15], v[44:47], a[116:119], v[12:15]
    s_add_u32 s21, s43, s22
    s_add_u32 m0, s20, 106496
    v_rcp_f32 v60, v60
    v_mfma_f32_16x16x32_bf16 v[16:19], v[44:47], a[120:123], v[16:19]
    buffer_load_dwordx4 v81, s[8:11], s21 offen lds
    v_rcp_f32 v61, v61
    v_mfma_f32_16x16x32_bf16 v[20:23], v[44:47], a[124:127], v[20:23]
    s_waitcnt lgkmcnt(2)
    v_rcp_f32 v62, v62
    v_mfma_f32_16x16x32_bf16 v[8:11], v[48:51], a[128:131], v[8:11]
    ds_read_b64_tr_b16 v[44:45], v98 offset:4096
    ds_read_b64_tr_b16 v[46:47], v98 offset:6144
    v_mfma_f32_16x16x32_bf16 v[12:15], v[48:51], a[132:135], v[12:15]
    s_add_u32 m0, s20, 110592
    v_rcp_f32 v63, v63
    v_mfma_f32_16x16x32_bf16 v[16:19], v[48:51], a[136:139], v[16:19]
    buffer_load_dwordx4 v97, s[8:11], s21 offen lds
    v_mul_f32 v60, v28, v60
    v_mul_f32 v61, v29, v61
    v_mfma_f32_16x16x32_bf16 v[20:23], v[48:51], a[140:143], v[20:23]
    s_waitcnt lgkmcnt(2)
    v_mul_f32 v62, v30, v62
    v_mul_f32 v63, v31, v63
    v_cvt_pk_bf16_f32 v74, v60, v61
    v_cvt_pk_bf16_f32 v75, v62, v63
    v_mfma_f32_16x16x32_bf16 v[8:11], v[40:43], a[144:147], v[8:11]
    s_add_u32 s21, s44, s22
    ds_read_b64_tr_b16 v[48:49], v98 offset:8192
    ds_read_b64_tr_b16 v[50:51], v98 offset:10240
    v_mfma_f32_16x16x32_bf16 v[12:15], v[40:43], a[148:151], v[12:15]
    s_add_u32 m0, s20, 114688
    ds_write_b64 v84, v[74:75] offset:1024
    v_mfma_f32_16x16x32_bf16 v[16:19], v[40:43], a[152:155], v[16:19]
    buffer_load_dwordx4 v81, s[8:11], s21 offen lds
    v_exp_f32 v56, -v32
    v_mfma_f32_16x16x32_bf16 v[20:23], v[40:43], a[156:159], v[20:23]
    s_waitcnt vmcnt(10) lgkmcnt(3)
    v_exp_f32 v57, -v33
    v_exp_f32 v58, -v34
    v_mfma_f32_16x16x32_bf16 v[8:11], v[44:47], a[160:163], v[8:11]
    s_barrier
    ds_read_b64_tr_b16 v[40:41], v98 offset:12288
    ds_read_b64_tr_b16 v[42:43], v98 offset:14336
    v_mfma_f32_16x16x32_bf16 v[12:15], v[44:47], a[164:167], v[12:15]
    s_add_u32 m0, s20, 118784
    v_exp_f32 v59, -v35
    v_mfma_f32_16x16x32_bf16 v[16:19], v[44:47], a[168:171], v[16:19]
    buffer_load_dwordx4 v97, s[8:11], s21 offen lds
    v_fma_f32 v56, v56, s30, s30
    v_fma_f32 v57, v57, s30, s30
    v_mfma_f32_16x16x32_bf16 v[20:23], v[44:47], a[172:175], v[20:23]
    s_waitcnt lgkmcnt(3)
    v_fma_f32 v58, v58, s30, s30
    v_fma_f32 v59, v59, s30, s30
    v_mfma_f32_16x16x32_bf16 v[8:11], v[48:51], a[176:179], v[8:11]
    s_add_u32 s21, s45, s22
    ds_read_b64_tr_b16 v[44:45], v98 offset:16384
    ds_read_b64_tr_b16 v[46:47], v98 offset:18432
    v_mfma_f32_16x16x32_bf16 v[12:15], v[48:51], a[180:183], v[12:15]
    s_add_u32 m0, s20, 122880
    v_rcp_f32 v56, v56
    v_mfma_f32_16x16x32_bf16 v[16:19], v[48:51], a[184:187], v[16:19]
    buffer_load_dwordx4 v81, s[8:11], s21 offen lds
    v_rcp_f32 v57, v57
    v_mfma_f32_16x16x32_bf16 v[20:23], v[48:51], a[188:191], v[20:23]
    s_waitcnt lgkmcnt(2)
    v_rcp_f32 v58, v58
    v_mfma_f32_16x16x32_bf16 v[8:11], v[40:43], a[192:195], v[8:11]
    ds_read_b64_tr_b16 v[48:49], v98 offset:20480
    ds_read_b64_tr_b16 v[50:51], v98 offset:22528
    v_mfma_f32_16x16x32_bf16 v[12:15], v[40:43], a[196:199], v[12:15]
    s_add_u32 m0, s20, 126976
    v_rcp_f32 v59, v59
    v_mfma_f32_16x16x32_bf16 v[16:19], v[40:43], a[200:203], v[16:19]
    buffer_load_dwordx4 v97, s[8:11], s21 offen lds
    v_mul_f32 v56, v32, v56
    v_mul_f32 v57, v33, v57
    v_mfma_f32_16x16x32_bf16 v[20:23], v[40:43], a[204:207], v[20:23]
    s_waitcnt vmcnt(10) lgkmcnt(2)
    v_mul_f32 v58, v34, v58
    v_mul_f32 v59, v35, v59
    v_cvt_pk_bf16_f32 v72, v56, v57
    v_cvt_pk_bf16_f32 v73, v58, v59
    v_mfma_f32_16x16x32_bf16 v[8:11], v[44:47], a[208:211], v[8:11]
    s_barrier
    ds_read_b64_tr_b16 v[40:41], v98 offset:24576
    ds_read_b64_tr_b16 v[42:43], v98 offset:26624
    v_mfma_f32_16x16x32_bf16 v[12:15], v[44:47], a[212:215], v[12:15]
    s_add_u32 s21, s46, s22
    s_add_u32 m0, s20, 131072
    ds_write_b64 v84, v[72:73] offset:2048
    v_mfma_f32_16x16x32_bf16 v[16:19], v[44:47], a[216:219], v[16:19]
    buffer_load_dwordx4 v81, s[8:11], s21 offen lds
    v_exp_f32 v60, -v36
    v_mfma_f32_16x16x32_bf16 v[20:23], v[44:47], a[220:223], v[20:23]
    s_waitcnt lgkmcnt(3)
    v_exp_f32 v61, -v37
    v_exp_f32 v62, -v38
    v_mfma_f32_16x16x32_bf16 v[8:11], v[48:51], a[224:227], v[8:11]
    ds_read_b64_tr_b16 v[44:45], v98 offset:28672
    ds_read_b64_tr_b16 v[46:47], v98 offset:30720
    v_mfma_f32_16x16x32_bf16 v[12:15], v[48:51], a[228:231], v[12:15]
    s_add_u32 m0, s20, 135168
    v_exp_f32 v63, -v39
    v_mfma_f32_16x16x32_bf16 v[16:19], v[48:51], a[232:235], v[16:19]
    buffer_load_dwordx4 v97, s[8:11], s21 offen lds
    v_fma_f32 v60, v60, s30, s30
    v_fma_f32 v61, v61, s30, s30
    v_mfma_f32_16x16x32_bf16 v[20:23], v[48:51], a[236:239], v[20:23]
    s_waitcnt lgkmcnt(3)
    v_fma_f32 v62, v62, s30, s30
    v_fma_f32 v63, v63, s30, s30
    v_mfma_f32_16x16x32_bf16 v[8:11], v[40:43], a[240:243], v[8:11]
    s_add_u32 s21, s47, s22
    ds_read_b64_tr_b16 v[48:49], v98 offset:32768
    ds_read_b64_tr_b16 v[50:51], v98 offset:34816
    v_mfma_f32_16x16x32_bf16 v[12:15], v[40:43], a[244:247], v[12:15]
    s_add_u32 m0, s20, 139264
    v_rcp_f32 v60, v60
    v_mfma_f32_16x16x32_bf16 v[16:19], v[40:43], a[248:251], v[16:19]
    buffer_load_dwordx4 v81, s[8:11], s21 offen lds
    v_rcp_f32 v61, v61
    v_mfma_f32_16x16x32_bf16 v[20:23], v[40:43], a[252:255], v[20:23]
    s_waitcnt vmcnt(10) lgkmcnt(2)
    v_rcp_f32 v62, v62
    v_rcp_f32 v63, v63
    v_mfma_f32_16x16x32_bf16 v[8:11], v[44:47], v[224:227], v[8:11]
    s_barrier
    ds_read_b64_tr_b16 v[40:41], v82 offset:0
    ds_read_b64_tr_b16 v[42:43], v82 offset:2048
    v_mfma_f32_16x16x32_bf16 v[12:15], v[44:47], v[228:231], v[12:15]
    s_add_u32 m0, s20, 143360
    ds_read_b128 a[0:3], v83 offset:0
    ds_read_b128 a[4:7], v83 offset:1024
    v_mfma_f32_16x16x32_bf16 v[16:19], v[44:47], v[232:235], v[16:19]
    buffer_load_dwordx4 v97, s[8:11], s21 offen lds
    ds_read_b128 a[8:11], v83 offset:2048
    ds_read_b128 a[12:15], v83 offset:3072
    v_mfma_f32_16x16x32_bf16 v[20:23], v[44:47], v[236:239], v[20:23]
    s_waitcnt lgkmcnt(6)
    v_mul_f32 v60, v36, v60
    v_mul_f32 v61, v37, v61
    v_mul_f32 v62, v38, v62
    v_mul_f32 v63, v39, v63
    v_cvt_pk_bf16_f32 v74, v60, v61
    v_cvt_pk_bf16_f32 v75, v62, v63
    ds_write_b64 v84, v[74:75] offset:3072
    v_add_u32 v84, 0x2000, v84
    v_mfma_f32_16x16x32_bf16 v[24:27], v[48:51], v[240:243], v[8:11]
    s_add_u32 s21, s48, s22
    ds_read_b64_tr_b16 v[44:45], v82 offset:4096
    ds_read_b64_tr_b16 v[46:47], v82 offset:6144
    v_mfma_f32_16x16x32_bf16 v[28:31], v[48:51], v[244:247], v[12:15]
    s_add_u32 m0, s20, 147456
    ds_read_b128 a[16:19], v220 offset:4096
    ds_read_b128 a[20:23], v220 offset:5120
    v_mfma_f32_16x16x32_bf16 v[32:35], v[48:51], v[248:251], v[16:19]
    buffer_load_dwordx4 v81, s[8:11], s21 offen lds
    ds_read_b128 a[24:27], v220 offset:6144
    ds_read_b128 a[28:31], v220 offset:7168
    v_mfma_f32_16x16x32_bf16 v[36:39], v[48:51], v[252:255], v[20:23]
    s_waitcnt lgkmcnt(7)
    v_mfma_f32_16x16x32_bf16 v[8:11], v[40:43], a[0:3], 0
    ds_read_b64_tr_b16 v[48:49], v82 offset:8192
    ds_read_b64_tr_b16 v[50:51], v82 offset:10240
    v_mfma_f32_16x16x32_bf16 v[12:15], v[40:43], a[4:7], 0
    s_add_u32 m0, s20, 151552
    ds_read_b128 a[32:35], v83 offset:8192
    ds_read_b128 a[36:39], v83 offset:9216
    v_mfma_f32_16x16x32_bf16 v[16:19], v[40:43], a[8:11], 0
    buffer_load_dwordx4 v97, s[8:11], s21 offen lds
    ds_read_b128 a[40:43], v83 offset:10240
    ds_read_b128 a[44:47], v83 offset:11264
    v_mfma_f32_16x16x32_bf16 v[20:23], v[40:43], a[12:15], 0
    s_waitcnt vmcnt(10) lgkmcnt(6)
    v_mfma_f32_16x16x32_bf16 v[8:11], v[44:47], a[16:19], v[8:11]
    s_barrier
    ds_read_b64_tr_b16 v[40:41], v82 offset:12288
    ds_read_b64_tr_b16 v[42:43], v82 offset:14336
    v_mfma_f32_16x16x32_bf16 v[12:15], v[44:47], a[20:23], v[12:15]
    s_add_u32 s21, s49, s22
    s_add_u32 m0, s20, 155648
    ds_read_b128 a[48:51], v220 offset:12288
    ds_read_b128 a[52:55], v220 offset:13312
    v_mfma_f32_16x16x32_bf16 v[16:19], v[44:47], a[24:27], v[16:19]
    buffer_load_dwordx4 v81, s[8:11], s21 offen lds
    ds_read_b128 a[56:59], v220 offset:14336
    ds_read_b128 a[60:63], v220 offset:15360
    v_mfma_f32_16x16x32_bf16 v[20:23], v[44:47], a[28:31], v[20:23]
    s_waitcnt lgkmcnt(6)
    v_exp_f32 v56, -v24
    v_exp_f32 v57, -v25
    v_exp_f32 v58, -v26
    v_exp_f32 v59, -v27
    v_mfma_f32_16x16x32_bf16 v[8:11], v[48:51], a[32:35], v[8:11]
    ds_read_b64_tr_b16 v[44:45], v82 offset:16384
    ds_read_b64_tr_b16 v[46:47], v82 offset:18432
    v_mfma_f32_16x16x32_bf16 v[12:15], v[48:51], a[36:39], v[12:15]
    s_add_u32 m0, s20, 159744
    ds_read_b128 a[64:67], v83 offset:16384
    ds_read_b128 a[68:71], v83 offset:17408
    v_mfma_f32_16x16x32_bf16 v[16:19], v[48:51], a[40:43], v[16:19]
    buffer_load_dwordx4 v97, s[8:11], s21 offen lds
    ds_read_b128 a[72:75], v83 offset:18432
    ds_read_b128 a[76:79], v83 offset:19456
    v_mfma_f32_16x16x32_bf16 v[20:23], v[48:51], a[44:47], v[20:23]
    s_waitcnt lgkmcnt(6)
    v_fma_f32 v56, v56, s30, s30
    v_fma_f32 v57, v57, s30, s30
    v_fma_f32 v58, v58, s30, s30
    v_fma_f32 v59, v59, s30, s30
    v_rcp_f32 v56, v56
    v_rcp_f32 v57, v57
    v_rcp_f32 v58, v58
    v_mfma_f32_16x16x32_bf16 v[8:11], v[40:43], a[48:51], v[8:11]
    s_add_u32 s22, s22, 128
    s_cmp_eq_u32 s22, s24
    s_cselect_b32 s22, s23, s22
    s_add_u32 s21, s41, s22
    ds_read_b64_tr_b16 v[48:49], v82 offset:20480
    ds_read_b64_tr_b16 v[50:51], v82 offset:22528
    v_mfma_f32_16x16x32_bf16 v[12:15], v[40:43], a[52:55], v[12:15]
    s_add_u32 m0, s20, 90112
    ds_read_b128 a[80:83], v220 offset:20480
    ds_read_b128 a[84:87], v220 offset:21504
    v_mfma_f32_16x16x32_bf16 v[16:19], v[40:43], a[56:59], v[16:19]
    buffer_load_dwordx4 v81, s[8:11], s21 offen lds
    ds_read_b128 a[88:91], v220 offset:22528
    ds_read_b128 a[92:95], v220 offset:23552
    v_mfma_f32_16x16x32_bf16 v[20:23], v[40:43], a[60:63], v[20:23]
    s_waitcnt vmcnt(10) lgkmcnt(6)
    v_rcp_f32 v59, v59
    v_mul_f32 v56, v24, v56
    v_mul_f32 v57, v25, v57
    v_mul_f32 v58, v26, v58
    v_mul_f32 v59, v27, v59
    v_cvt_pk_bf16_f32 v72, v56, v57
    v_cvt_pk_bf16_f32 v73, v58, v59
    v_mfma_f32_16x16x32_bf16 v[8:11], v[44:47], a[64:67], v[8:11]
    s_barrier
    ds_read_b64_tr_b16 v[40:41], v82 offset:24576
    ds_read_b64_tr_b16 v[42:43], v82 offset:26624
    v_mfma_f32_16x16x32_bf16 v[12:15], v[44:47], a[68:71], v[12:15]
    s_add_u32 m0, s20, 94208
    ds_read_b128 a[96:99], v83 offset:24576
    ds_read_b128 a[100:103], v83 offset:25600
    v_mfma_f32_16x16x32_bf16 v[16:19], v[44:47], a[72:75], v[16:19]
    buffer_load_dwordx4 v97, s[8:11], s21 offen lds
    ds_read_b128 a[104:107], v83 offset:26624
    ds_read_b128 a[108:111], v83 offset:27648
    v_mfma_f32_16x16x32_bf16 v[20:23], v[44:47], a[76:79], v[20:23]
    s_waitcnt lgkmcnt(6)
    ds_write_b64 v84, v[72:73] offset:0
    v_exp_f32 v60, -v28
    v_exp_f32 v61, -v29
    v_exp_f32 v62, -v30
    v_exp_f32 v63, -v31
    v_fma_f32 v60, v60, s30, s30
    v_fma_f32 v61, v61, s30, s30
    v_fma_f32 v62, v62, s30, s30
    v_mfma_f32_16x16x32_bf16 v[8:11], v[48:51], a[80:83], v[8:11]
    s_add_u32 s21, s42, s22
    ds_read_b64_tr_b16 v[44:45], v82 offset:28672
    ds_read_b64_tr_b16 v[46:47], v82 offset:30720
    v_mfma_f32_16x16x32_bf16 v[12:15], v[48:51], a[84:87], v[12:15]
    s_add_u32 m0, s20, 98304
    ds_read_b128 a[112:115], v220 offset:28672
    ds_read_b128 a[116:119], v220 offset:29696
    v_mfma_f32_16x16x32_bf16 v[16:19], v[48:51], a[88:91], v[16:19]
    buffer_load_dwordx4 v81, s[8:11], s21 offen lds
    ds_read_b128 a[120:123], v220 offset:30720
    ds_read_b128 a[124:127], v220 offset:31744
    v_mfma_f32_16x16x32_bf16 v[20:23], v[48:51], a[92:95], v[20:23]
    s_waitcnt lgkmcnt(7)
    v_fma_f32 v63, v63, s30, s30
    v_rcp_f32 v60, v60
    v_rcp_f32 v61, v61
    v_rcp_f32 v62, v62
    v_rcp_f32 v63, v63
    v_mul_f32 v60, v28, v60
    v_mfma_f32_16x16x32_bf16 v[8:11], v[40:43], a[96:99], v[8:11]
    ds_read_b64_tr_b16 v[48:49], v82 offset:32768
    ds_read_b64_tr_b16 v[50:51], v82 offset:34816
    v_mfma_f32_16x16x32_bf16 v[12:15], v[40:43], a[100:103], v[12:15]
    s_add_u32 m0, s20, 102400
    ds_read_b128 a[128:131], v83 offset:32768
    ds_read_b128 a[132:135], v83 offset:33792
    v_mfma_f32_16x16x32_bf16 v[16:19], v[40:43], a[104:107], v[16:19]
    buffer_load_dwordx4 v97, s[8:11], s21 offen lds
    ds_read_b128 a[136:139], v83 offset:34816
    ds_read_b128 a[140:143], v83 offset:35840
    v_mfma_f32_16x16x32_bf16 v[20:23], v[40:43], a[108:111], v[20:23]
    s_waitcnt vmcnt(10) lgkmcnt(6)
    v_mul_f32 v61, v29, v61
    v_mul_f32 v62, v30, v62
    v_mul_f32 v63, v31, v63
    v_cvt_pk_bf16_f32 v74, v60, v61
    v_cvt_pk_bf16_f32 v75, v62, v63
    v_mfma_f32_16x16x32_bf16 v[8:11], v[44:47], a[112:115], v[8:11]
    s_barrier
    ds_read_b64_tr_b16 v[40:41], v98 offset:0
    ds_read_b64_tr_b16 v[42:43], v98 offset:2048
    v_mfma_f32_16x16x32_bf16 v[12:15], v[44:47], a[116:119], v[12:15]
    s_add_u32 s21, s43, s22
    s_add_u32 m0, s20, 106496
    ds_read_b128 a[144:147], v220 offset:36864
    ds_read_b128 a[148:151], v220 offset:37888
    v_mfma_f32_16x16x32_bf16 v[16:19], v[44:47], a[120:123], v[16:19]
    buffer_load_dwordx4 v81, s[8:11], s21 offen lds
    ds_read_b128 a[152:155], v220 offset:38912
    ds_read_b128 a[156:159], v220 offset:39936
    v_mfma_f32_16x16x32_bf16 v[20:23], v[44:47], a[124:127], v[20:23]
    s_waitcnt lgkmcnt(6)
    ds_write_b64 v84, v[74:75] offset:1024
    v_exp_f32 v56, -v32
    v_exp_f32 v57, -v33
    v_exp_f32 v58, -v34
    v_exp_f32 v59, -v35
    v_fma_f32 v56, v56, s30, s30
    v_fma_f32 v57, v57, s30, s30
    v_fma_f32 v58, v58, s30, s30
    v_fma_f32 v59, v59, s30, s30
    v_rcp_f32 v56, v56
    v_mfma_f32_16x16x32_bf16 v[8:11], v[48:51], a[128:131], v[8:11]
    ds_read_b64_tr_b16 v[44:45], v98 offset:4096
    ds_read_b64_tr_b16 v[46:47], v98 offset:6144
    v_mfma_f32_16x16x32_bf16 v[12:15], v[48:51], a[132:135], v[12:15]
    s_add_u32 m0, s20, 110592
    ds_read_b128 a[160:163], v221 offset:0
    ds_read_b128 a[164:167], v221 offset:1024
    v_mfma_f32_16x16x32_bf16 v[16:19], v[48:51], a[136:139], v[16:19]
    buffer_load_dwordx4 v97, s[8:11], s21 offen lds
    ds_read_b128 a[168:171], v221 offset:2048
    ds_read_b128 a[172:175], v221 offset:3072
    v_mfma_f32_16x16x32_bf16 v[20:23], v[48:51], a[140:143], v[20:23]
    s_waitcnt lgkmcnt(7)
    v_rcp_f32 v57, v57
    v_rcp_f32 v58, v58
    v_rcp_f32 v59, v59
    v_mul_f32 v56, v32, v56
    v_mul_f32 v57, v33, v57
    v_mul_f32 v58, v34, v58
    v_mul_f32 v59, v35, v59
    v_mfma_f32_16x16x32_bf16 v[8:11], v[40:43], a[144:147], v[8:11]
    s_add_u32 s21, s44, s22
    ds_read_b64_tr_b16 v[48:49], v98 offset:8192
    ds_read_b64_tr_b16 v[50:51], v98 offset:10240
    v_mfma_f32_16x16x32_bf16 v[12:15], v[40:43], a[148:151], v[12:15]
    s_add_u32 m0, s20, 114688
    ds_read_b128 a[176:179], v222 offset:4096
    ds_read_b128 a[180:183], v222 offset:5120
    v_mfma_f32_16x16x32_bf16 v[16:19], v[40:43], a[152:155], v[16:19]
    buffer_load_dwordx4 v81, s[8:11], s21 offen lds
    ds_read_b128 a[184:187], v222 offset:6144
    ds_read_b128 a[188:191], v222 offset:7168
    v_mfma_f32_16x16x32_bf16 v[20:23], v[40:43], a[156:159], v[20:23]
    s_waitcnt vmcnt(10) lgkmcnt(6)
    v_cvt_pk_bf16_f32 v72, v56, v57
    v_cvt_pk_bf16_f32 v73, v58, v59
    v_mfma_f32_16x16x32_bf16 v[8:11], v[44:47], a[160:163], v[8:11]
    s_barrier
    ds_read_b64_tr_b16 v[40:41], v98 offset:12288
    ds_read_b64_tr_b16 v[42:43], v98 offset:14336
    v_mfma_f32_16x16x32_bf16 v[12:15], v[44:47], a[164:167], v[12:15]
    s_add_u32 m0, s20, 118784
    ds_read_b128 a[192:195], v221 offset:8192
    ds_read_b128 a[196:199], v221 offset:9216
    v_mfma_f32_16x16x32_bf16 v[16:19], v[44:47], a[168:171], v[16:19]
    buffer_load_dwordx4 v97, s[8:11], s21 offen lds
    ds_read_b128 a[200:203], v221 offset:10240
    ds_read_b128 a[204:207], v221 offset:11264
    v_mfma_f32_16x16x32_bf16 v[20:23], v[44:47], a[172:175], v[20:23]
    s_waitcnt lgkmcnt(6)
    ds_write_b64 v84, v[72:73] offset:2048
    v_exp_f32 v60, -v36
    v_exp_f32 v61, -v37
    v_exp_f32 v62, -v38
    v_exp_f32 v63, -v39
    v_fma_f32 v60, v60, s30, s30
    v_fma_f32 v61, v61, s30, s30
    v_fma_f32 v62, v62, s30, s30
    v_fma_f32 v63, v63, s30, s30
    v_rcp_f32 v60, v60
    v_rcp_f32 v61, v61
    v_mfma_f32_16x16x32_bf16 v[8:11], v[48:51], a[176:179], v[8:11]
    s_add_u32 s21, s45, s22
    ds_read_b64_tr_b16 v[44:45], v98 offset:16384
    ds_read_b64_tr_b16 v[46:47], v98 offset:18432
    v_mfma_f32_16x16x32_bf16 v[12:15], v[48:51], a[180:183], v[12:15]
    s_add_u32 m0, s20, 122880
    ds_read_b128 a[208:211], v222 offset:12288
    ds_read_b128 a[212:215], v222 offset:13312
    v_mfma_f32_16x16x32_bf16 v[16:19], v[48:51], a[184:187], v[16:19]
    buffer_load_dwordx4 v81, s[8:11], s21 offen lds
    ds_read_b128 a[216:219], v222 offset:14336
    ds_read_b128 a[220:223], v222 offset:15360
    v_mfma_f32_16x16x32_bf16 v[20:23], v[48:51], a[188:191], v[20:23]
    s_waitcnt lgkmcnt(7)
    v_rcp_f32 v62, v62
    v_rcp_f32 v63, v63
    v_mul_f32 v60, v36, v60
    v_mul_f32 v61, v37, v61
    v_mul_f32 v62, v38, v62
    v_mul_f32 v63, v39, v63
    v_cvt_pk_bf16_f32 v74, v60, v61
    v_cvt_pk_bf16_f32 v75, v62, v63
    ds_write_b64 v84, v[74:75] offset:3072
    v_add_u32 v84, 0x2000, v84
    v_mfma_f32_16x16x32_bf16 v[8:11], v[40:43], a[192:195], v[8:11]
    ds_read_b64_tr_b16 v[48:49], v98 offset:20480
    ds_read_b64_tr_b16 v[50:51], v98 offset:22528
    buffer_load_dword v70, v95, s[12:15], 0 offen sc1
    v_mfma_f32_16x16x32_bf16 v[12:15], v[40:43], a[196:199], v[12:15]
    s_add_u32 m0, s20, 126976
    ds_read_b128 a[224:227], v221 offset:16384
    ds_read_b128 a[228:231], v221 offset:17408
    v_mfma_f32_16x16x32_bf16 v[16:19], v[40:43], a[200:203], v[16:19]
    buffer_load_dwordx4 v97, s[8:11], s21 offen lds
    ds_read_b128 a[232:235], v221 offset:18432
    ds_read_b128 a[236:239], v221 offset:19456
    v_mfma_f32_16x16x32_bf16 v[20:23], v[40:43], a[204:207], v[20:23]
    s_waitcnt vmcnt(11) lgkmcnt(6)
    v_mfma_f32_16x16x32_bf16 v[8:11], v[44:47], a[208:211], v[8:11]
    s_barrier
    ds_read_b64_tr_b16 v[40:41], v98 offset:24576
    ds_read_b64_tr_b16 v[42:43], v98 offset:26624
    v_mfma_f32_16x16x32_bf16 v[12:15], v[44:47], a[212:215], v[12:15]
    s_add_u32 s21, s46, s22
    s_add_u32 m0, s20, 131072
    ds_read_b128 a[240:243], v222 offset:20480
    ds_read_b128 a[244:247], v222 offset:21504
    v_mfma_f32_16x16x32_bf16 v[16:19], v[44:47], a[216:219], v[16:19]
    buffer_load_dwordx4 v81, s[8:11], s21 offen lds
    ds_read_b128 a[248:251], v222 offset:22528
    ds_read_b128 a[252:255], v222 offset:23552
    v_mfma_f32_16x16x32_bf16 v[20:23], v[44:47], a[220:223], v[20:23]
    s_waitcnt lgkmcnt(6)
    v_mfma_f32_16x16x32_bf16 v[8:11], v[48:51], a[224:227], v[8:11]
    ds_read_b64_tr_b16 v[44:45], v98 offset:28672
    ds_read_b64_tr_b16 v[46:47], v98 offset:30720
    v_mfma_f32_16x16x32_bf16 v[12:15], v[48:51], a[228:231], v[12:15]
    s_add_u32 m0, s20, 135168
    ds_read_b128 v[224:227], v221 offset:24576
    ds_read_b128 v[228:231], v221 offset:25600
    v_mfma_f32_16x16x32_bf16 v[16:19], v[48:51], a[232:235], v[16:19]
    buffer_load_dwordx4 v97, s[8:11], s21 offen lds
    ds_read_b128 v[232:235], v221 offset:26624
    ds_read_b128 v[236:239], v221 offset:27648
    v_mfma_f32_16x16x32_bf16 v[20:23], v[48:51], a[236:239], v[20:23]
    s_waitcnt lgkmcnt(6)
    v_mfma_f32_16x16x32_bf16 v[8:11], v[40:43], a[240:243], v[8:11]
    s_add_u32 s21, s47, s22
    ds_read_b64_tr_b16 v[48:49], v98 offset:32768
    ds_read_b64_tr_b16 v[50:51], v98 offset:34816
    v_mfma_f32_16x16x32_bf16 v[12:15], v[40:43], a[244:247], v[12:15]
    s_add_u32 m0, s20, 139264
    ds_read_b128 v[240:243], v222 offset:28672
    ds_read_b128 v[244:247], v222 offset:29696
    v_mfma_f32_16x16x32_bf16 v[16:19], v[40:43], a[248:251], v[16:19]
    buffer_load_dwordx4 v81, s[8:11], s21 offen lds
    ds_read_b128 v[248:251], v222 offset:30720
    ds_read_b128 v[252:255], v222 offset:31744
    v_mfma_f32_16x16x32_bf16 v[20:23], v[40:43], a[252:255], v[20:23]
    s_waitcnt vmcnt(11) lgkmcnt(6)
    v_mfma_f32_16x16x32_bf16 v[8:11], v[44:47], v[224:227], v[8:11]
    s_barrier
    ds_read_b64_tr_b16 v[40:41], v82 offset:0
    ds_read_b64_tr_b16 v[42:43], v82 offset:2048
    v_mfma_f32_16x16x32_bf16 v[12:15], v[44:47], v[228:231], v[12:15]
    s_add_u32 m0, s20, 143360
    v_mfma_f32_16x16x32_bf16 v[16:19], v[44:47], v[232:235], v[16:19]
    buffer_load_dwordx4 v97, s[8:11], s21 offen lds
    v_mfma_f32_16x16x32_bf16 v[20:23], v[44:47], v[236:239], v[20:23]
    s_waitcnt lgkmcnt(2)
    v_mfma_f32_16x16x32_bf16 v[24:27], v[48:51], v[240:243], v[8:11]
    s_add_u32 s21, s48, s22
    ds_read_b64_tr_b16 v[44:45], v82 offset:4096
    ds_read_b64_tr_b16 v[46:47], v82 offset:6144
    v_mfma_f32_16x16x32_bf16 v[28:31], v[48:51], v[244:247], v[12:15]
    s_add_u32 m0, s20, 147456
    v_mfma_f32_16x16x32_bf16 v[32:35], v[48:51], v[248:251], v[16:19]
    buffer_load_dwordx4 v81, s[8:11], s21 offen lds
    v_mfma_f32_16x16x32_bf16 v[36:39], v[48:51], v[252:255], v[20:23]
    s_waitcnt lgkmcnt(2)
    s_mov_b32 s25, 7
.p2align 5
parallel_sum__ssm_conv_s4d__dense_activation_silu__prompt_kernel_lb:
    v_mfma_f32_16x16x32_bf16 v[8:11], v[40:43], a[0:3], 0
    ds_read_b64_tr_b16 v[48:49], v82 offset:8192
    ds_read_b64_tr_b16 v[50:51], v82 offset:10240
    v_mfma_f32_16x16x32_bf16 v[12:15], v[40:43], a[4:7], 0
    s_add_u32 m0, s20, 151552
    v_mfma_f32_16x16x32_bf16 v[16:19], v[40:43], a[8:11], 0
    buffer_load_dwordx4 v97, s[8:11], s21 offen lds
    v_mfma_f32_16x16x32_bf16 v[20:23], v[40:43], a[12:15], 0
    s_waitcnt vmcnt(11) lgkmcnt(2)
    v_mfma_f32_16x16x32_bf16 v[8:11], v[44:47], a[16:19], v[8:11]
    s_barrier
    ds_read_b64_tr_b16 v[40:41], v82 offset:12288
    ds_read_b64_tr_b16 v[42:43], v82 offset:14336
    v_mfma_f32_16x16x32_bf16 v[12:15], v[44:47], a[20:23], v[12:15]
    s_add_u32 s21, s49, s22
    s_add_u32 m0, s20, 155648
    v_cvt_pk_bf16_f32 v72, v24, v25
    v_cvt_pk_bf16_f32 v73, v26, v27
    v_mfma_f32_16x16x32_bf16 v[16:19], v[44:47], a[24:27], v[16:19]
    buffer_load_dwordx4 v81, s[8:11], s21 offen lds
    v_mfma_f32_16x16x32_bf16 v[20:23], v[44:47], a[28:31], v[20:23]
    s_waitcnt lgkmcnt(2)
    v_mfma_f32_16x16x32_bf16 v[8:11], v[48:51], a[32:35], v[8:11]
    ds_read_b64_tr_b16 v[44:45], v82 offset:16384
    ds_read_b64_tr_b16 v[46:47], v82 offset:18432
    v_mfma_f32_16x16x32_bf16 v[12:15], v[48:51], a[36:39], v[12:15]
    s_add_u32 m0, s20, 159744
    v_cvt_pk_bf16_f32 v74, v28, v29
    v_mfma_f32_16x16x32_bf16 v[16:19], v[48:51], a[40:43], v[16:19]
    buffer_load_dwordx4 v97, s[8:11], s21 offen lds
    v_mfma_f32_16x16x32_bf16 v[20:23], v[48:51], a[44:47], v[20:23]
    s_waitcnt lgkmcnt(2)
    v_mfma_f32_16x16x32_bf16 v[8:11], v[40:43], a[48:51], v[8:11]
    s_add_u32 s22, s22, 128
    s_cmp_eq_u32 s22, s24
    s_cselect_b32 s22, s23, s22
    s_add_u32 s21, s41, s22
    ds_read_b64_tr_b16 v[48:49], v82 offset:20480
    ds_read_b64_tr_b16 v[50:51], v82 offset:22528
    v_mfma_f32_16x16x32_bf16 v[12:15], v[40:43], a[52:55], v[12:15]
    s_add_u32 m0, s20, 90112
    v_cvt_pk_bf16_f32 v75, v30, v31
    s_nop 1
    v_permlane16_swap_b32 v72, v74
    v_mfma_f32_16x16x32_bf16 v[16:19], v[40:43], a[56:59], v[16:19]
    buffer_load_dwordx4 v81, s[8:11], s21 offen lds
    v_mfma_f32_16x16x32_bf16 v[20:23], v[40:43], a[60:63], v[20:23]
    s_waitcnt vmcnt(10) lgkmcnt(2)
    v_mfma_f32_16x16x32_bf16 v[8:11], v[44:47], a[64:67], v[8:11]
    s_barrier
    ds_read_b64_tr_b16 v[40:41], v82 offset:24576
    ds_read_b64_tr_b16 v[42:43], v82 offset:26624
    v_mfma_f32_16x16x32_bf16 v[12:15], v[44:47], a[68:71], v[12:15]
    s_add_u32 m0, s20, 94208
    v_permlane16_swap_b32 v73, v75
    v_mfma_f32_16x16x32_bf16 v[16:19], v[44:47], a[72:75], v[16:19]
    buffer_load_dwordx4 v97, s[8:11], s21 offen lds
    v_mfma_f32_16x16x32_bf16 v[20:23], v[44:47], a[76:79], v[20:23]
    s_waitcnt lgkmcnt(2)
    v_mfma_f32_16x16x32_bf16 v[8:11], v[48:51], a[80:83], v[8:11]
    s_add_u32 s21, s42, s22
    ds_read_b64_tr_b16 v[44:45], v82 offset:28672
    ds_read_b64_tr_b16 v[46:47], v82 offset:30720
    buffer_store_dwordx4 v[72:75], v99, s[12:15], s26 offen offset:0 sc1
    v_mfma_f32_16x16x32_bf16 v[12:15], v[48:51], a[84:87], v[12:15]
    s_add_u32 m0, s20, 98304
    v_cvt_pk_bf16_f32 v76, v32, v33
    v_cvt_pk_bf16_f32 v77, v34, v35
    v_mfma_f32_16x16x32_bf16 v[16:19], v[48:51], a[88:91], v[16:19]
    buffer_load_dwordx4 v81, s[8:11], s21 offen lds
    v_mfma_f32_16x16x32_bf16 v[20:23], v[48:51], a[92:95], v[20:23]
    s_waitcnt lgkmcnt(2)
    v_mfma_f32_16x16x32_bf16 v[8:11], v[40:43], a[96:99], v[8:11]
    ds_read_b64_tr_b16 v[48:49], v82 offset:32768
    ds_read_b64_tr_b16 v[50:51], v82 offset:34816
    v_mfma_f32_16x16x32_bf16 v[12:15], v[40:43], a[100:103], v[12:15]
    s_add_u32 m0, s20, 102400
    v_cvt_pk_bf16_f32 v78, v36, v37
    v_mfma_f32_16x16x32_bf16 v[16:19], v[40:43], a[104:107], v[16:19]
    buffer_load_dwordx4 v97, s[8:11], s21 offen lds
    v_mfma_f32_16x16x32_bf16 v[20:23], v[40:43], a[108:111], v[20:23]
    s_waitcnt vmcnt(11) lgkmcnt(2)
    v_mfma_f32_16x16x32_bf16 v[8:11], v[44:47], a[112:115], v[8:11]
    s_barrier
    ds_read_b64_tr_b16 v[40:41], v98 offset:0
    ds_read_b64_tr_b16 v[42:43], v98 offset:2048
    v_mfma_f32_16x16x32_bf16 v[12:15], v[44:47], a[116:119], v[12:15]
    s_add_u32 s21, s43, s22
    s_add_u32 m0, s20, 106496
    v_cvt_pk_bf16_f32 v79, v38, v39
    s_nop 1
    v_permlane16_swap_b32 v76, v78
    v_mfma_f32_16x16x32_bf16 v[16:19], v[44:47], a[120:123], v[16:19]
    buffer_load_dwordx4 v81, s[8:11], s21 offen lds
    v_mfma_f32_16x16x32_bf16 v[20:23], v[44:47], a[124:127], v[20:23]
    s_waitcnt lgkmcnt(2)
    v_mfma_f32_16x16x32_bf16 v[8:11], v[48:51], a[128:131], v[8:11]
    ds_read_b64_tr_b16 v[44:45], v98 offset:4096
    ds_read_b64_tr_b16 v[46:47], v98 offset:6144
    v_mfma_f32_16x16x32_bf16 v[12:15], v[48:51], a[132:135], v[12:15]
    s_add_u32 m0, s20, 110592
    v_permlane16_swap_b32 v77, v79
    v_mfma_f32_16x16x32_bf16 v[16:19], v[48:51], a[136:139], v[16:19]
    buffer_load_dwordx4 v97, s[8:11], s21 offen lds
    v_mfma_f32_16x16x32_bf16 v[20:23], v[48:51], a[140:143], v[20:23]
    s_waitcnt lgkmcnt(2)
    buffer_store_dwordx4 v[76:79], v99, s[12:15], s26 offen offset:1024 sc1
    s_add_u32 s26, s26, 0x2000
    s_cmp_eq_u32 s26, s28
    s_cselect_b32 s26, s27, s26
    v_mfma_f32_16x16x32_bf16 v[8:11], v[40:43], a[144:147], v[8:11]
    s_add_u32 s21, s44, s22
    ds_read_b64_tr_b16 v[48:49], v98 offset:8192
    ds_read_b64_tr_b16 v[50:51], v98 offset:10240
    v_mfma_f32_16x16x32_bf16 v[12:15], v[40:43], a[148:151], v[12:15]
    s_add_u32 m0, s20, 114688
    v_mfma_f32_16x16x32_bf16 v[16:19], v[40:43], a[152:155], v[16:19]
    buffer_load_dwordx4 v81, s[8:11], s21 offen lds
    v_mfma_f32_16x16x32_bf16 v[20:23], v[40:43], a[156:159], v[20:23]
    s_waitcnt vmcnt(12) lgkmcnt(2)
    v_mfma_f32_16x16x32_bf16 v[8:11], v[44:47], a[160:163], v[8:11]
    s_barrier
    ds_read_b64_tr_b16 v[40:41], v98 offset:12288
    ds_read_b64_tr_b16 v[42:43], v98 offset:14336
    v_mfma_f32_16x16x32_bf16 v[12:15], v[44:47], a[164:167], v[12:15]
    s_add_u32 m0, s20, 118784
    v_mfma_f32_16x16x32_bf16 v[16:19], v[44:47], a[168:171], v[16:19]
    buffer_load_dwordx4 v97, s[8:11], s21 offen lds
    v_mfma_f32_16x16x32_bf16 v[20:23], v[44:47], a[172:175], v[20:23]
    s_waitcnt lgkmcnt(2)
    v_mfma_f32_16x16x32_bf16 v[8:11], v[48:51], a[176:179], v[8:11]
    s_add_u32 s21, s45, s22
    ds_read_b64_tr_b16 v[44:45], v98 offset:16384
    ds_read_b64_tr_b16 v[46:47], v98 offset:18432
    v_mfma_f32_16x16x32_bf16 v[12:15], v[48:51], a[180:183], v[12:15]
    s_add_u32 m0, s20, 122880
    v_mfma_f32_16x16x32_bf16 v[16:19], v[48:51], a[184:187], v[16:19]
    buffer_load_dwordx4 v81, s[8:11], s21 offen lds
    v_mfma_f32_16x16x32_bf16 v[20:23], v[48:51], a[188:191], v[20:23]
    s_waitcnt lgkmcnt(2)
    v_mfma_f32_16x16x32_bf16 v[8:11], v[40:43], a[192:195], v[8:11]
    ds_read_b64_tr_b16 v[48:49], v98 offset:20480
    ds_read_b64_tr_b16 v[50:51], v98 offset:22528
    v_mfma_f32_16x16x32_bf16 v[12:15], v[40:43], a[196:199], v[12:15]
    s_add_u32 m0, s20, 126976
    v_mfma_f32_16x16x32_bf16 v[16:19], v[40:43], a[200:203], v[16:19]
    buffer_load_dwordx4 v97, s[8:11], s21 offen lds
    v_mfma_f32_16x16x32_bf16 v[20:23], v[40:43], a[204:207], v[20:23]
    s_waitcnt vmcnt(12) lgkmcnt(2)
    v_mfma_f32_16x16x32_bf16 v[8:11], v[44:47], a[208:211], v[8:11]
    s_barrier
    ds_read_b64_tr_b16 v[40:41], v98 offset:24576
    ds_read_b64_tr_b16 v[42:43], v98 offset:26624
    v_mfma_f32_16x16x32_bf16 v[12:15], v[44:47], a[212:215], v[12:15]
    s_add_u32 s21, s46, s22
    s_add_u32 m0, s20, 131072
    v_mfma_f32_16x16x32_bf16 v[16:19], v[44:47], a[216:219], v[16:19]
    buffer_load_dwordx4 v81, s[8:11], s21 offen lds
    v_mfma_f32_16x16x32_bf16 v[20:23], v[44:47], a[220:223], v[20:23]
    s_waitcnt lgkmcnt(2)
    v_mfma_f32_16x16x32_bf16 v[8:11], v[48:51], a[224:227], v[8:11]
    ds_read_b64_tr_b16 v[44:45], v98 offset:28672
    ds_read_b64_tr_b16 v[46:47], v98 offset:30720
    v_mfma_f32_16x16x32_bf16 v[12:15], v[48:51], a[228:231], v[12:15]
    s_add_u32 m0, s20, 135168
    v_mfma_f32_16x16x32_bf16 v[16:19], v[48:51], a[232:235], v[16:19]
    buffer_load_dwordx4 v97, s[8:11], s21 offen lds
    v_mfma_f32_16x16x32_bf16 v[20:23], v[48:51], a[236:239], v[20:23]
    s_waitcnt lgkmcnt(2)
    v_mfma_f32_16x16x32_bf16 v[8:11], v[40:43], a[240:243], v[8:11]
    s_add_u32 s21, s47, s22
    ds_read_b64_tr_b16 v[48:49], v98 offset:32768
    ds_read_b64_tr_b16 v[50:51], v98 offset:34816
    v_mfma_f32_16x16x32_bf16 v[12:15], v[40:43], a[244:247], v[12:15]
    s_add_u32 m0, s20, 139264
    v_mfma_f32_16x16x32_bf16 v[16:19], v[40:43], a[248:251], v[16:19]
    buffer_load_dwordx4 v81, s[8:11], s21 offen lds
    v_mfma_f32_16x16x32_bf16 v[20:23], v[40:43], a[252:255], v[20:23]
    s_waitcnt vmcnt(11) lgkmcnt(2)
    v_mfma_f32_16x16x32_bf16 v[8:11], v[44:47], v[224:227], v[8:11]
    s_barrier
    ds_read_b64_tr_b16 v[40:41], v82 offset:0
    ds_read_b64_tr_b16 v[42:43], v82 offset:2048
    v_mfma_f32_16x16x32_bf16 v[12:15], v[44:47], v[228:231], v[12:15]
    s_add_u32 m0, s20, 143360
    v_mfma_f32_16x16x32_bf16 v[16:19], v[44:47], v[232:235], v[16:19]
    buffer_load_dwordx4 v97, s[8:11], s21 offen lds
    v_mfma_f32_16x16x32_bf16 v[20:23], v[44:47], v[236:239], v[20:23]
    s_waitcnt lgkmcnt(2)
    v_mfma_f32_16x16x32_bf16 v[24:27], v[48:51], v[240:243], v[8:11]
    s_add_u32 s21, s48, s22
    ds_read_b64_tr_b16 v[44:45], v82 offset:4096
    ds_read_b64_tr_b16 v[46:47], v82 offset:6144
    v_mfma_f32_16x16x32_bf16 v[28:31], v[48:51], v[244:247], v[12:15]
    s_add_u32 m0, s20, 147456
    v_mfma_f32_16x16x32_bf16 v[32:35], v[48:51], v[248:251], v[16:19]
    buffer_load_dwordx4 v81, s[8:11], s21 offen lds
    v_mfma_f32_16x16x32_bf16 v[36:39], v[48:51], v[252:255], v[20:23]
    s_waitcnt lgkmcnt(2)
    s_sub_u32 s25, s25, 1
    s_cmp_lg_u32 s25, 0
    s_cbranch_scc1 parallel_sum__ssm_conv_s4d__dense_activation_silu__prompt_kernel_lb
    s_load_dwordx2 s[4:5], s[0:1], 0
    s_mov_b32 s25, 0x40000
parallel_sum__ssm_conv_s4d__dense_activation_silu__prompt_kernel_poll:
    v_cmp_ne_u32 vcc, s61, v70
    s_sub_u32 s25, s25, 1
    s_cbranch_scc1 parallel_sum__ssm_conv_s4d__dense_activation_silu__prompt_kernel_polled
    s_nop 3
    s_cbranch_vccz parallel_sum__ssm_conv_s4d__dense_activation_silu__prompt_kernel_polled
    buffer_load_dword v70, v95, s[12:15], 0 offen sc1
    s_waitcnt vmcnt(0)
    s_branch parallel_sum__ssm_conv_s4d__dense_activation_silu__prompt_kernel_poll
parallel_sum__ssm_conv_s4d__dense_activation_silu__prompt_kernel_polled:
    s_cmp_lg_u32 s2, 253
    s_cbranch_scc1 parallel_sum__ssm_conv_s4d__dense_activation_silu__prompt_kernel_nrs
    s_barrier
    v_mov_b32 v70, 0
    buffer_store_dword v70, v93, s[16:19], 0 offen sc1
parallel_sum__ssm_conv_s4d__dense_activation_silu__prompt_kernel_nrs:
    s_waitcnt lgkmcnt(0)
    v_mfma_f32_16x16x32_bf16 v[8:11], v[40:43], a[0:3], 0
    ds_read_b64_tr_b16 v[48:49], v82 offset:8192
    ds_read_b64_tr_b16 v[50:51], v82 offset:10240
    v_mfma_f32_16x16x32_bf16 v[12:15], v[40:43], a[4:7], 0
    s_add_u32 m0, s20, 151552
    v_mfma_f32_16x16x32_bf16 v[16:19], v[40:43], a[8:11], 0
    buffer_load_dwordx4 v97, s[8:11], s21 offen lds
    v_mfma_f32_16x16x32_bf16 v[20:23], v[40:43], a[12:15], 0
    s_waitcnt vmcnt(11)
    v_mfma_f32_16x16x32_bf16 v[8:11], v[44:47], a[16:19], v[8:11]
    s_barrier
    ds_read_b64_tr_b16 v[40:41], v82 offset:12288
    ds_read_b64_tr_b16 v[42:43], v82 offset:14336
    v_mfma_f32_16x16x32_bf16 v[12:15], v[44:47], a[20:23], v[12:15]
    s_add_u32 s21, s49, s22
    s_add_u32 m0, s20, 155648
    v_cvt_pk_bf16_f32 v72, v24, v25
    v_cvt_pk_bf16_f32 v73, v26, v27
    v_mfma_f32_16x16x32_bf16 v[16:19], v[44:47], a[24:27], v[16:19]
    buffer_load_dwordx4 v81, s[8:11], s21 offen lds
    v_mfma_f32_16x16x32_bf16 v[20:23], v[44:47], a[28:31], v[20:23]
    s_waitcnt lgkmcnt(2)
    s_add_u32 m0, s20, 17152
    s_add_u32 s31, s51, 0
    buffer_load_dwordx4 v223, s[12:15], s31 offen sc1 lds
    v_mfma_f32_16x16x32_bf16 v[8:11], v[48:51], a[32:35], v[8:11]
    ds_read_b64_tr_b16 v[44:45], v82 offset:16384
    ds_read_b64_tr_b16 v[46:47], v82 offset:18432
    v_mfma_f32_16x16x32_bf16 v[12:15], v[48:51], a[36:39], v[12:15]
    s_add_u32 m0, s20, 159744
    v_mov_b32 v104, 0
    v_mov_b32 v105, 0
    v_mfma_f32_16x16x32_bf16 v[16:19], v[48:51], a[40:43], v[16:19]
    buffer_load_dwordx4 v97, s[8:11], s21 offen lds
    v_mov_b32 v106, 0
    v_mov_b32 v107, 0
    v_mfma_f32_16x16x32_bf16 v[20:23], v[48:51], a[44:47], v[20:23]
    s_waitcnt lgkmcnt(2)
    s_add_u32 m0, s20, 256
    s_add_u32 s31, s50, 0
    buffer_load_dwordx4 v85, s[12:15], s31 offen sc1 lds
    ds_write_b128 v94, v[104:107]
    v_cvt_pk_bf16_f32 v74, v28, v29
    v_mfma_f32_16x16x32_bf16 v[8:11], v[40:43], a[48:51], v[8:11]
    s_add_u32 s31, s50, 1024
    ds_read_b64_tr_b16 v[48:49], v82 offset:20480
    ds_read_b64_tr_b16 v[50:51], v82 offset:22528
    v_mfma_f32_16x16x32_bf16 v[12:15], v[40:43], a[52:55], v[12:15]
    s_add_u32 m0, s20, 4352
    v_cvt_pk_bf16_f32 v75, v30, v31
    s_nop 1
    v_permlane16_swap_b32 v72, v74
    v_mfma_f32_16x16x32_bf16 v[16:19], v[40:43], a[56:59], v[16:19]
    buffer_load_dwordx4 v85, s[12:15], s31 offen sc1 lds
    v_mfma_f32_16x16x32_bf16 v[20:23], v[40:43], a[60:63], v[20:23]
    s_waitcnt vmcnt(12) lgkmcnt(3)
    s_add_u32 m0, s20, 8448
    s_add_u32 s31, s50, 2048
    buffer_load_dwordx4 v85, s[12:15], s31 offen sc1 lds
    v_mfma_f32_16x16x32_bf16 v[8:11], v[44:47], a[64:67], v[8:11]
    s_barrier
    ds_read_b64_tr_b16 v[40:41], v82 offset:24576
    ds_read_b64_tr_b16 v[42:43], v82 offset:26624
    v_mfma_f32_16x16x32_bf16 v[12:15], v[44:47], a[68:71], v[12:15]
    s_add_u32 s31, s50, 3072
    s_add_u32 m0, s20, 12544
    s_lshr_b32 s40, s2, 3
    s_lshl_b32 s39, s40, 7
    s_add_u32 s39, s39, 9953280
    v_mov_b32 v68, 1
    buffer_atomic_add v68, v93, s[12:15], s39 offen sc0 sc1
    v_permlane16_swap_b32 v73, v75
    buffer_store_dwordx4 v[72:75], v99, s[12:15], s26 offen offset:0 sc1
    v_mfma_f32_16x16x32_bf16 v[16:19], v[44:47], a[72:75], v[16:19]
    buffer_load_dwordx4 v85, s[12:15], s31 offen sc1 lds
    v_cvt_pk_bf16_f32 v76, v32, v33
    v_mfma_f32_16x16x32_bf16 v[20:23], v[44:47], a[76:79], v[20:23]
    s_waitcnt lgkmcnt(2)
    s_add_u32 m0, s20, 38400
    s_add_u32 s31, s51, 4096
    buffer_load_dwordx4 v223, s[12:15], s31 offen sc1 lds
    v_mfma_f32_16x16x32_bf16 v[8:11], v[48:51], a[80:83], v[8:11]
    s_add_u32 s31, s50, 8320
    ds_read_b64_tr_b16 v[44:45], v82 offset:28672
    ds_read_b64_tr_b16 v[46:47], v82 offset:30720
    v_mfma_f32_16x16x32_bf16 v[12:15], v[48:51], a[84:87], v[12:15]
    s_add_u32 m0, s20, 21504
    v_cvt_pk_bf16_f32 v77, v34, v35
    v_cvt_pk_bf16_f32 v78, v36, v37
    v_mfma_f32_16x16x32_bf16 v[16:19], v[48:51], a[88:91], v[16:19]
    buffer_load_dwordx4 v85, s[12:15], s31 offen sc1 lds
    v_mfma_f32_16x16x32_bf16 v[20:23], v[48:51], a[92:95], v[20:23]
    s_waitcnt lgkmcnt(2)
    s_add_u32 m0, s20, 25600
    s_add_u32 s31, s50, 9344
    buffer_load_dwordx4 v85, s[12:15], s31 offen sc1 lds
    v_mfma_f32_16x16x32_bf16 v[8:11], v[40:43], a[96:99], v[8:11]
    s_add_u32 s31, s50, 10368
    ds_read_b64_tr_b16 v[48:49], v82 offset:32768
    ds_read_b64_tr_b16 v[50:51], v82 offset:34816
    v_mfma_f32_16x16x32_bf16 v[12:15], v[40:43], a[100:103], v[12:15]
    s_add_u32 m0, s20, 29696
    v_cvt_pk_bf16_f32 v79, v38, v39
    v_mfma_f32_16x16x32_bf16 v[16:19], v[40:43], a[104:107], v[16:19]
    buffer_load_dwordx4 v85, s[12:15], s31 offen sc1 lds
    v_mfma_f32_16x16x32_bf16 v[20:23], v[40:43], a[108:111], v[20:23]
    s_waitcnt vmcnt(17) lgkmcnt(2)
    s_add_u32 m0, s20, 33792
    s_add_u32 s31, s50, 11392
    buffer_load_dwordx4 v85, s[12:15], s31 offen sc1 lds
    v_mfma_f32_16x16x32_bf16 v[8:11], v[44:47], a[112:115], v[8:11]
    s_barrier
    ds_read_b64_tr_b16 v[40:41], v98 offset:0
    ds_read_b64_tr_b16 v[42:43], v98 offset:2048
    v_mfma_f32_16x16x32_bf16 v[12:15], v[44:47], a[116:119], v[12:15]
    s_nop 1
    v_permlane16_swap_b32 v76, v78
    v_permlane16_swap_b32 v77, v79
    v_mfma_f32_16x16x32_bf16 v[16:19], v[44:47], a[120:123], v[16:19]
    v_mfma_f32_16x16x32_bf16 v[20:23], v[44:47], a[124:127], v[20:23]
    s_waitcnt lgkmcnt(2)
    v_mfma_f32_16x16x32_bf16 v[8:11], v[48:51], a[128:131], v[8:11]
    ds_read_b64_tr_b16 v[44:45], v98 offset:4096
    ds_read_b64_tr_b16 v[46:47], v98 offset:6144
    buffer_store_dwordx4 v[76:79], v99, s[12:15], s26 offen offset:1024 sc1
    s_add_u32 s26, s26, 0x2000
    s_cmp_eq_u32 s26, s28
    s_cselect_b32 s26, s27, s26
    v_mfma_f32_16x16x32_bf16 v[12:15], v[48:51], a[132:135], v[12:15]
    s_and_b32 s5, s5, 0xffff
    s_mov_b32 s6, 2359296
    v_mfma_f32_16x16x32_bf16 v[16:19], v[48:51], a[136:139], v[16:19]
    v_mfma_f32_16x16x32_bf16 v[20:23], v[48:51], a[140:143], v[20:23]
    s_waitcnt lgkmcnt(2)
    v_mfma_f32_16x16x32_bf16 v[8:11], v[40:43], a[144:147], v[8:11]
    ds_read_b64_tr_b16 v[48:49], v98 offset:8192
    ds_read_b64_tr_b16 v[50:51], v98 offset:10240
    v_mfma_f32_16x16x32_bf16 v[12:15], v[40:43], a[148:151], v[12:15]
    v_mfma_f32_16x16x32_bf16 v[16:19], v[40:43], a[152:155], v[16:19]
    v_mfma_f32_16x16x32_bf16 v[20:23], v[40:43], a[156:159], v[20:23]
    s_waitcnt vmcnt(16) lgkmcnt(2)
    v_mfma_f32_16x16x32_bf16 v[8:11], v[44:47], a[160:163], v[8:11]
    s_barrier
    ds_read_b64_tr_b16 v[40:41], v98 offset:12288
    ds_read_b64_tr_b16 v[42:43], v98 offset:14336
    v_mfma_f32_16x16x32_bf16 v[12:15], v[44:47], a[164:167], v[12:15]
    v_mfma_f32_16x16x32_bf16 v[16:19], v[44:47], a[168:171], v[16:19]
    v_mfma_f32_16x16x32_bf16 v[20:23], v[44:47], a[172:175], v[20:23]
    s_waitcnt lgkmcnt(2)
    v_mfma_f32_16x16x32_bf16 v[8:11], v[48:51], a[176:179], v[8:11]
    ds_read_b64_tr_b16 v[44:45], v98 offset:16384
    ds_read_b64_tr_b16 v[46:47], v98 offset:18432
    v_mfma_f32_16x16x32_bf16 v[12:15], v[48:51], a[180:183], v[12:15]
    v_mfma_f32_16x16x32_bf16 v[16:19], v[48:51], a[184:187], v[16:19]
    v_mfma_f32_16x16x32_bf16 v[20:23], v[48:51], a[188:191], v[20:23]
    s_waitcnt lgkmcnt(2)
    v_mfma_f32_16x16x32_bf16 v[8:11], v[40:43], a[192:195], v[8:11]
    ds_read_b64_tr_b16 v[48:49], v98 offset:20480
    ds_read_b64_tr_b16 v[50:51], v98 offset:22528
    v_mfma_f32_16x16x32_bf16 v[12:15], v[40:43], a[196:199], v[12:15]
    v_mfma_f32_16x16x32_bf16 v[16:19], v[40:43], a[200:203], v[16:19]
    v_mfma_f32_16x16x32_bf16 v[20:23], v[40:43], a[204:207], v[20:23]
    s_waitcnt vmcnt(12) lgkmcnt(2)
    v_mfma_f32_16x16x32_bf16 v[8:11], v[44:47], a[208:211], v[8:11]
    s_barrier
    ds_read_b64_tr_b16 v[40:41], v98 offset:24576
    ds_read_b64_tr_b16 v[42:43], v98 offset:26624
    v_mfma_f32_16x16x32_bf16 v[12:15], v[44:47], a[212:215], v[12:15]
    v_mfma_f32_16x16x32_bf16 v[16:19], v[44:47], a[216:219], v[16:19]
    v_mfma_f32_16x16x32_bf16 v[20:23], v[44:47], a[220:223], v[20:23]
    s_waitcnt lgkmcnt(2)
    v_mfma_f32_16x16x32_bf16 v[8:11], v[48:51], a[224:227], v[8:11]
    ds_read_b64_tr_b16 v[44:45], v98 offset:28672
    ds_read_b64_tr_b16 v[46:47], v98 offset:30720
    v_mfma_f32_16x16x32_bf16 v[12:15], v[48:51], a[228:231], v[12:15]
    v_mfma_f32_16x16x32_bf16 v[16:19], v[48:51], a[232:235], v[16:19]
    v_mfma_f32_16x16x32_bf16 v[20:23], v[48:51], a[236:239], v[20:23]
    s_waitcnt lgkmcnt(2)
    buffer_load_dwordx4 v[196:199], v216, s[4:7], s65 offen offset:0
    v_mfma_f32_16x16x32_bf16 v[8:11], v[40:43], a[240:243], v[8:11]
    ds_read_b64_tr_b16 v[48:49], v98 offset:32768
    ds_read_b64_tr_b16 v[50:51], v98 offset:34816
    v_mfma_f32_16x16x32_bf16 v[12:15], v[40:43], a[244:247], v[12:15]
    v_mfma_f32_16x16x32_bf16 v[16:19], v[40:43], a[248:251], v[16:19]
    v_mfma_f32_16x16x32_bf16 v[20:23], v[40:43], a[252:255], v[20:23]
    s_waitcnt lgkmcnt(2)
    buffer_load_dwordx4 v[200:203], v216, s[4:7], s65 offen offset:32
    v_mfma_f32_16x16x32_bf16 v[8:11], v[44:47], v[224:227], v[8:11]
    v_mfma_f32_16x16x32_bf16 v[12:15], v[44:47], v[228:231], v[12:15]
    v_mfma_f32_16x16x32_bf16 v[16:19], v[44:47], v[232:235], v[16:19]
    v_mfma_f32_16x16x32_bf16 v[20:23], v[44:47], v[236:239], v[20:23]
    s_waitcnt lgkmcnt(0)
    buffer_load_dwordx4 v[204:207], v216, s[4:7], s65 offen offset:64
    v_mfma_f32_16x16x32_bf16 v[24:27], v[48:51], v[240:243], v[8:11]
    v_mfma_f32_16x16x32_bf16 v[28:31], v[48:51], v[244:247], v[12:15]
    v_mfma_f32_16x16x32_bf16 v[32:35], v[48:51], v[248:251], v[16:19]
    v_mfma_f32_16x16x32_bf16 v[36:39], v[48:51], v[252:255], v[20:23]
    s_load_dwordx2 s[8:9], s[0:1], 80
    s_nop 3
    v_cvt_pk_bf16_f32 v72, v24, v25
    v_cvt_pk_bf16_f32 v73, v26, v27
    v_cvt_pk_bf16_f32 v74, v28, v29
    v_cvt_pk_bf16_f32 v75, v30, v31
    s_nop 1
    v_permlane16_swap_b32 v72, v74
    v_permlane16_swap_b32 v73, v75
    buffer_store_dwordx4 v[72:75], v99, s[12:15], s26 offen offset:0 sc1
    v_cvt_pk_bf16_f32 v76, v32, v33
    v_cvt_pk_bf16_f32 v77, v34, v35
    v_cvt_pk_bf16_f32 v78, v36, v37
    v_cvt_pk_bf16_f32 v79, v38, v39
    s_nop 1
    v_permlane16_swap_b32 v76, v78
    v_permlane16_swap_b32 v77, v79
    buffer_store_dwordx4 v[76:79], v99, s[12:15], s26 offen offset:1024 sc1
    s_waitcnt vmcnt(6)
    s_barrier
    s_bitcmp1_b32 s3, 0
    s_cbranch_scc1 parallel_sum__ssm_conv_s4d__dense_activation_silu__prompt_kernel_convy
    ds_read_b64_tr_b16 v[116:117], v86 offset:16128
    ds_read_b64_tr_b16 v[118:119], v87 offset:16128
    ds_read_b128 a[0:3], v88 offset:0
    ds_read_b64_tr_b16 v[120:121], v86 offset:15872
    ds_read_b64_tr_b16 v[122:123], v87 offset:15872
    ds_read_b128 a[4:7], v88 offset:64
    ds_read_b64_tr_b16 v[124:125], v86 offset:15616
    ds_read_b64_tr_b16 v[126:127], v87 offset:15616
    ds_read_b128 a[8:11], v88 offset:128
    ds_read_b64_tr_b16 v[128:129], v86 offset:15360
    ds_read_b64_tr_b16 v[130:131], v87 offset:15360
    ds_read_b128 a[12:15], v88 offset:192
    s_waitcnt lgkmcnt(9)
    v_mfma_f32_16x16x32_bf16 v[100:103], v[116:119], a[0:3], 0
    ds_read_b64_tr_b16 v[132:133], v86 offset:15104
    ds_read_b64_tr_b16 v[134:135], v87 offset:15104
    ds_read_b128 a[16:19], v88 offset:256
    s_waitcnt lgkmcnt(9)
    v_mfma_f32_16x16x32_bf16 v[100:103], v[120:123], a[4:7], v[100:103]
    ds_read_b64_tr_b16 v[136:137], v86 offset:14848
    ds_read_b64_tr_b16 v[138:139], v87 offset:14848
    ds_read_b128 a[20:23], v88 offset:320
    s_waitcnt lgkmcnt(9)
    v_mfma_f32_16x16x32_bf16 v[100:103], v[124:127], a[8:11], v[100:103]
    ds_read_b64_tr_b16 v[140:141], v86 offset:14592
    ds_read_b64_tr_b16 v[142:143], v87 offset:14592
    ds_read_b128 a[24:27], v88 offset:384
    s_cmp_lg_u32 s3, 0
    s_cbranch_scc1 parallel_sum__ssm_conv_s4d__dense_activation_silu__prompt_kernel_nt
    s_mov_b64 exec, 1
    ds_write_b32 v64, v68
    s_mov_b64 exec, -1
parallel_sum__ssm_conv_s4d__dense_activation_silu__prompt_kernel_nt:
    s_waitcnt lgkmcnt(9)
    v_mfma_f32_16x16x32_bf16 v[100:103], v[128:131], a[12:15], v[100:103]
    ds_read_b64_tr_b16 v[144:145], v86 offset:14336
    ds_read_b64_tr_b16 v[146:147], v87 offset:14336
    ds_read_b128 a[28:31], v88 offset:448
    s_waitcnt lgkmcnt(9)
    v_mfma_f32_16x16x32_bf16 v[100:103], v[132:135], a[16:19], v[100:103]
    ds_read_b64_tr_b16 v[116:117], v86 offset:14080
    ds_read_b64_tr_b16 v[118:119], v87 offset:14080
    ds_read_b128 a[32:35], v88 offset:512
    s_waitcnt lgkmcnt(9)
    v_mfma_f32_16x16x32_bf16 v[100:103], v[136:139], a[20:23], v[100:103]
    ds_read_b64_tr_b16 v[120:121], v86 offset:13824
    ds_read_b64_tr_b16 v[122:123], v87 offset:13824
    ds_read_b128 a[36:39], v88 offset:576
    s_waitcnt lgkmcnt(9)
    v_mfma_f32_16x16x32_bf16 v[100:103], v[140:143], a[24:27], v[100:103]
    ds_read_b64_tr_b16 v[124:125], v86 offset:13568
    ds_read_b64_tr_b16 v[126:127], v87 offset:13568
    ds_read_b128 a[40:43], v88 offset:640
    s_waitcnt lgkmcnt(9)
    v_mfma_f32_16x16x32_bf16 v[100:103], v[144:147], a[28:31], v[100:103]
    ds_read_b64_tr_b16 v[128:129], v86 offset:13312
    ds_read_b64_tr_b16 v[130:131], v87 offset:13312
    ds_read_b128 a[44:47], v88 offset:704
    s_waitcnt lgkmcnt(9)
    v_mfma_f32_16x16x32_bf16 v[100:103], v[116:119], a[32:35], v[100:103]
    ds_read_b64_tr_b16 v[132:133], v86 offset:13056
    ds_read_b64_tr_b16 v[134:135], v87 offset:13056
    ds_read_b128 a[48:51], v88 offset:768
    s_waitcnt lgkmcnt(9)
    v_mfma_f32_16x16x32_bf16 v[100:103], v[120:123], a[36:39], v[100:103]
    ds_read_b64_tr_b16 v[136:137], v86 offset:12800
    ds_read_b64_tr_b16 v[138:139], v87 offset:12800
    ds_read_b128 a[52:55], v88 offset:832
    s_waitcnt lgkmcnt(9)
    v_mfma_f32_16x16x32_bf16 v[100:103], v[124:127], a[40:43], v[100:103]
    ds_read_b64_tr_b16 v[140:141], v86 offset:12544
    ds_read_b64_tr_b16 v[142:143], v87 offset:12544
    ds_read_b128 a[56:59], v88 offset:896
    s_waitcnt lgkmcnt(9)
    v_mfma_f32_16x16x32_bf16 v[100:103], v[128:131], a[44:47], v[100:103]
    ds_read_b64_tr_b16 v[144:145], v86 offset:12288
    ds_read_b64_tr_b16 v[146:147], v87 offset:12288
    ds_read_b128 a[60:63], v88 offset:960
    s_waitcnt lgkmcnt(9)
    v_mfma_f32_16x16x32_bf16 v[100:103], v[132:135], a[48:51], v[100:103]
    ds_read_b64_tr_b16 v[116:117], v86 offset:12032
    ds_read_b64_tr_b16 v[118:119], v87 offset:12032
    ds_read_b128 a[64:67], v88 offset:1024
    s_waitcnt lgkmcnt(9)
    v_mfma_f32_16x16x32_bf16 v[100:103], v[136:139], a[52:55], v[100:103]
    ds_read_b64_tr_b16 v[120:121], v86 offset:11776
    ds_read_b64_tr_b16 v[122:123], v87 offset:11776
    ds_read_b128 a[68:71], v88 offset:1088
    s_waitcnt lgkmcnt(9)
    v_mfma_f32_16x16x32_bf16 v[100:103], v[140:143], a[56:59], v[100:103]
    ds_read_b64_tr_b16 v[124:125], v86 offset:11520
    ds_read_b64_tr_b16 v[126:127], v87 offset:11520
    ds_read_b128 a[72:75], v88 offset:1152
    s_waitcnt lgkmcnt(9)
    v_mfma_f32_16x16x32_bf16 v[100:103], v[144:147], a[60:63], v[100:103]
    ds_read_b64_tr_b16 v[128:129], v86 offset:11264
    ds_read_b64_tr_b16 v[130:131], v87 offset:11264
    ds_read_b128 a[76:79], v88 offset:1216
    s_waitcnt lgkmcnt(9)
    v_mfma_f32_16x16x32_bf16 v[100:103], v[116:119], a[64:67], v[100:103]
    ds_read_b64_tr_b16 v[132:133], v86 offset:11008
    ds_read_b64_tr_b16 v[134:135], v87 offset:11008
    v_mfma_f32_16x16x32_bf16 v[104:107], v[116:119], a[0:3], 0
    ds_read_b128 a[80:83], v88 offset:1280
    s_waitcnt lgkmcnt(9)
    v_mfma_f32_16x16x32_bf16 v[100:103], v[120:123], a[68:71], v[100:103]
    ds_read_b64_tr_b16 v[136:137], v86 offset:10752
    ds_read_b64_tr_b16 v[138:139], v87 offset:10752
    v_mfma_f32_16x16x32_bf16 v[104:107], v[120:123], a[4:7], v[104:107]
    ds_read_b128 a[84:87], v88 offset:1344
    s_waitcnt lgkmcnt(9)
    v_mfma_f32_16x16x32_bf16 v[100:103], v[124:127], a[72:75], v[100:103]
    ds_read_b64_tr_b16 v[140:141], v86 offset:10496
    ds_read_b64_tr_b16 v[142:143], v87 offset:10496
    v_mfma_f32_16x16x32_bf16 v[104:107], v[124:127], a[8:11], v[104:107]
    ds_read_b128 a[88:91], v88 offset:1408
    s_waitcnt lgkmcnt(9)
    v_mfma_f32_16x16x32_bf16 v[100:103], v[128:131], a[76:79], v[100:103]
    ds_read_b64_tr_b16 v[144:145], v86 offset:10240
    ds_read_b64_tr_b16 v[146:147], v87 offset:10240
    v_mfma_f32_16x16x32_bf16 v[104:107], v[128:131], a[12:15], v[104:107]
    ds_read_b128 a[92:95], v88 offset:1472
    s_waitcnt lgkmcnt(9)
    v_mfma_f32_16x16x32_bf16 v[100:103], v[132:135], a[80:83], v[100:103]
    ds_read_b64_tr_b16 v[116:117], v86 offset:9984
    ds_read_b64_tr_b16 v[118:119], v87 offset:9984
    v_mfma_f32_16x16x32_bf16 v[104:107], v[132:135], a[16:19], v[104:107]
    ds_read_b128 a[96:99], v88 offset:1536
    s_waitcnt lgkmcnt(9)
    v_mfma_f32_16x16x32_bf16 v[100:103], v[136:139], a[84:87], v[100:103]
    ds_read_b64_tr_b16 v[120:121], v86 offset:9728
    ds_read_b64_tr_b16 v[122:123], v87 offset:9728
    v_mfma_f32_16x16x32_bf16 v[104:107], v[136:139], a[20:23], v[104:107]
    ds_read_b128 a[100:103], v88 offset:1600
    s_waitcnt lgkmcnt(9)
    v_mfma_f32_16x16x32_bf16 v[100:103], v[140:143], a[88:91], v[100:103]
    ds_read_b64_tr_b16 v[124:125], v86 offset:9472
    ds_read_b64_tr_b16 v[126:127], v87 offset:9472
    v_mfma_f32_16x16x32_bf16 v[104:107], v[140:143], a[24:27], v[104:107]
    ds_read_b128 a[104:107], v88 offset:1664
    s_waitcnt lgkmcnt(9)
    v_mfma_f32_16x16x32_bf16 v[100:103], v[144:147], a[92:95], v[100:103]
    ds_read_b64_tr_b16 v[128:129], v86 offset:9216
    ds_read_b64_tr_b16 v[130:131], v87 offset:9216
    v_mfma_f32_16x16x32_bf16 v[104:107], v[144:147], a[28:31], v[104:107]
    ds_read_b128 a[108:111], v88 offset:1728
    s_waitcnt lgkmcnt(9)
    v_mfma_f32_16x16x32_bf16 v[100:103], v[116:119], a[96:99], v[100:103]
    ds_read_b64_tr_b16 v[132:133], v86 offset:8960
    ds_read_b64_tr_b16 v[134:135], v87 offset:8960
    ds_read_b128 a[112:115], v88 offset:1792
    v_mfma_f32_16x16x32_bf16 v[104:107], v[116:119], a[32:35], v[104:107]
    s_waitcnt vmcnt(0)
    buffer_store_dword v69, v219, s[12:15], s71 offen sc1
    s_waitcnt lgkmcnt(9)
    v_mfma_f32_16x16x32_bf16 v[100:103], v[120:123], a[100:103], v[100:103]
    ds_read_b64_tr_b16 v[136:137], v86 offset:8704
    ds_read_b64_tr_b16 v[138:139], v87 offset:8704
    v_mfma_f32_16x16x32_bf16 v[104:107], v[120:123], a[36:39], v[104:107]
    ds_read_b128 a[116:119], v88 offset:1856
    s_waitcnt lgkmcnt(9)
    v_mfma_f32_16x16x32_bf16 v[100:103], v[124:127], a[104:107], v[100:103]
    ds_read_b64_tr_b16 v[140:141], v86 offset:8448
    ds_read_b64_tr_b16 v[142:143], v87 offset:8448
    v_mfma_f32_16x16x32_bf16 v[104:107], v[124:127], a[40:43], v[104:107]
    ds_read_b128 a[120:123], v88 offset:1920
    s_waitcnt lgkmcnt(9)
    v_mfma_f32_16x16x32_bf16 v[100:103], v[128:131], a[108:111], v[100:103]
    ds_read_b64_tr_b16 v[144:145], v86 offset:8192
    ds_read_b64_tr_b16 v[146:147], v87 offset:8192
    v_mfma_f32_16x16x32_bf16 v[104:107], v[128:131], a[44:47], v[104:107]
    ds_read_b128 a[124:127], v88 offset:1984
    s_waitcnt lgkmcnt(9)
    v_mfma_f32_16x16x32_bf16 v[100:103], v[132:135], a[112:115], v[100:103]
    ds_read_b64_tr_b16 v[116:117], v86 offset:7936
    ds_read_b64_tr_b16 v[118:119], v87 offset:7936
    v_mfma_f32_16x16x32_bf16 v[104:107], v[132:135], a[48:51], v[104:107]
    ds_read_b128 a[128:131], v88 offset:2048
    s_waitcnt lgkmcnt(9)
    v_mfma_f32_16x16x32_bf16 v[100:103], v[136:139], a[116:119], v[100:103]
    ds_read_b64_tr_b16 v[120:121], v86 offset:7680
    ds_read_b64_tr_b16 v[122:123], v87 offset:7680
    v_mfma_f32_16x16x32_bf16 v[104:107], v[136:139], a[52:55], v[104:107]
    ds_read_b128 a[132:135], v88 offset:2112
    s_waitcnt lgkmcnt(9)
    v_mfma_f32_16x16x32_bf16 v[100:103], v[140:143], a[120:123], v[100:103]
    ds_read_b64_tr_b16 v[124:125], v86 offset:7424
    ds_read_b64_tr_b16 v[126:127], v87 offset:7424
    ds_read_b128 a[136:139], v88 offset:2176
    ds_read_b32 v63, v64
    v_mfma_f32_16x16x32_bf16 v[104:107], v[140:143], a[56:59], v[104:107]
    s_waitcnt lgkmcnt(0)
    s_mov_b32 s25, 0x100000
parallel_sum__ssm_conv_s4d__dense_activation_silu__prompt_kernel_tkx:
    v_readfirstlane_b32 s33, v63
    s_sub_u32 s25, s25, 1
    s_cbranch_scc1 parallel_sum__ssm_conv_s4d__dense_activation_silu__prompt_kernel_tkdx
    s_cmp_lg_u32 s33, -1
    s_cbranch_scc1 parallel_sum__ssm_conv_s4d__dense_activation_silu__prompt_kernel_tkdx
    ds_read_b32 v63, v64
    s_waitcnt lgkmcnt(0)
    s_branch parallel_sum__ssm_conv_s4d__dense_activation_silu__prompt_kernel_tkx
parallel_sum__ssm_conv_s4d__dense_activation_silu__prompt_kernel_tkdx:
    s_lshl_b32 s74, s40, 2
    s_add_u32 s74, s74, s33
    s_cmp_lt_u32 s33, 4
    s_cselect_b32 s33, s74, 0xff
    s_cmp_lt_u32 s33, 128
    s_cbranch_scc0 parallel_sum__ssm_conv_s4d__dense_activation_silu__prompt_kernel_nxx
    s_lshr_b32 s74, s33, 1
    s_add_u32 s74, s74, 512
    s_mul_i32 s52, s74, 8320
    s_add_u32 s52, s52, 35651896
    s_lshl_b32 s53, s74, 12
    s_add_u32 s53, s53, 2359296
    s_add_u32 m0, s20, 59648
    s_add_u32 s31, s53, 0
    buffer_load_dwordx4 v223, s[12:15], s31 offen sc1 lds
    s_add_u32 m0, s20, 42752
    s_add_u32 s31, s52, 0
    buffer_load_dwordx4 v85, s[12:15], s31 offen sc1 lds
    s_add_u32 m0, s20, 46848
    s_add_u32 s31, s52, 1024
    buffer_load_dwordx4 v85, s[12:15], s31 offen sc1 lds
    s_add_u32 m0, s20, 50944
    s_add_u32 s31, s52, 2048
    buffer_load_dwordx4 v85, s[12:15], s31 offen sc1 lds
    s_add_u32 m0, s20, 55040
    s_add_u32 s31, s52, 3072
    buffer_load_dwordx4 v85, s[12:15], s31 offen sc1 lds
parallel_sum__ssm_conv_s4d__dense_activation_silu__prompt_kernel_nxx:
    v_mfma_f32_16x16x32_bf16 v[100:103], v[144:147], a[124:127], v[100:103]
    ds_read_b64_tr_b16 v[128:129], v86 offset:7168
    ds_read_b64_tr_b16 v[130:131], v87 offset:7168
    v_mfma_f32_16x16x32_bf16 v[104:107], v[144:147], a[60:63], v[104:107]
    ds_read_b128 a[140:143], v88 offset:2240
    v_mfma_f32_16x16x32_bf16 v[100:103], v[116:119], a[128:131], v[100:103]
    ds_read_b64_tr_b16 v[132:133], v86 offset:6912
    ds_read_b64_tr_b16 v[134:135], v87 offset:6912
    v_mfma_f32_16x16x32_bf16 v[104:107], v[116:119], a[64:67], v[104:107]
    ds_read_b128 a[144:147], v88 offset:2304
    v_mfma_f32_16x16x32_bf16 v[100:103], v[120:123], a[132:135], v[100:103]
    ds_read_b64_tr_b16 v[136:137], v86 offset:6656
    ds_read_b64_tr_b16 v[138:139], v87 offset:6656
    v_mfma_f32_16x16x32_bf16 v[104:107], v[120:123], a[68:71], v[104:107]
    ds_read_b128 a[148:151], v88 offset:2368
    v_mfma_f32_16x16x32_bf16 v[100:103], v[124:127], a[136:139], v[100:103]
    ds_read_b64_tr_b16 v[140:141], v86 offset:6400
    ds_read_b64_tr_b16 v[142:143], v87 offset:6400
    v_mfma_f32_16x16x32_bf16 v[104:107], v[124:127], a[72:75], v[104:107]
    ds_read_b128 a[152:155], v88 offset:2432
    s_waitcnt lgkmcnt(9)
    v_mfma_f32_16x16x32_bf16 v[100:103], v[128:131], a[140:143], v[100:103]
    ds_read_b64_tr_b16 v[144:145], v86 offset:6144
    ds_read_b64_tr_b16 v[146:147], v87 offset:6144
    v_mfma_f32_16x16x32_bf16 v[104:107], v[128:131], a[76:79], v[104:107]
    ds_read_b128 a[156:159], v88 offset:2496
    s_waitcnt lgkmcnt(9)
    v_mfma_f32_16x16x32_bf16 v[100:103], v[132:135], a[144:147], v[100:103]
    ds_read_b64_tr_b16 v[116:117], v86 offset:5888
    ds_read_b64_tr_b16 v[118:119], v87 offset:5888
    v_mfma_f32_16x16x32_bf16 v[104:107], v[132:135], a[80:83], v[104:107]
    ds_read_b128 a[160:163], v88 offset:2560
    s_waitcnt lgkmcnt(9)
    v_mfma_f32_16x16x32_bf16 v[100:103], v[136:139], a[148:151], v[100:103]
    ds_read_b64_tr_b16 v[120:121], v86 offset:5632
    ds_read_b64_tr_b16 v[122:123], v87 offset:5632
    v_mfma_f32_16x16x32_bf16 v[104:107], v[136:139], a[84:87], v[104:107]
    ds_read_b128 a[164:167], v88 offset:2624
    s_waitcnt lgkmcnt(9)
    v_mfma_f32_16x16x32_bf16 v[100:103], v[140:143], a[152:155], v[100:103]
    ds_read_b64_tr_b16 v[124:125], v86 offset:5376
    ds_read_b64_tr_b16 v[126:127], v87 offset:5376
    v_mfma_f32_16x16x32_bf16 v[104:107], v[140:143], a[88:91], v[104:107]
    ds_read_b128 a[168:171], v88 offset:2688
    s_waitcnt lgkmcnt(9)
    v_mfma_f32_16x16x32_bf16 v[100:103], v[144:147], a[156:159], v[100:103]
    ds_read_b64_tr_b16 v[128:129], v86 offset:5120
    ds_read_b64_tr_b16 v[130:131], v87 offset:5120
    v_mfma_f32_16x16x32_bf16 v[104:107], v[144:147], a[92:95], v[104:107]
    ds_read_b128 a[172:175], v88 offset:2752
    s_waitcnt lgkmcnt(9)
    v_mfma_f32_16x16x32_bf16 v[100:103], v[116:119], a[160:163], v[100:103]
    ds_read_b64_tr_b16 v[132:133], v86 offset:4864
    v_mfma_f32_16x16x32_bf16 v[104:107], v[116:119], a[96:99], v[104:107]
    ds_read_b64_tr_b16 v[134:135], v87 offset:4864
    v_mfma_f32_16x16x32_bf16 v[108:111], v[116:119], a[0:3], 0
    ds_read_b128 a[176:179], v88 offset:2816
    s_waitcnt lgkmcnt(9)
    v_mfma_f32_16x16x32_bf16 v[100:103], v[120:123], a[164:167], v[100:103]
    ds_read_b64_tr_b16 v[136:137], v86 offset:4608
    v_mfma_f32_16x16x32_bf16 v[104:107], v[120:123], a[100:103], v[104:107]
    ds_read_b64_tr_b16 v[138:139], v87 offset:4608
    v_mfma_f32_16x16x32_bf16 v[108:111], v[120:123], a[4:7], v[108:111]
    ds_read_b128 a[180:183], v88 offset:2880
    s_waitcnt lgkmcnt(9)
    v_mfma_f32_16x16x32_bf16 v[100:103], v[124:127], a[168:171], v[100:103]
    ds_read_b64_tr_b16 v[140:141], v86 offset:4352
    v_mfma_f32_16x16x32_bf16 v[104:107], v[124:127], a[104:107], v[104:107]
    ds_read_b64_tr_b16 v[142:143], v87 offset:4352
    v_mfma_f32_16x16x32_bf16 v[108:111], v[124:127], a[8:11], v[108:111]
    ds_read_b128 a[184:187], v88 offset:2944
    s_waitcnt lgkmcnt(9)
    v_mfma_f32_16x16x32_bf16 v[100:103], v[128:131], a[172:175], v[100:103]
    ds_read_b64_tr_b16 v[144:145], v86 offset:4096
    v_mfma_f32_16x16x32_bf16 v[104:107], v[128:131], a[108:111], v[104:107]
    ds_read_b64_tr_b16 v[146:147], v87 offset:4096
    v_mfma_f32_16x16x32_bf16 v[108:111], v[128:131], a[12:15], v[108:111]
    ds_read_b128 a[188:191], v88 offset:3008
    s_waitcnt lgkmcnt(9)
    v_mfma_f32_16x16x32_bf16 v[100:103], v[132:135], a[176:179], v[100:103]
    ds_read_b64_tr_b16 v[116:117], v86 offset:3840
    v_mfma_f32_16x16x32_bf16 v[104:107], v[132:135], a[112:115], v[104:107]
    ds_read_b64_tr_b16 v[118:119], v87 offset:3840
    v_mfma_f32_16x16x32_bf16 v[108:111], v[132:135], a[16:19], v[108:111]
    ds_read_b128 a[192:195], v88 offset:3072
    s_waitcnt lgkmcnt(9)
    v_mfma_f32_16x16x32_bf16 v[100:103], v[136:139], a[180:183], v[100:103]
    ds_read_b64_tr_b16 v[120:121], v86 offset:3584
    v_mfma_f32_16x16x32_bf16 v[104:107], v[136:139], a[116:119], v[104:107]
    ds_read_b64_tr_b16 v[122:123], v87 offset:3584
    v_mfma_f32_16x16x32_bf16 v[108:111], v[136:139], a[20:23], v[108:111]
    ds_read_b128 a[196:199], v88 offset:3136
    s_waitcnt lgkmcnt(9)
    v_mfma_f32_16x16x32_bf16 v[100:103], v[140:143], a[184:187], v[100:103]
    ds_read_b64_tr_b16 v[124:125], v86 offset:3328
    ds_read_b64_tr_b16 v[126:127], v87 offset:3328
    v_mfma_f32_16x16x32_bf16 v[104:107], v[140:143], a[120:123], v[104:107]
    ds_read_b128 a[200:203], v88 offset:3200
    buffer_load_dword v70, v71, s[12:15], s63 offen sc1
    v_mfma_f32_16x16x32_bf16 v[108:111], v[140:143], a[24:27], v[108:111]
    s_waitcnt lgkmcnt(9)
    v_mfma_f32_16x16x32_bf16 v[100:103], v[144:147], a[188:191], v[100:103]
    ds_read_b64_tr_b16 v[128:129], v86 offset:3072
    v_mfma_f32_16x16x32_bf16 v[104:107], v[144:147], a[124:127], v[104:107]
    ds_read_b64_tr_b16 v[130:131], v87 offset:3072
    v_mfma_f32_16x16x32_bf16 v[108:111], v[144:147], a[28:31], v[108:111]
    ds_read_b128 a[204:207], v88 offset:3264
    s_waitcnt lgkmcnt(9)
    v_mfma_f32_16x16x32_bf16 v[100:103], v[116:119], a[192:195], v[100:103]
    ds_read_b64_tr_b16 v[132:133], v86 offset:2816
    v_mfma_f32_16x16x32_bf16 v[104:107], v[116:119], a[128:131], v[104:107]
    ds_read_b64_tr_b16 v[134:135], v87 offset:2816
    v_mfma_f32_16x16x32_bf16 v[108:111], v[116:119], a[32:35], v[108:111]
    ds_read_b128 a[208:211], v88 offset:3328
    s_waitcnt lgkmcnt(9)
    v_mfma_f32_16x16x32_bf16 v[100:103], v[120:123], a[196:199], v[100:103]
    ds_read_b64_tr_b16 v[136:137], v86 offset:2560
    v_mfma_f32_16x16x32_bf16 v[104:107], v[120:123], a[132:135], v[104:107]
    ds_read_b64_tr_b16 v[138:139], v87 offset:2560
    v_mfma_f32_16x16x32_bf16 v[108:111], v[120:123], a[36:39], v[108:111]
    ds_read_b128 a[212:215], v88 offset:3392
    s_waitcnt lgkmcnt(9)
    v_mfma_f32_16x16x32_bf16 v[100:103], v[124:127], a[200:203], v[100:103]
    ds_read_b64_tr_b16 v[140:141], v86 offset:2304
    v_mfma_f32_16x16x32_bf16 v[104:107], v[124:127], a[136:139], v[104:107]
    ds_read_b64_tr_b16 v[142:143], v87 offset:2304
    v_mfma_f32_16x16x32_bf16 v[108:111], v[124:127], a[40:43], v[108:111]
    ds_read_b128 a[216:219], v88 offset:3456
    s_waitcnt lgkmcnt(9)
    v_mfma_f32_16x16x32_bf16 v[100:103], v[128:131], a[204:207], v[100:103]
    ds_read_b64_tr_b16 v[144:145], v86 offset:2048
    v_mfma_f32_16x16x32_bf16 v[104:107], v[128:131], a[140:143], v[104:107]
    ds_read_b64_tr_b16 v[146:147], v87 offset:2048
    v_mfma_f32_16x16x32_bf16 v[108:111], v[128:131], a[44:47], v[108:111]
    ds_read_b128 a[220:223], v88 offset:3520
    s_waitcnt lgkmcnt(9)
    v_mfma_f32_16x16x32_bf16 v[100:103], v[132:135], a[208:211], v[100:103]
    ds_read_b64_tr_b16 v[116:117], v86 offset:1792
    v_mfma_f32_16x16x32_bf16 v[104:107], v[132:135], a[144:147], v[104:107]
    ds_read_b64_tr_b16 v[118:119], v87 offset:1792
    v_mfma_f32_16x16x32_bf16 v[108:111], v[132:135], a[48:51], v[108:111]
    ds_read_b128 a[224:227], v88 offset:3584
    s_waitcnt lgkmcnt(9)
    v_mfma_f32_16x16x32_bf16 v[100:103], v[136:139], a[212:215], v[100:103]
    ds_read_b64_tr_b16 v[120:121], v86 offset:1536
    v_mfma_f32_16x16x32_bf16 v[104:107], v[136:139], a[148:151], v[104:107]
    ds_read_b64_tr_b16 v[122:123], v87 offset:1536
    v_mfma_f32_16x16x32_bf16 v[108:111], v[136:139], a[52:55], v[108:111]
    ds_read_b128 a[228:231], v88 offset:3648
    s_waitcnt lgkmcnt(9)
    v_mfma_f32_16x16x32_bf16 v[100:103], v[140:143], a[216:219], v[100:103]
    ds_read_b64_tr_b16 v[124:125], v86 offset:1280
    v_mfma_f32_16x16x32_bf16 v[104:107], v[140:143], a[152:155], v[104:107]
    ds_read_b64_tr_b16 v[126:127], v87 offset:1280
    v_mfma_f32_16x16x32_bf16 v[108:111], v[140:143], a[56:59], v[108:111]
    ds_read_b128 a[232:235], v88 offset:3712
    s_waitcnt lgkmcnt(9)
    v_mfma_f32_16x16x32_bf16 v[100:103], v[144:147], a[220:223], v[100:103]
    ds_read_b64_tr_b16 v[128:129], v86 offset:1024
    v_mfma_f32_16x16x32_bf16 v[104:107], v[144:147], a[156:159], v[104:107]
    ds_read_b64_tr_b16 v[130:131], v87 offset:1024
    v_mfma_f32_16x16x32_bf16 v[108:111], v[144:147], a[60:63], v[108:111]
    ds_read_b128 a[236:239], v88 offset:3776
    s_waitcnt lgkmcnt(9)
    v_mfma_f32_16x16x32_bf16 v[100:103], v[116:119], a[224:227], v[100:103]
    ds_read_b64_tr_b16 v[132:133], v86 offset:768
    v_mfma_f32_16x16x32_bf16 v[104:107], v[116:119], a[160:163], v[104:107]
    ds_read_b64_tr_b16 v[134:135], v87 offset:768
    v_mfma_f32_16x16x32_bf16 v[108:111], v[116:119], a[64:67], v[108:111]
    ds_read_b128 a[240:243], v88 offset:3840
    v_mfma_f32_16x16x32_bf16 v[112:115], v[116:119], a[0:3], 0
    s_waitcnt lgkmcnt(9)
    v_mfma_f32_16x16x32_bf16 v[100:103], v[120:123], a[228:231], v[100:103]
    ds_read_b64_tr_b16 v[136:137], v86 offset:512
    v_mfma_f32_16x16x32_bf16 v[104:107], v[120:123], a[164:167], v[104:107]
    ds_read_b64_tr_b16 v[138:139], v87 offset:512
    v_mfma_f32_16x16x32_bf16 v[108:111], v[120:123], a[68:71], v[108:111]
    ds_read_b128 a[244:247], v88 offset:3904
    v_mfma_f32_16x16x32_bf16 v[112:115], v[120:123], a[4:7], v[112:115]
    s_waitcnt lgkmcnt(9)
    v_mfma_f32_16x16x32_bf16 v[100:103], v[124:127], a[232:235], v[100:103]
    ds_read_b64_tr_b16 v[140:141], v86 offset:256
    v_mfma_f32_16x16x32_bf16 v[104:107], v[124:127], a[168:171], v[104:107]
    ds_read_b64_tr_b16 v[142:143], v87 offset:256
    v_mfma_f32_16x16x32_bf16 v[108:111], v[124:127], a[72:75], v[108:111]
    ds_read_b128 a[248:251], v88 offset:3968
    v_mfma_f32_16x16x32_bf16 v[112:115], v[124:127], a[8:11], v[112:115]
    s_waitcnt lgkmcnt(9)
    v_mfma_f32_16x16x32_bf16 v[100:103], v[128:131], a[236:239], v[100:103]
    ds_read_b64_tr_b16 v[144:145], v86 offset:0
    v_mfma_f32_16x16x32_bf16 v[104:107], v[128:131], a[172:175], v[104:107]
    ds_read_b64_tr_b16 v[146:147], v87 offset:0
    v_mfma_f32_16x16x32_bf16 v[108:111], v[128:131], a[76:79], v[108:111]
    ds_read_b128 a[252:255], v88 offset:4032
    v_mfma_f32_16x16x32_bf16 v[112:115], v[128:131], a[12:15], v[112:115]
    s_waitcnt lgkmcnt(9)
    v_mfma_f32_16x16x32_bf16 v[100:103], v[132:135], a[240:243], v[100:103]
    v_mfma_f32_16x16x32_bf16 v[104:107], v[132:135], a[176:179], v[104:107]
    v_mfma_f32_16x16x32_bf16 v[108:111], v[132:135], a[80:83], v[108:111]
    v_mfma_f32_16x16x32_bf16 v[112:115], v[132:135], a[16:19], v[112:115]
    s_waitcnt lgkmcnt(6)
    v_mfma_f32_16x16x32_bf16 v[100:103], v[136:139], a[244:247], v[100:103]
    v_mfma_f32_16x16x32_bf16 v[104:107], v[136:139], a[180:183], v[104:107]
    v_mfma_f32_16x16x32_bf16 v[108:111], v[136:139], a[84:87], v[108:111]
    v_mfma_f32_16x16x32_bf16 v[112:115], v[136:139], a[20:23], v[112:115]
    s_waitcnt lgkmcnt(3)
    v_mfma_f32_16x16x32_bf16 v[100:103], v[140:143], a[248:251], v[100:103]
    v_mfma_f32_16x16x32_bf16 v[104:107], v[140:143], a[184:187], v[104:107]
    v_mfma_f32_16x16x32_bf16 v[108:111], v[140:143], a[88:91], v[108:111]
    v_mfma_f32_16x16x32_bf16 v[112:115], v[140:143], a[24:27], v[112:115]
    s_waitcnt lgkmcnt(0)
    v_mfma_f32_16x16x32_bf16 v[100:103], v[144:147], a[252:255], v[100:103]
    v_mfma_f32_16x16x32_bf16 v[104:107], v[144:147], a[188:191], v[104:107]
    v_mfma_f32_16x16x32_bf16 v[108:111], v[144:147], a[92:95], v[108:111]
    v_mfma_f32_16x16x32_bf16 v[112:115], v[144:147], a[28:31], v[112:115]
    s_nop 4
    v_cvt_pk_bf16_f32 v72, v100, v101
    v_cvt_pk_bf16_f32 v73, v102, v103
    buffer_store_dwordx2 v[72:73], v89, s[12:15], s70 offen offset:3584 sc1
    v_cvt_pk_bf16_f32 v74, v104, v105
    v_cvt_pk_bf16_f32 v75, v106, v107
    buffer_store_dwordx2 v[74:75], v89, s[12:15], s70 offen offset:2560 sc1
    v_cvt_pk_bf16_f32 v76, v108, v109
    v_cvt_pk_bf16_f32 v77, v110, v111
    buffer_store_dwordx2 v[76:77], v89, s[12:15], s70 offen offset:1024 sc1
    v_cvt_pk_bf16_f32 v78, v112, v113
    v_cvt_pk_bf16_f32 v79, v114, v115
    buffer_store_dwordx2 v[78:79], v89, s[12:15], s70 offen offset:0 sc1
    s_waitcnt vmcnt(4)
    s_branch parallel_sum__ssm_conv_s4d__dense_activation_silu__prompt_kernel_convd
parallel_sum__ssm_conv_s4d__dense_activation_silu__prompt_kernel_convy:
    ds_read_b64_tr_b16 v[116:117], v86 offset:14080
    ds_read_b64_tr_b16 v[118:119], v87 offset:14080
    ds_read_b128 a[0:3], v88 offset:0
    ds_read_b64_tr_b16 v[120:121], v86 offset:13824
    ds_read_b64_tr_b16 v[122:123], v87 offset:13824
    ds_read_b128 a[4:7], v88 offset:64
    ds_read_b64_tr_b16 v[124:125], v86 offset:13568
    ds_read_b64_tr_b16 v[126:127], v87 offset:13568
    ds_read_b128 a[8:11], v88 offset:128
    ds_read_b64_tr_b16 v[128:129], v86 offset:13312
    ds_read_b64_tr_b16 v[130:131], v87 offset:13312
    ds_read_b128 a[12:15], v88 offset:192
    s_waitcnt lgkmcnt(9)
    v_mfma_f32_16x16x32_bf16 v[100:103], v[116:119], a[0:3], 0
    ds_read_b64_tr_b16 v[132:133], v86 offset:13056
    ds_read_b64_tr_b16 v[134:135], v87 offset:13056
    ds_read_b128 a[16:19], v88 offset:256
    s_waitcnt lgkmcnt(9)
    v_mfma_f32_16x16x32_bf16 v[100:103], v[120:123], a[4:7], v[100:103]
    ds_read_b64_tr_b16 v[136:137], v86 offset:12800
    ds_read_b64_tr_b16 v[138:139], v87 offset:12800
    ds_read_b128 a[20:23], v88 offset:320
    s_waitcnt lgkmcnt(9)
    v_mfma_f32_16x16x32_bf16 v[100:103], v[124:127], a[8:11], v[100:103]
    ds_read_b64_tr_b16 v[140:141], v86 offset:12544
    ds_read_b64_tr_b16 v[142:143], v87 offset:12544
    ds_read_b128 a[24:27], v88 offset:384
    s_waitcnt lgkmcnt(9)
    v_mfma_f32_16x16x32_bf16 v[100:103], v[128:131], a[12:15], v[100:103]
    ds_read_b64_tr_b16 v[144:145], v86 offset:12288
    ds_read_b64_tr_b16 v[146:147], v87 offset:12288
    ds_read_b128 a[28:31], v88 offset:448
    s_waitcnt lgkmcnt(9)
    v_mfma_f32_16x16x32_bf16 v[100:103], v[132:135], a[16:19], v[100:103]
    ds_read_b64_tr_b16 v[116:117], v86 offset:12032
    ds_read_b64_tr_b16 v[118:119], v87 offset:12032
    ds_read_b128 a[32:35], v88 offset:512
    s_waitcnt lgkmcnt(9)
    v_mfma_f32_16x16x32_bf16 v[100:103], v[136:139], a[20:23], v[100:103]
    ds_read_b64_tr_b16 v[120:121], v86 offset:11776
    ds_read_b64_tr_b16 v[122:123], v87 offset:11776
    ds_read_b128 a[36:39], v88 offset:576
    s_waitcnt lgkmcnt(9)
    v_mfma_f32_16x16x32_bf16 v[100:103], v[140:143], a[24:27], v[100:103]
    ds_read_b64_tr_b16 v[124:125], v86 offset:11520
    ds_read_b64_tr_b16 v[126:127], v87 offset:11520
    ds_read_b128 a[40:43], v88 offset:640
    s_waitcnt lgkmcnt(9)
    v_mfma_f32_16x16x32_bf16 v[100:103], v[144:147], a[28:31], v[100:103]
    ds_read_b64_tr_b16 v[128:129], v86 offset:11264
    ds_read_b64_tr_b16 v[130:131], v87 offset:11264
    ds_read_b128 a[44:47], v88 offset:704
    s_waitcnt lgkmcnt(9)
    v_mfma_f32_16x16x32_bf16 v[100:103], v[116:119], a[32:35], v[100:103]
    ds_read_b64_tr_b16 v[132:133], v86 offset:11008
    ds_read_b64_tr_b16 v[134:135], v87 offset:11008
    ds_read_b128 a[48:51], v88 offset:768
    s_waitcnt lgkmcnt(9)
    v_mfma_f32_16x16x32_bf16 v[100:103], v[120:123], a[36:39], v[100:103]
    ds_read_b64_tr_b16 v[136:137], v86 offset:10752
    ds_read_b64_tr_b16 v[138:139], v87 offset:10752
    ds_read_b128 a[52:55], v88 offset:832
    s_waitcnt lgkmcnt(9)
    v_mfma_f32_16x16x32_bf16 v[100:103], v[124:127], a[40:43], v[100:103]
    ds_read_b64_tr_b16 v[140:141], v86 offset:10496
    ds_read_b64_tr_b16 v[142:143], v87 offset:10496
    ds_read_b128 a[56:59], v88 offset:896
    s_waitcnt lgkmcnt(9)
    v_mfma_f32_16x16x32_bf16 v[100:103], v[128:131], a[44:47], v[100:103]
    ds_read_b64_tr_b16 v[144:145], v86 offset:10240
    ds_read_b64_tr_b16 v[146:147], v87 offset:10240
    ds_read_b128 a[60:63], v88 offset:960
    s_waitcnt lgkmcnt(9)
    v_mfma_f32_16x16x32_bf16 v[100:103], v[132:135], a[48:51], v[100:103]
    ds_read_b64_tr_b16 v[116:117], v86 offset:9984
    ds_read_b64_tr_b16 v[118:119], v87 offset:9984
    ds_read_b128 a[64:67], v88 offset:1024
    s_waitcnt lgkmcnt(9)
    v_mfma_f32_16x16x32_bf16 v[100:103], v[136:139], a[52:55], v[100:103]
    ds_read_b64_tr_b16 v[120:121], v86 offset:9728
    ds_read_b64_tr_b16 v[122:123], v87 offset:9728
    ds_read_b128 a[68:71], v88 offset:1088
    s_waitcnt lgkmcnt(9)
    v_mfma_f32_16x16x32_bf16 v[100:103], v[140:143], a[56:59], v[100:103]
    ds_read_b64_tr_b16 v[124:125], v86 offset:9472
    ds_read_b64_tr_b16 v[126:127], v87 offset:9472
    ds_read_b128 a[72:75], v88 offset:1152
    s_waitcnt lgkmcnt(9)
    v_mfma_f32_16x16x32_bf16 v[100:103], v[144:147], a[60:63], v[100:103]
    ds_read_b64_tr_b16 v[128:129], v86 offset:9216
    ds_read_b64_tr_b16 v[130:131], v87 offset:9216
    ds_read_b128 a[76:79], v88 offset:1216
    s_waitcnt lgkmcnt(9)
    v_mfma_f32_16x16x32_bf16 v[100:103], v[116:119], a[64:67], v[100:103]
    ds_read_b64_tr_b16 v[132:133], v86 offset:8960
    ds_read_b64_tr_b16 v[134:135], v87 offset:8960
    v_mfma_f32_16x16x32_bf16 v[104:107], v[116:119], a[0:3], 0
    ds_read_b128 a[80:83], v88 offset:1280
    s_waitcnt lgkmcnt(9)
    v_mfma_f32_16x16x32_bf16 v[100:103], v[120:123], a[68:71], v[100:103]
    ds_read_b64_tr_b16 v[136:137], v86 offset:8704
    ds_read_b64_tr_b16 v[138:139], v87 offset:8704
    v_mfma_f32_16x16x32_bf16 v[104:107], v[120:123], a[4:7], v[104:107]
    ds_read_b128 a[84:87], v88 offset:1344
    s_waitcnt lgkmcnt(9)
    v_mfma_f32_16x16x32_bf16 v[100:103], v[124:127], a[72:75], v[100:103]
    ds_read_b64_tr_b16 v[140:141], v86 offset:8448
    ds_read_b64_tr_b16 v[142:143], v87 offset:8448
    v_mfma_f32_16x16x32_bf16 v[104:107], v[124:127], a[8:11], v[104:107]
    ds_read_b128 a[88:91], v88 offset:1408
    s_waitcnt lgkmcnt(9)
    v_mfma_f32_16x16x32_bf16 v[100:103], v[128:131], a[76:79], v[100:103]
    ds_read_b64_tr_b16 v[144:145], v86 offset:8192
    ds_read_b64_tr_b16 v[146:147], v87 offset:8192
    v_mfma_f32_16x16x32_bf16 v[104:107], v[128:131], a[12:15], v[104:107]
    ds_read_b128 a[92:95], v88 offset:1472
    s_waitcnt lgkmcnt(9)
    v_mfma_f32_16x16x32_bf16 v[100:103], v[132:135], a[80:83], v[100:103]
    ds_read_b64_tr_b16 v[116:117], v86 offset:7936
    ds_read_b64_tr_b16 v[118:119], v87 offset:7936
    v_mfma_f32_16x16x32_bf16 v[104:107], v[132:135], a[16:19], v[104:107]
    ds_read_b128 a[96:99], v88 offset:1536
    s_waitcnt lgkmcnt(9)
    v_mfma_f32_16x16x32_bf16 v[100:103], v[136:139], a[84:87], v[100:103]
    ds_read_b64_tr_b16 v[120:121], v86 offset:7680
    ds_read_b64_tr_b16 v[122:123], v87 offset:7680
    v_mfma_f32_16x16x32_bf16 v[104:107], v[136:139], a[20:23], v[104:107]
    ds_read_b128 a[100:103], v88 offset:1600
    s_waitcnt lgkmcnt(9)
    v_mfma_f32_16x16x32_bf16 v[100:103], v[140:143], a[88:91], v[100:103]
    ds_read_b64_tr_b16 v[124:125], v86 offset:7424
    ds_read_b64_tr_b16 v[126:127], v87 offset:7424
    v_mfma_f32_16x16x32_bf16 v[104:107], v[140:143], a[24:27], v[104:107]
    ds_read_b128 a[104:107], v88 offset:1664
    s_waitcnt lgkmcnt(9)
    v_mfma_f32_16x16x32_bf16 v[100:103], v[144:147], a[92:95], v[100:103]
    ds_read_b64_tr_b16 v[128:129], v86 offset:7168
    ds_read_b64_tr_b16 v[130:131], v87 offset:7168
    v_mfma_f32_16x16x32_bf16 v[104:107], v[144:147], a[28:31], v[104:107]
    ds_read_b128 a[108:111], v88 offset:1728
    s_waitcnt lgkmcnt(9)
    v_mfma_f32_16x16x32_bf16 v[100:103], v[116:119], a[96:99], v[100:103]
    ds_read_b64_tr_b16 v[132:133], v86 offset:6912
    ds_read_b64_tr_b16 v[134:135], v87 offset:6912
    v_mfma_f32_16x16x32_bf16 v[104:107], v[116:119], a[32:35], v[104:107]
    ds_read_b128 a[112:115], v88 offset:1792
    s_waitcnt vmcnt(0)
    v_mfma_f32_16x16x32_bf16 v[108:111], v[116:119], a[0:3], 0
    buffer_store_dword v69, v219, s[12:15], s71 offen sc1
    s_waitcnt lgkmcnt(9)
    v_mfma_f32_16x16x32_bf16 v[100:103], v[120:123], a[100:103], v[100:103]
    ds_read_b64_tr_b16 v[136:137], v86 offset:6656
    v_mfma_f32_16x16x32_bf16 v[104:107], v[120:123], a[36:39], v[104:107]
    ds_read_b64_tr_b16 v[138:139], v87 offset:6656
    v_mfma_f32_16x16x32_bf16 v[108:111], v[120:123], a[4:7], v[108:111]
    ds_read_b128 a[116:119], v88 offset:1856
    s_waitcnt lgkmcnt(9)
    v_mfma_f32_16x16x32_bf16 v[100:103], v[124:127], a[104:107], v[100:103]
    ds_read_b64_tr_b16 v[140:141], v86 offset:6400
    v_mfma_f32_16x16x32_bf16 v[104:107], v[124:127], a[40:43], v[104:107]
    ds_read_b64_tr_b16 v[142:143], v87 offset:6400
    v_mfma_f32_16x16x32_bf16 v[108:111], v[124:127], a[8:11], v[108:111]
    ds_read_b128 a[120:123], v88 offset:1920
    s_waitcnt lgkmcnt(9)
    v_mfma_f32_16x16x32_bf16 v[100:103], v[128:131], a[108:111], v[100:103]
    ds_read_b64_tr_b16 v[144:145], v86 offset:6144
    v_mfma_f32_16x16x32_bf16 v[104:107], v[128:131], a[44:47], v[104:107]
    ds_read_b64_tr_b16 v[146:147], v87 offset:6144
    v_mfma_f32_16x16x32_bf16 v[108:111], v[128:131], a[12:15], v[108:111]
    ds_read_b128 a[124:127], v88 offset:1984
    s_waitcnt lgkmcnt(9)
    v_mfma_f32_16x16x32_bf16 v[100:103], v[132:135], a[112:115], v[100:103]
    ds_read_b64_tr_b16 v[116:117], v86 offset:5888
    v_mfma_f32_16x16x32_bf16 v[104:107], v[132:135], a[48:51], v[104:107]
    ds_read_b64_tr_b16 v[118:119], v87 offset:5888
    v_mfma_f32_16x16x32_bf16 v[108:111], v[132:135], a[16:19], v[108:111]
    ds_read_b128 a[128:131], v88 offset:2048
    s_waitcnt lgkmcnt(9)
    v_mfma_f32_16x16x32_bf16 v[100:103], v[136:139], a[116:119], v[100:103]
    ds_read_b64_tr_b16 v[120:121], v86 offset:5632
    v_mfma_f32_16x16x32_bf16 v[104:107], v[136:139], a[52:55], v[104:107]
    ds_read_b64_tr_b16 v[122:123], v87 offset:5632
    v_mfma_f32_16x16x32_bf16 v[108:111], v[136:139], a[20:23], v[108:111]
    ds_read_b128 a[132:135], v88 offset:2112
    s_waitcnt lgkmcnt(9)
    v_mfma_f32_16x16x32_bf16 v[100:103], v[140:143], a[120:123], v[100:103]
    ds_read_b64_tr_b16 v[124:125], v86 offset:5376
    ds_read_b64_tr_b16 v[126:127], v87 offset:5376
    ds_read_b128 a[136:139], v88 offset:2176
    v_mfma_f32_16x16x32_bf16 v[104:107], v[140:143], a[56:59], v[104:107]
    ds_read_b32 v63, v64
    s_waitcnt lgkmcnt(0)
    s_mov_b32 s25, 0x100000
parallel_sum__ssm_conv_s4d__dense_activation_silu__prompt_kernel_tky:
    v_readfirstlane_b32 s33, v63
    s_sub_u32 s25, s25, 1
    s_cbranch_scc1 parallel_sum__ssm_conv_s4d__dense_activation_silu__prompt_kernel_tkdy
    s_cmp_lg_u32 s33, -1
    s_cbranch_scc1 parallel_sum__ssm_conv_s4d__dense_activation_silu__prompt_kernel_tkdy
    ds_read_b32 v63, v64
    s_waitcnt lgkmcnt(0)
    s_branch parallel_sum__ssm_conv_s4d__dense_activation_silu__prompt_kernel_tky
parallel_sum__ssm_conv_s4d__dense_activation_silu__prompt_kernel_tkdy:
    s_lshl_b32 s74, s40, 2
    s_add_u32 s74, s74, s33
    s_cmp_lt_u32 s33, 4
    s_cselect_b32 s33, s74, 0xff
    s_cmp_lt_u32 s33, 128
    s_cbranch_scc0 parallel_sum__ssm_conv_s4d__dense_activation_silu__prompt_kernel_nxy
    s_lshr_b32 s74, s33, 1
    s_add_u32 s74, s74, 512
    s_mul_i32 s52, s74, 8320
    s_add_u32 s52, s52, 35651896
    s_lshl_b32 s53, s74, 12
    s_add_u32 s53, s53, 2359296
    s_add_u32 m0, s20, 59648
    s_add_u32 s31, s53, 0
    buffer_load_dwordx4 v223, s[12:15], s31 offen sc1 lds
    s_add_u32 m0, s20, 42752
    s_add_u32 s31, s52, 0
    buffer_load_dwordx4 v85, s[12:15], s31 offen sc1 lds
    s_add_u32 m0, s20, 46848
    s_add_u32 s31, s52, 1024
    buffer_load_dwordx4 v85, s[12:15], s31 offen sc1 lds
    s_add_u32 m0, s20, 50944
    s_add_u32 s31, s52, 2048
    buffer_load_dwordx4 v85, s[12:15], s31 offen sc1 lds
    s_add_u32 m0, s20, 55040
    s_add_u32 s31, s52, 3072
    buffer_load_dwordx4 v85, s[12:15], s31 offen sc1 lds
parallel_sum__ssm_conv_s4d__dense_activation_silu__prompt_kernel_nxy:
    v_mfma_f32_16x16x32_bf16 v[108:111], v[140:143], a[24:27], v[108:111]
    v_mfma_f32_16x16x32_bf16 v[100:103], v[144:147], a[124:127], v[100:103]
    ds_read_b64_tr_b16 v[128:129], v86 offset:5120
    v_mfma_f32_16x16x32_bf16 v[104:107], v[144:147], a[60:63], v[104:107]
    ds_read_b64_tr_b16 v[130:131], v87 offset:5120
    v_mfma_f32_16x16x32_bf16 v[108:111], v[144:147], a[28:31], v[108:111]
    ds_read_b128 a[140:143], v88 offset:2240
    v_mfma_f32_16x16x32_bf16 v[100:103], v[116:119], a[128:131], v[100:103]
    ds_read_b64_tr_b16 v[132:133], v86 offset:4864
    v_mfma_f32_16x16x32_bf16 v[104:107], v[116:119], a[64:67], v[104:107]
    ds_read_b64_tr_b16 v[134:135], v87 offset:4864
    v_mfma_f32_16x16x32_bf16 v[108:111], v[116:119], a[32:35], v[108:111]
    ds_read_b128 a[144:147], v88 offset:2304
    v_mfma_f32_16x16x32_bf16 v[100:103], v[120:123], a[132:135], v[100:103]
    ds_read_b64_tr_b16 v[136:137], v86 offset:4608
    v_mfma_f32_16x16x32_bf16 v[104:107], v[120:123], a[68:71], v[104:107]
    ds_read_b64_tr_b16 v[138:139], v87 offset:4608
    v_mfma_f32_16x16x32_bf16 v[108:111], v[120:123], a[36:39], v[108:111]
    ds_read_b128 a[148:151], v88 offset:2368
    v_mfma_f32_16x16x32_bf16 v[100:103], v[124:127], a[136:139], v[100:103]
    ds_read_b64_tr_b16 v[140:141], v86 offset:4352
    v_mfma_f32_16x16x32_bf16 v[104:107], v[124:127], a[72:75], v[104:107]
    ds_read_b64_tr_b16 v[142:143], v87 offset:4352
    v_mfma_f32_16x16x32_bf16 v[108:111], v[124:127], a[40:43], v[108:111]
    ds_read_b128 a[152:155], v88 offset:2432
    s_waitcnt lgkmcnt(9)
    v_mfma_f32_16x16x32_bf16 v[100:103], v[128:131], a[140:143], v[100:103]
    ds_read_b64_tr_b16 v[144:145], v86 offset:4096
    v_mfma_f32_16x16x32_bf16 v[104:107], v[128:131], a[76:79], v[104:107]
    ds_read_b64_tr_b16 v[146:147], v87 offset:4096
    v_mfma_f32_16x16x32_bf16 v[108:111], v[128:131], a[44:47], v[108:111]
    ds_read_b128 a[156:159], v88 offset:2496
    s_waitcnt lgkmcnt(9)
    v_mfma_f32_16x16x32_bf16 v[100:103], v[132:135], a[144:147], v[100:103]
    ds_read_b64_tr_b16 v[116:117], v86 offset:3840
    v_mfma_f32_16x16x32_bf16 v[104:107], v[132:135], a[80:83], v[104:107]
    ds_read_b64_tr_b16 v[118:119], v87 offset:3840
    v_mfma_f32_16x16x32_bf16 v[108:111], v[132:135], a[48:51], v[108:111]
    ds_read_b128 a[160:163], v88 offset:2560
    s_waitcnt lgkmcnt(9)
    v_mfma_f32_16x16x32_bf16 v[100:103], v[136:139], a[148:151], v[100:103]
    ds_read_b64_tr_b16 v[120:121], v86 offset:3584
    v_mfma_f32_16x16x32_bf16 v[104:107], v[136:139], a[84:87], v[104:107]
    ds_read_b64_tr_b16 v[122:123], v87 offset:3584
    v_mfma_f32_16x16x32_bf16 v[108:111], v[136:139], a[52:55], v[108:111]
    ds_read_b128 a[164:167], v88 offset:2624
    s_waitcnt lgkmcnt(9)
    v_mfma_f32_16x16x32_bf16 v[100:103], v[140:143], a[152:155], v[100:103]
    ds_read_b64_tr_b16 v[124:125], v86 offset:3328
    v_mfma_f32_16x16x32_bf16 v[104:107], v[140:143], a[88:91], v[104:107]
    ds_read_b64_tr_b16 v[126:127], v87 offset:3328
    v_mfma_f32_16x16x32_bf16 v[108:111], v[140:143], a[56:59], v[108:111]
    ds_read_b128 a[168:171], v88 offset:2688
    s_waitcnt lgkmcnt(9)
    v_mfma_f32_16x16x32_bf16 v[100:103], v[144:147], a[156:159], v[100:103]
    ds_read_b64_tr_b16 v[128:129], v86 offset:3072
    v_mfma_f32_16x16x32_bf16 v[104:107], v[144:147], a[92:95], v[104:107]
    ds_read_b64_tr_b16 v[130:131], v87 offset:3072
    v_mfma_f32_16x16x32_bf16 v[108:111], v[144:147], a[60:63], v[108:111]
    ds_read_b128 a[172:175], v88 offset:2752
    s_waitcnt lgkmcnt(9)
    v_mfma_f32_16x16x32_bf16 v[100:103], v[116:119], a[160:163], v[100:103]
    ds_read_b64_tr_b16 v[132:133], v86 offset:2816
    v_mfma_f32_16x16x32_bf16 v[104:107], v[116:119], a[96:99], v[104:107]
    ds_read_b64_tr_b16 v[134:135], v87 offset:2816
    v_mfma_f32_16x16x32_bf16 v[108:111], v[116:119], a[64:67], v[108:111]
    ds_read_b128 a[176:179], v88 offset:2816
    v_mfma_f32_16x16x32_bf16 v[112:115], v[116:119], a[0:3], 0
    s_waitcnt lgkmcnt(9)
    v_mfma_f32_16x16x32_bf16 v[100:103], v[120:123], a[164:167], v[100:103]
    ds_read_b64_tr_b16 v[136:137], v86 offset:2560
    v_mfma_f32_16x16x32_bf16 v[104:107], v[120:123], a[100:103], v[104:107]
    ds_read_b64_tr_b16 v[138:139], v87 offset:2560
    v_mfma_f32_16x16x32_bf16 v[108:111], v[120:123], a[68:71], v[108:111]
    ds_read_b128 a[180:183], v88 offset:2880
    v_mfma_f32_16x16x32_bf16 v[112:115], v[120:123], a[4:7], v[112:115]
    s_waitcnt lgkmcnt(9)
    v_mfma_f32_16x16x32_bf16 v[100:103], v[124:127], a[168:171], v[100:103]
    ds_read_b64_tr_b16 v[140:141], v86 offset:2304
    v_mfma_f32_16x16x32_bf16 v[104:107], v[124:127], a[104:107], v[104:107]
    ds_read_b64_tr_b16 v[142:143], v87 offset:2304
    v_mfma_f32_16x16x32_bf16 v[108:111], v[124:127], a[72:75], v[108:111]
    ds_read_b128 a[184:187], v88 offset:2944
    v_mfma_f32_16x16x32_bf16 v[112:115], v[124:127], a[8:11], v[112:115]
    s_waitcnt lgkmcnt(9)
    v_mfma_f32_16x16x32_bf16 v[100:103], v[128:131], a[172:175], v[100:103]
    ds_read_b64_tr_b16 v[144:145], v86 offset:2048
    v_mfma_f32_16x16x32_bf16 v[104:107], v[128:131], a[108:111], v[104:107]
    ds_read_b64_tr_b16 v[146:147], v87 offset:2048
    v_mfma_f32_16x16x32_bf16 v[108:111], v[128:131], a[76:79], v[108:111]
    ds_read_b128 a[188:191], v88 offset:3008
    v_mfma_f32_16x16x32_bf16 v[112:115], v[128:131], a[12:15], v[112:115]
    s_waitcnt lgkmcnt(9)
    v_mfma_f32_16x16x32_bf16 v[100:103], v[132:135], a[176:179], v[100:103]
    ds_read_b64_tr_b16 v[116:117], v86 offset:1792
    v_mfma_f32_16x16x32_bf16 v[104:107], v[132:135], a[112:115], v[104:107]
    ds_read_b64_tr_b16 v[118:119], v87 offset:1792
    v_mfma_f32_16x16x32_bf16 v[108:111], v[132:135], a[80:83], v[108:111]
    ds_read_b128 a[192:195], v88 offset:3072
    v_mfma_f32_16x16x32_bf16 v[112:115], v[132:135], a[16:19], v[112:115]
    s_waitcnt lgkmcnt(9)
    v_mfma_f32_16x16x32_bf16 v[100:103], v[136:139], a[180:183], v[100:103]
    ds_read_b64_tr_b16 v[120:121], v86 offset:1536
    v_mfma_f32_16x16x32_bf16 v[104:107], v[136:139], a[116:119], v[104:107]
    ds_read_b64_tr_b16 v[122:123], v87 offset:1536
    v_mfma_f32_16x16x32_bf16 v[108:111], v[136:139], a[84:87], v[108:111]
    ds_read_b128 a[196:199], v88 offset:3136
    v_mfma_f32_16x16x32_bf16 v[112:115], v[136:139], a[20:23], v[112:115]
    s_waitcnt lgkmcnt(9)
    v_mfma_f32_16x16x32_bf16 v[100:103], v[140:143], a[184:187], v[100:103]
    ds_read_b64_tr_b16 v[124:125], v86 offset:1280
    v_mfma_f32_16x16x32_bf16 v[104:107], v[140:143], a[120:123], v[104:107]
    ds_read_b64_tr_b16 v[126:127], v87 offset:1280
    v_mfma_f32_16x16x32_bf16 v[108:111], v[140:143], a[88:91], v[108:111]
    ds_read_b128 a[200:203], v88 offset:3200
    v_mfma_f32_16x16x32_bf16 v[112:115], v[140:143], a[24:27], v[112:115]
    buffer_load_dword v70, v71, s[12:15], s63 offen sc1
    s_waitcnt lgkmcnt(9)
    v_mfma_f32_16x16x32_bf16 v[100:103], v[144:147], a[188:191], v[100:103]
    ds_read_b64_tr_b16 v[128:129], v86 offset:1024
    v_mfma_f32_16x16x32_bf16 v[104:107], v[144:147], a[124:127], v[104:107]
    ds_read_b64_tr_b16 v[130:131], v87 offset:1024
    v_mfma_f32_16x16x32_bf16 v[108:111], v[144:147], a[92:95], v[108:111]
    ds_read_b128 a[204:207], v88 offset:3264
    v_mfma_f32_16x16x32_bf16 v[112:115], v[144:147], a[28:31], v[112:115]
    s_waitcnt lgkmcnt(9)
    v_mfma_f32_16x16x32_bf16 v[100:103], v[116:119], a[192:195], v[100:103]
    ds_read_b64_tr_b16 v[132:133], v86 offset:768
    v_mfma_f32_16x16x32_bf16 v[104:107], v[116:119], a[128:131], v[104:107]
    ds_read_b64_tr_b16 v[134:135], v87 offset:768
    v_mfma_f32_16x16x32_bf16 v[108:111], v[116:119], a[96:99], v[108:111]
    ds_read_b128 a[208:211], v88 offset:3328
    v_mfma_f32_16x16x32_bf16 v[112:115], v[116:119], a[32:35], v[112:115]
    s_waitcnt lgkmcnt(9)
    v_mfma_f32_16x16x32_bf16 v[100:103], v[120:123], a[196:199], v[100:103]
    ds_read_b64_tr_b16 v[136:137], v86 offset:512
    v_mfma_f32_16x16x32_bf16 v[104:107], v[120:123], a[132:135], v[104:107]
    ds_read_b64_tr_b16 v[138:139], v87 offset:512
    v_mfma_f32_16x16x32_bf16 v[108:111], v[120:123], a[100:103], v[108:111]
    ds_read_b128 a[212:215], v88 offset:3392
    v_mfma_f32_16x16x32_bf16 v[112:115], v[120:123], a[36:39], v[112:115]
    s_waitcnt lgkmcnt(9)
    v_mfma_f32_16x16x32_bf16 v[100:103], v[124:127], a[200:203], v[100:103]
    ds_read_b64_tr_b16 v[140:141], v86 offset:256
    v_mfma_f32_16x16x32_bf16 v[104:107], v[124:127], a[136:139], v[104:107]
    ds_read_b64_tr_b16 v[142:143], v87 offset:256
    v_mfma_f32_16x16x32_bf16 v[108:111], v[124:127], a[104:107], v[108:111]
    ds_read_b128 a[216:219], v88 offset:3456
    v_mfma_f32_16x16x32_bf16 v[112:115], v[124:127], a[40:43], v[112:115]
    s_waitcnt lgkmcnt(9)
    v_mfma_f32_16x16x32_bf16 v[100:103], v[128:131], a[204:207], v[100:103]
    ds_read_b64_tr_b16 v[144:145], v86 offset:0
    v_mfma_f32_16x16x32_bf16 v[104:107], v[128:131], a[140:143], v[104:107]
    ds_read_b64_tr_b16 v[146:147], v87 offset:0
    v_mfma_f32_16x16x32_bf16 v[108:111], v[128:131], a[108:111], v[108:111]
    ds_read_b128 a[220:223], v88 offset:3520
    v_mfma_f32_16x16x32_bf16 v[112:115], v[128:131], a[44:47], v[112:115]
    s_waitcnt lgkmcnt(9)
    v_mfma_f32_16x16x32_bf16 v[100:103], v[132:135], a[208:211], v[100:103]
    v_mfma_f32_16x16x32_bf16 v[104:107], v[132:135], a[144:147], v[104:107]
    v_mfma_f32_16x16x32_bf16 v[108:111], v[132:135], a[112:115], v[108:111]
    v_mfma_f32_16x16x32_bf16 v[112:115], v[132:135], a[48:51], v[112:115]
    s_waitcnt lgkmcnt(6)
    v_mfma_f32_16x16x32_bf16 v[100:103], v[136:139], a[212:215], v[100:103]
    v_mfma_f32_16x16x32_bf16 v[104:107], v[136:139], a[148:151], v[104:107]
    v_mfma_f32_16x16x32_bf16 v[108:111], v[136:139], a[116:119], v[108:111]
    v_mfma_f32_16x16x32_bf16 v[112:115], v[136:139], a[52:55], v[112:115]
    s_waitcnt lgkmcnt(3)
    v_mfma_f32_16x16x32_bf16 v[100:103], v[140:143], a[216:219], v[100:103]
    v_mfma_f32_16x16x32_bf16 v[104:107], v[140:143], a[152:155], v[104:107]
    v_mfma_f32_16x16x32_bf16 v[108:111], v[140:143], a[120:123], v[108:111]
    v_mfma_f32_16x16x32_bf16 v[112:115], v[140:143], a[56:59], v[112:115]
    s_waitcnt lgkmcnt(0)
    v_mfma_f32_16x16x32_bf16 v[100:103], v[144:147], a[220:223], v[100:103]
    v_mfma_f32_16x16x32_bf16 v[104:107], v[144:147], a[156:159], v[104:107]
    v_mfma_f32_16x16x32_bf16 v[108:111], v[144:147], a[124:127], v[108:111]
    v_mfma_f32_16x16x32_bf16 v[112:115], v[144:147], a[60:63], v[112:115]
    s_nop 4
    v_cvt_pk_bf16_f32 v72, v100, v101
    v_cvt_pk_bf16_f32 v73, v102, v103
    buffer_store_dwordx2 v[72:73], v89, s[12:15], s70 offen offset:3072 sc1
    v_cvt_pk_bf16_f32 v74, v104, v105
    v_cvt_pk_bf16_f32 v75, v106, v107
    buffer_store_dwordx2 v[74:75], v89, s[12:15], s70 offen offset:2048 sc1
    v_cvt_pk_bf16_f32 v76, v108, v109
    v_cvt_pk_bf16_f32 v77, v110, v111
    buffer_store_dwordx2 v[76:77], v89, s[12:15], s70 offen offset:1536 sc1
    v_cvt_pk_bf16_f32 v78, v112, v113
    v_cvt_pk_bf16_f32 v79, v114, v115
    buffer_store_dwordx2 v[78:79], v89, s[12:15], s70 offen offset:512 sc1
    s_waitcnt vmcnt(4)
parallel_sum__ssm_conv_s4d__dense_activation_silu__prompt_kernel_convd:
    s_waitcnt lgkmcnt(0)
    s_and_b32 s9, s9, 0xffff
    s_mov_b32 s10, 2359296
    s_cmp_lt_u32 s33, 128
    s_cbranch_scc0 parallel_sum__ssm_conv_s4d__dense_activation_silu__prompt_kernel_tail
    s_movk_i32 s76, 0x0257
    s_and_b32 s74, s33, 1
    s_cselect_b32 s74, 0x1346, s76
    s_lshl_b32 s75, s3, 2
    s_lshr_b32 s74, s74, s75
    s_and_b32 s74, s74, 15
    s_lshr_b32 s76, s3, 1
    s_sub_u32 s75, 2, s76
    s_mul_i32 s75, s75, 21248
    s_lshl_b32 s76, s76, 12
    s_add_u32 s70, s53, 4980736
    s_sub_u32 s70, s70, s76
    s_lshl_b32 s76, s74, 9
    s_add_u32 s70, s70, s76
    v_add_u32 v86, s75, v86
    v_add_u32 v87, s75, v87
    s_add_u32 s75, s75, s76
    s_sub_u32 s75, s75, 512
    v_add_u32 v88, s75, v88
    v_mov_b32 v100, 0
    v_mov_b32 v101, 0
    v_mov_b32 v102, 0
    v_mov_b32 v103, 0
    s_waitcnt vmcnt(5)
    s_barrier
    s_lshl_b32 s56, s33, 7
    s_add_u32 s56, s56, 9895936
    buffer_load_dword v70, v71, s[12:15], s63 offen sc1
    ds_read_b64_tr_b16 v[116:117], v86 offset:0
    ds_read_b64_tr_b16 v[118:119], v87 offset:0
    ds_read_b128 v[120:123], v88 offset:960
    ds_read_b64_tr_b16 v[124:125], v86 offset:256
    ds_read_b64_tr_b16 v[126:127], v87 offset:256
    ds_read_b128 v[128:131], v88 offset:896
    ds_read_b64_tr_b16 v[132:133], v86 offset:512
    ds_read_b64_tr_b16 v[134:135], v87 offset:512
    ds_read_b128 v[136:139], v88 offset:832
.p2align 5
parallel_sum__ssm_conv_s4d__dense_activation_silu__prompt_kernel_xl:
    s_waitcnt lgkmcnt(6)
    v_mfma_f32_16x16x32_bf16 v[100:103], v[116:119], v[120:123], v[100:103]
    ds_read_b64_tr_b16 v[140:141], v86 offset:768
    ds_read_b64_tr_b16 v[142:143], v87 offset:768
    ds_read_b128 v[144:147], v88 offset:768
    s_waitcnt lgkmcnt(6)
    v_mfma_f32_16x16x32_bf16 v[100:103], v[124:127], v[128:131], v[100:103]
    ds_read_b64_tr_b16 v[116:117], v86 offset:1024
    ds_read_b64_tr_b16 v[118:119], v87 offset:1024
    ds_read_b128 v[120:123], v88 offset:704
    s_waitcnt lgkmcnt(6)
    v_mfma_f32_16x16x32_bf16 v[100:103], v[132:135], v[136:139], v[100:103]
    ds_read_b64_tr_b16 v[124:125], v86 offset:1280
    ds_read_b64_tr_b16 v[126:127], v87 offset:1280
    ds_read_b128 v[128:131], v88 offset:640
    s_waitcnt lgkmcnt(6)
    v_mfma_f32_16x16x32_bf16 v[100:103], v[140:143], v[144:147], v[100:103]
    ds_read_b64_tr_b16 v[132:133], v86 offset:1536
    ds_read_b64_tr_b16 v[134:135], v87 offset:1536
    ds_read_b128 v[136:139], v88 offset:576
    s_waitcnt lgkmcnt(6)
    v_mfma_f32_16x16x32_bf16 v[100:103], v[116:119], v[120:123], v[100:103]
    ds_read_b64_tr_b16 v[140:141], v86 offset:1792
    ds_read_b64_tr_b16 v[142:143], v87 offset:1792
    ds_read_b128 v[144:147], v88 offset:512
    s_waitcnt lgkmcnt(6)
    v_mfma_f32_16x16x32_bf16 v[100:103], v[124:127], v[128:131], v[100:103]
    ds_read_b64_tr_b16 v[116:117], v86 offset:2048
    ds_read_b64_tr_b16 v[118:119], v87 offset:2048
    ds_read_b128 v[120:123], v88 offset:448
    s_waitcnt lgkmcnt(6)
    v_mfma_f32_16x16x32_bf16 v[100:103], v[132:135], v[136:139], v[100:103]
    ds_read_b64_tr_b16 v[124:125], v86 offset:2304
    ds_read_b64_tr_b16 v[126:127], v87 offset:2304
    ds_read_b128 v[128:131], v88 offset:384
    s_waitcnt lgkmcnt(6)
    v_mfma_f32_16x16x32_bf16 v[100:103], v[140:143], v[144:147], v[100:103]
    ds_read_b64_tr_b16 v[132:133], v86 offset:2560
    ds_read_b64_tr_b16 v[134:135], v87 offset:2560
    ds_read_b128 v[136:139], v88 offset:320
    v_add_u32 v86, 0x800, v86
    v_add_u32 v87, 0x800, v87
    v_add_u32 v88, 0xfffffe00, v88
    s_sub_u32 s74, s74, 1
    s_cbranch_scc0 parallel_sum__ssm_conv_s4d__dense_activation_silu__prompt_kernel_xl
    s_waitcnt vmcnt(0) lgkmcnt(0)
    v_cvt_pk_bf16_f32 v72, v100, v101
    v_cvt_pk_bf16_f32 v73, v102, v103
    buffer_store_dwordx2 v[72:73], v89, s[12:15], s70 offen sc1
parallel_sum__ssm_conv_s4d__dense_activation_silu__prompt_kernel_tail:
    s_cmp_eq_u32 s3, 3
    s_cbranch_scc1 parallel_sum__ssm_conv_s4d__dense_activation_silu__prompt_kernel_yw
    s_mov_b32 s25, 0x40000
    v_cmp_ne_u32 vcc, s61, v70
    s_nop 4
    s_cbranch_vccnz parallel_sum__ssm_conv_s4d__dense_activation_silu__prompt_kernel_slow
    buffer_load_dwordx4 v[100:103], v99, s[12:15], s64 offen offset:0 sc1
    buffer_load_dwordx4 v[104:107], v99, s[12:15], s64 offen offset:2048 sc1
    buffer_load_dwordx4 v[108:111], v66, s[12:15], s64 offen offset:0 sc1
    s_add_u32 s64, s64, 2359296
    s_cmp_eq_u32 s64, s66
    s_cselect_b32 s64, s67, s64
    buffer_load_dwordx4 v[112:115], v99, s[12:15], s64 offen offset:0 sc1
    buffer_load_dwordx4 v[116:119], v99, s[12:15], s64 offen offset:2048 sc1
    buffer_load_dwordx4 v[120:123], v66, s[12:15], s64 offen offset:0 sc1
    s_add_u32 s64, s64, 2359296
    s_cmp_eq_u32 s64, s66
    s_cselect_b32 s64, s67, s64
    s_waitcnt vmcnt(6)
    s_barrier
    s_cmp_lg_u32 s3, 0
    s_cbranch_scc1 parallel_sum__ssm_conv_s4d__dense_activation_silu__prompt_kernel_nfa
    buffer_store_dword v69, v219, s[12:15], s57 offen sc1
    buffer_store_dword v69, v219, s[12:15], s56 offen sc1
parallel_sum__ssm_conv_s4d__dense_activation_silu__prompt_kernel_nfa:
    buffer_load_dwordx4 v[124:127], v99, s[12:15], s64 offen offset:0 sc1
    buffer_load_dwordx4 v[128:131], v99, s[12:15], s64 offen offset:2048 sc1
    buffer_load_dwordx4 v[132:135], v66, s[12:15], s64 offen offset:0 sc1
    s_add_u32 s64, s64, 2359296
    s_cmp_eq_u32 s64, s66
    s_cselect_b32 s64, s67, s64
    buffer_load_dwordx4 v[136:139], v99, s[12:15], s64 offen offset:0 sc1
    buffer_load_dwordx4 v[140:143], v99, s[12:15], s64 offen offset:2048 sc1
    buffer_load_dwordx4 v[144:147], v66, s[12:15], s64 offen offset:0 sc1
    s_add_u32 s64, s64, 2359296
    s_cmp_eq_u32 s64, s66
    s_cselect_b32 s64, s67, s64
    buffer_load_dwordx4 v[148:151], v99, s[12:15], s64 offen offset:0 sc1
    buffer_load_dwordx4 v[152:155], v99, s[12:15], s64 offen offset:2048 sc1
    buffer_load_dwordx4 v[156:159], v66, s[12:15], s64 offen offset:0 sc1
    s_add_u32 s64, s64, 2359296
    s_cmp_eq_u32 s64, s66
    s_cselect_b32 s64, s67, s64
    buffer_load_dwordx4 v[160:163], v99, s[12:15], s64 offen offset:0 sc1
    buffer_load_dwordx4 v[164:167], v99, s[12:15], s64 offen offset:2048 sc1
    buffer_load_dwordx4 v[168:171], v66, s[12:15], s64 offen offset:0 sc1
    s_add_u32 s64, s64, 2359296
    s_cmp_eq_u32 s64, s66
    s_cselect_b32 s64, s67, s64
    buffer_load_dwordx4 v[172:175], v99, s[12:15], s64 offen offset:0 sc1
    buffer_load_dwordx4 v[176:179], v99, s[12:15], s64 offen offset:2048 sc1
    buffer_load_dwordx4 v[180:183], v66, s[12:15], s64 offen offset:0 sc1
    s_add_u32 s64, s64, 2359296
    s_cmp_eq_u32 s64, s66
    s_cselect_b32 s64, s67, s64
    buffer_load_dwordx4 v[184:187], v99, s[12:15], s64 offen offset:0 sc1
    buffer_load_dwordx4 v[188:191], v99, s[12:15], s64 offen offset:2048 sc1
    buffer_load_dwordx4 v[192:195], v66, s[12:15], s64 offen offset:0 sc1
    s_branch parallel_sum__ssm_conv_s4d__dense_activation_silu__prompt_kernel_p2e
parallel_sum__ssm_conv_s4d__dense_activation_silu__prompt_kernel_slow:
    buffer_load_dword v70, v71, s[12:15], s63 offen sc1
    s_waitcnt vmcnt(1)
    s_barrier
    s_cmp_lg_u32 s3, 0
    s_cbranch_scc1 parallel_sum__ssm_conv_s4d__dense_activation_silu__prompt_kernel_nfb
    buffer_store_dword v69, v219, s[12:15], s57 offen sc1
    buffer_store_dword v69, v219, s[12:15], s56 offen sc1
parallel_sum__ssm_conv_s4d__dense_activation_silu__prompt_kernel_nfb:
parallel_sum__ssm_conv_s4d__dense_activation_silu__prompt_kernel_p2:
    s_waitcnt vmcnt(0)
    v_cmp_ne_u32 vcc, s61, v70
    s_sub_u32 s25, s25, 1
    s_cbranch_scc1 parallel_sum__ssm_conv_s4d__dense_activation_silu__prompt_kernel_p2d
    s_nop 3
    s_cbranch_vccz parallel_sum__ssm_conv_s4d__dense_activation_silu__prompt_kernel_p2d
    buffer_load_dword v70, v71, s[12:15], s63 offen sc1
    s_branch parallel_sum__ssm_conv_s4d__dense_activation_silu__prompt_kernel_p2
parallel_sum__ssm_conv_s4d__dense_activation_silu__prompt_kernel_p2d:
    buffer_load_dwordx4 v[100:103], v99, s[12:15], s64 offen offset:0 sc1
    buffer_load_dwordx4 v[104:107], v99, s[12:15], s64 offen offset:2048 sc1
    buffer_load_dwordx4 v[108:111], v66, s[12:15], s64 offen offset:0 sc1
    s_add_u32 s64, s64, 2359296
    s_cmp_eq_u32 s64, s66
    s_cselect_b32 s64, s67, s64
    buffer_load_dwordx4 v[112:115], v99, s[12:15], s64 offen offset:0 sc1
    buffer_load_dwordx4 v[116:119], v99, s[12:15], s64 offen offset:2048 sc1
    buffer_load_dwordx4 v[120:123], v66, s[12:15], s64 offen offset:0 sc1
    s_add_u32 s64, s64, 2359296
    s_cmp_eq_u32 s64, s66
    s_cselect_b32 s64, s67, s64
    buffer_load_dwordx4 v[124:127], v99, s[12:15], s64 offen offset:0 sc1
    buffer_load_dwordx4 v[128:131], v99, s[12:15], s64 offen offset:2048 sc1
    buffer_load_dwordx4 v[132:135], v66, s[12:15], s64 offen offset:0 sc1
    s_add_u32 s64, s64, 2359296
    s_cmp_eq_u32 s64, s66
    s_cselect_b32 s64, s67, s64
    buffer_load_dwordx4 v[136:139], v99, s[12:15], s64 offen offset:0 sc1
    buffer_load_dwordx4 v[140:143], v99, s[12:15], s64 offen offset:2048 sc1
    buffer_load_dwordx4 v[144:147], v66, s[12:15], s64 offen offset:0 sc1
    s_add_u32 s64, s64, 2359296
    s_cmp_eq_u32 s64, s66
    s_cselect_b32 s64, s67, s64
    buffer_load_dwordx4 v[148:151], v99, s[12:15], s64 offen offset:0 sc1
    buffer_load_dwordx4 v[152:155], v99, s[12:15], s64 offen offset:2048 sc1
    buffer_load_dwordx4 v[156:159], v66, s[12:15], s64 offen offset:0 sc1
    s_add_u32 s64, s64, 2359296
    s_cmp_eq_u32 s64, s66
    s_cselect_b32 s64, s67, s64
    buffer_load_dwordx4 v[160:163], v99, s[12:15], s64 offen offset:0 sc1
    buffer_load_dwordx4 v[164:167], v99, s[12:15], s64 offen offset:2048 sc1
    buffer_load_dwordx4 v[168:171], v66, s[12:15], s64 offen offset:0 sc1
    s_add_u32 s64, s64, 2359296
    s_cmp_eq_u32 s64, s66
    s_cselect_b32 s64, s67, s64
    buffer_load_dwordx4 v[172:175], v99, s[12:15], s64 offen offset:0 sc1
    buffer_load_dwordx4 v[176:179], v99, s[12:15], s64 offen offset:2048 sc1
    buffer_load_dwordx4 v[180:183], v66, s[12:15], s64 offen offset:0 sc1
    s_add_u32 s64, s64, 2359296
    s_cmp_eq_u32 s64, s66
    s_cselect_b32 s64, s67, s64
    buffer_load_dwordx4 v[184:187], v99, s[12:15], s64 offen offset:0 sc1
    buffer_load_dwordx4 v[188:191], v99, s[12:15], s64 offen offset:2048 sc1
    buffer_load_dwordx4 v[192:195], v66, s[12:15], s64 offen offset:0 sc1
parallel_sum__ssm_conv_s4d__dense_activation_silu__prompt_kernel_p2e:
    s_mov_b32 s74, 0x00003f80
    s_mov_b32 s75, 0x3f800000
    v_dot2_f32_bf16 v8, v196, s74, 0
    v_dot2_f32_bf16 v9, v196, s75, 0
    v_dot2_f32_bf16 v10, v197, s74, 0
    v_dot2_f32_bf16 v11, v197, s75, 0
    v_dot2_f32_bf16 v12, v198, s74, 0
    v_dot2_f32_bf16 v13, v198, s75, 0
    v_dot2_f32_bf16 v14, v199, s74, 0
    v_dot2_f32_bf16 v15, v199, s75, 0
    v_dot2_f32_bf16 v16, v200, s74, 0
    v_dot2_f32_bf16 v17, v200, s75, 0
    v_dot2_f32_bf16 v18, v201, s74, 0
    v_dot2_f32_bf16 v19, v201, s75, 0
    v_dot2_f32_bf16 v20, v202, s74, 0
    v_dot2_f32_bf16 v21, v202, s75, 0
    v_dot2_f32_bf16 v22, v203, s74, 0
    v_dot2_f32_bf16 v23, v203, s75, 0
    v_dot2_f32_bf16 v24, v204, s74, 0
    v_dot2_f32_bf16 v25, v204, s75, 0
    v_dot2_f32_bf16 v26, v205, s74, 0
    v_dot2_f32_bf16 v27, v205, s75, 0
    v_dot2_f32_bf16 v28, v206, s74, 0
    v_dot2_f32_bf16 v29, v206, s75, 0
    v_dot2_f32_bf16 v30, v207, s74, 0
    v_dot2_f32_bf16 v31, v207, s75, 0
    s_waitcnt vmcnt(21)
    v_dot2_f32_bf16 v8, v100, s74, v8
    v_dot2_f32_bf16 v9, v100, s75, v9
    v_dot2_f32_bf16 v10, v101, s74, v10
    v_dot2_f32_bf16 v11, v101, s75, v11
    v_dot2_f32_bf16 v12, v102, s74, v12
    v_dot2_f32_bf16 v13, v102, s75, v13
    v_dot2_f32_bf16 v14, v103, s74, v14
    v_dot2_f32_bf16 v15, v103, s75, v15
    v_dot2_f32_bf16 v16, v104, s74, v16
    v_dot2_f32_bf16 v17, v104, s75, v17
    v_dot2_f32_bf16 v18, v105, s74, v18
    v_dot2_f32_bf16 v19, v105, s75, v19
    v_dot2_f32_bf16 v20, v106, s74, v20
    v_dot2_f32_bf16 v21, v106, s75, v21
    v_dot2_f32_bf16 v22, v107, s74, v22
    v_dot2_f32_bf16 v23, v107, s75, v23
    v_dot2_f32_bf16 v24, v108, s74, v24
    v_dot2_f32_bf16 v25, v108, s75, v25
    v_dot2_f32_bf16 v26, v109, s74, v26
    v_dot2_f32_bf16 v27, v109, s75, v27
    v_dot2_f32_bf16 v28, v110, s74, v28
    v_dot2_f32_bf16 v29, v110, s75, v29
    v_dot2_f32_bf16 v30, v111, s74, v30
    v_dot2_f32_bf16 v31, v111, s75, v31
    s_waitcnt vmcnt(18)
    v_dot2_f32_bf16 v8, v112, s74, v8
    v_dot2_f32_bf16 v9, v112, s75, v9
    v_dot2_f32_bf16 v10, v113, s74, v10
    v_dot2_f32_bf16 v11, v113, s75, v11
    v_dot2_f32_bf16 v12, v114, s74, v12
    v_dot2_f32_bf16 v13, v114, s75, v13
    v_dot2_f32_bf16 v14, v115, s74, v14
    v_dot2_f32_bf16 v15, v115, s75, v15
    v_dot2_f32_bf16 v16, v116, s74, v16
    v_dot2_f32_bf16 v17, v116, s75, v17
    v_dot2_f32_bf16 v18, v117, s74, v18
    v_dot2_f32_bf16 v19, v117, s75, v19
    v_dot2_f32_bf16 v20, v118, s74, v20
    v_dot2_f32_bf16 v21, v118, s75, v21
    v_dot2_f32_bf16 v22, v119, s74, v22
    v_dot2_f32_bf16 v23, v119, s75, v23
    v_dot2_f32_bf16 v24, v120, s74, v24
    v_dot2_f32_bf16 v25, v120, s75, v25
    v_dot2_f32_bf16 v26, v121, s74, v26
    v_dot2_f32_bf16 v27, v121, s75, v27
    v_dot2_f32_bf16 v28, v122, s74, v28
    v_dot2_f32_bf16 v29, v122, s75, v29
    v_dot2_f32_bf16 v30, v123, s74, v30
    v_dot2_f32_bf16 v31, v123, s75, v31
    s_waitcnt vmcnt(15)
    v_dot2_f32_bf16 v8, v124, s74, v8
    v_dot2_f32_bf16 v9, v124, s75, v9
    v_dot2_f32_bf16 v10, v125, s74, v10
    v_dot2_f32_bf16 v11, v125, s75, v11
    v_dot2_f32_bf16 v12, v126, s74, v12
    v_dot2_f32_bf16 v13, v126, s75, v13
    v_dot2_f32_bf16 v14, v127, s74, v14
    v_dot2_f32_bf16 v15, v127, s75, v15
    v_dot2_f32_bf16 v16, v128, s74, v16
    v_dot2_f32_bf16 v17, v128, s75, v17
    v_dot2_f32_bf16 v18, v129, s74, v18
    v_dot2_f32_bf16 v19, v129, s75, v19
    v_dot2_f32_bf16 v20, v130, s74, v20
    v_dot2_f32_bf16 v21, v130, s75, v21
    v_dot2_f32_bf16 v22, v131, s74, v22
    v_dot2_f32_bf16 v23, v131, s75, v23
    v_dot2_f32_bf16 v24, v132, s74, v24
    v_dot2_f32_bf16 v25, v132, s75, v25
    v_dot2_f32_bf16 v26, v133, s74, v26
    v_dot2_f32_bf16 v27, v133, s75, v27
    v_dot2_f32_bf16 v28, v134, s74, v28
    v_dot2_f32_bf16 v29, v134, s75, v29
    v_dot2_f32_bf16 v30, v135, s74, v30
    v_dot2_f32_bf16 v31, v135, s75, v31
    s_waitcnt vmcnt(12)
    v_dot2_f32_bf16 v8, v136, s74, v8
    v_dot2_f32_bf16 v9, v136, s75, v9
    v_dot2_f32_bf16 v10, v137, s74, v10
    v_dot2_f32_bf16 v11, v137, s75, v11
    v_dot2_f32_bf16 v12, v138, s74, v12
    v_dot2_f32_bf16 v13, v138, s75, v13
    v_dot2_f32_bf16 v14, v139, s74, v14
    v_dot2_f32_bf16 v15, v139, s75, v15
    v_dot2_f32_bf16 v16, v140, s74, v16
    v_dot2_f32_bf16 v17, v140, s75, v17
    v_dot2_f32_bf16 v18, v141, s74, v18
    v_dot2_f32_bf16 v19, v141, s75, v19
    v_dot2_f32_bf16 v20, v142, s74, v20
    v_dot2_f32_bf16 v21, v142, s75, v21
    v_dot2_f32_bf16 v22, v143, s74, v22
    v_dot2_f32_bf16 v23, v143, s75, v23
    v_dot2_f32_bf16 v24, v144, s74, v24
    v_dot2_f32_bf16 v25, v144, s75, v25
    v_dot2_f32_bf16 v26, v145, s74, v26
    v_dot2_f32_bf16 v27, v145, s75, v27
    v_dot2_f32_bf16 v28, v146, s74, v28
    v_dot2_f32_bf16 v29, v146, s75, v29
    v_dot2_f32_bf16 v30, v147, s74, v30
    v_dot2_f32_bf16 v31, v147, s75, v31
    s_waitcnt vmcnt(9)
    v_dot2_f32_bf16 v8, v148, s74, v8
    v_dot2_f32_bf16 v9, v148, s75, v9
    v_dot2_f32_bf16 v10, v149, s74, v10
    v_dot2_f32_bf16 v11, v149, s75, v11
    v_dot2_f32_bf16 v12, v150, s74, v12
    v_dot2_f32_bf16 v13, v150, s75, v13
    v_dot2_f32_bf16 v14, v151, s74, v14
    v_dot2_f32_bf16 v15, v151, s75, v15
    v_dot2_f32_bf16 v16, v152, s74, v16
    v_dot2_f32_bf16 v17, v152, s75, v17
    v_dot2_f32_bf16 v18, v153, s74, v18
    v_dot2_f32_bf16 v19, v153, s75, v19
    v_dot2_f32_bf16 v20, v154, s74, v20
    v_dot2_f32_bf16 v21, v154, s75, v21
    v_dot2_f32_bf16 v22, v155, s74, v22
    v_dot2_f32_bf16 v23, v155, s75, v23
    v_dot2_f32_bf16 v24, v156, s74, v24
    v_dot2_f32_bf16 v25, v156, s75, v25
    v_dot2_f32_bf16 v26, v157, s74, v26
    v_dot2_f32_bf16 v27, v157, s75, v27
    v_dot2_f32_bf16 v28, v158, s74, v28
    v_dot2_f32_bf16 v29, v158, s75, v29
    v_dot2_f32_bf16 v30, v159, s74, v30
    v_dot2_f32_bf16 v31, v159, s75, v31
    s_waitcnt vmcnt(6)
    v_dot2_f32_bf16 v8, v160, s74, v8
    v_dot2_f32_bf16 v9, v160, s75, v9
    v_dot2_f32_bf16 v10, v161, s74, v10
    v_dot2_f32_bf16 v11, v161, s75, v11
    v_dot2_f32_bf16 v12, v162, s74, v12
    v_dot2_f32_bf16 v13, v162, s75, v13
    v_dot2_f32_bf16 v14, v163, s74, v14
    v_dot2_f32_bf16 v15, v163, s75, v15
    v_dot2_f32_bf16 v16, v164, s74, v16
    v_dot2_f32_bf16 v17, v164, s75, v17
    v_dot2_f32_bf16 v18, v165, s74, v18
    v_dot2_f32_bf16 v19, v165, s75, v19
    v_dot2_f32_bf16 v20, v166, s74, v20
    v_dot2_f32_bf16 v21, v166, s75, v21
    v_dot2_f32_bf16 v22, v167, s74, v22
    v_dot2_f32_bf16 v23, v167, s75, v23
    v_dot2_f32_bf16 v24, v168, s74, v24
    v_dot2_f32_bf16 v25, v168, s75, v25
    v_dot2_f32_bf16 v26, v169, s74, v26
    v_dot2_f32_bf16 v27, v169, s75, v27
    v_dot2_f32_bf16 v28, v170, s74, v28
    v_dot2_f32_bf16 v29, v170, s75, v29
    v_dot2_f32_bf16 v30, v171, s74, v30
    v_dot2_f32_bf16 v31, v171, s75, v31
    s_waitcnt vmcnt(3)
    v_dot2_f32_bf16 v8, v172, s74, v8
    v_dot2_f32_bf16 v9, v172, s75, v9
    v_dot2_f32_bf16 v10, v173, s74, v10
    v_dot2_f32_bf16 v11, v173, s75, v11
    v_dot2_f32_bf16 v12, v174, s74, v12
    v_dot2_f32_bf16 v13, v174, s75, v13
    v_dot2_f32_bf16 v14, v175, s74, v14
    v_dot2_f32_bf16 v15, v175, s75, v15
    v_dot2_f32_bf16 v16, v176, s74, v16
    v_dot2_f32_bf16 v17, v176, s75, v17
    v_dot2_f32_bf16 v18, v177, s74, v18
    v_dot2_f32_bf16 v19, v177, s75, v19
    v_dot2_f32_bf16 v20, v178, s74, v20
    v_dot2_f32_bf16 v21, v178, s75, v21
    v_dot2_f32_bf16 v22, v179, s74, v22
    v_dot2_f32_bf16 v23, v179, s75, v23
    v_dot2_f32_bf16 v24, v180, s74, v24
    v_dot2_f32_bf16 v25, v180, s75, v25
    v_dot2_f32_bf16 v26, v181, s74, v26
    v_dot2_f32_bf16 v27, v181, s75, v27
    v_dot2_f32_bf16 v28, v182, s74, v28
    v_dot2_f32_bf16 v29, v182, s75, v29
    v_dot2_f32_bf16 v30, v183, s74, v30
    v_dot2_f32_bf16 v31, v183, s75, v31
    s_waitcnt vmcnt(0)
    v_dot2_f32_bf16 v8, v184, s74, v8
    v_dot2_f32_bf16 v9, v184, s75, v9
    v_dot2_f32_bf16 v10, v185, s74, v10
    v_dot2_f32_bf16 v11, v185, s75, v11
    v_dot2_f32_bf16 v12, v186, s74, v12
    v_dot2_f32_bf16 v13, v186, s75, v13
    v_dot2_f32_bf16 v14, v187, s74, v14
    v_dot2_f32_bf16 v15, v187, s75, v15
    v_dot2_f32_bf16 v16, v188, s74, v16
    v_dot2_f32_bf16 v17, v188, s75, v17
    v_dot2_f32_bf16 v18, v189, s74, v18
    v_dot2_f32_bf16 v19, v189, s75, v19
    v_dot2_f32_bf16 v20, v190, s74, v20
    v_dot2_f32_bf16 v21, v190, s75, v21
    v_dot2_f32_bf16 v22, v191, s74, v22
    v_dot2_f32_bf16 v23, v191, s75, v23
    v_dot2_f32_bf16 v24, v192, s74, v24
    v_dot2_f32_bf16 v25, v192, s75, v25
    v_dot2_f32_bf16 v26, v193, s74, v26
    v_dot2_f32_bf16 v27, v193, s75, v27
    v_dot2_f32_bf16 v28, v194, s74, v28
    v_dot2_f32_bf16 v29, v194, s75, v29
    v_dot2_f32_bf16 v30, v195, s74, v30
    v_dot2_f32_bf16 v31, v195, s75, v31
    s_barrier
    ds_read_b64_tr_b16 v[100:101], v218 offset:0
    ds_read_b64_tr_b16 v[102:103], v218 offset:256
    ds_read_b64_tr_b16 v[104:105], v218 offset:1024
    ds_read_b64_tr_b16 v[106:107], v218 offset:1280
    ds_read_b64_tr_b16 v[108:109], v218 offset:2048
    ds_read_b64_tr_b16 v[110:111], v218 offset:2304
    s_waitcnt lgkmcnt(4)
    v_dot2_f32_bf16 v8, v100, s74, v8
    v_dot2_f32_bf16 v9, v100, s75, v9
    v_dot2_f32_bf16 v10, v101, s74, v10
    v_dot2_f32_bf16 v11, v101, s75, v11
    v_dot2_f32_bf16 v12, v102, s74, v12
    v_dot2_f32_bf16 v13, v102, s75, v13
    v_dot2_f32_bf16 v14, v103, s74, v14
    v_dot2_f32_bf16 v15, v103, s75, v15
    s_waitcnt lgkmcnt(2)
    v_dot2_f32_bf16 v16, v104, s74, v16
    v_dot2_f32_bf16 v17, v104, s75, v17
    v_dot2_f32_bf16 v18, v105, s74, v18
    v_dot2_f32_bf16 v19, v105, s75, v19
    v_dot2_f32_bf16 v20, v106, s74, v20
    v_dot2_f32_bf16 v21, v106, s75, v21
    v_dot2_f32_bf16 v22, v107, s74, v22
    v_dot2_f32_bf16 v23, v107, s75, v23
    s_waitcnt lgkmcnt(0)
    v_dot2_f32_bf16 v24, v108, s74, v24
    v_dot2_f32_bf16 v25, v108, s75, v25
    v_dot2_f32_bf16 v26, v109, s74, v26
    v_dot2_f32_bf16 v27, v109, s75, v27
    v_dot2_f32_bf16 v28, v110, s74, v28
    v_dot2_f32_bf16 v29, v110, s75, v29
    v_dot2_f32_bf16 v30, v111, s74, v30
    v_dot2_f32_bf16 v31, v111, s75, v31
    v_cvt_pk_bf16_f32 v116, v8, v9
    v_cvt_pk_bf16_f32 v117, v10, v11
    v_cvt_pk_bf16_f32 v118, v12, v13
    v_cvt_pk_bf16_f32 v119, v14, v15
    buffer_store_dwordx4 v[116:119], v216, s[8:11], s65 offen offset:0
    v_cvt_pk_bf16_f32 v120, v16, v17
    v_cvt_pk_bf16_f32 v121, v18, v19
    v_cvt_pk_bf16_f32 v122, v20, v21
    v_cvt_pk_bf16_f32 v123, v22, v23
    buffer_store_dwordx4 v[120:123], v216, s[8:11], s65 offen offset:32
    s_nop 0
    v_cvt_pk_bf16_f32 v124, v24, v25
    v_cvt_pk_bf16_f32 v125, v26, v27
    v_cvt_pk_bf16_f32 v126, v28, v29
    v_cvt_pk_bf16_f32 v127, v30, v31
    buffer_store_dwordx4 v[124:127], v216, s[8:11], s65 offen offset:64
    s_branch parallel_sum__ssm_conv_s4d__dense_activation_silu__prompt_kernel_fin
parallel_sum__ssm_conv_s4d__dense_activation_silu__prompt_kernel_yw:
    s_movk_i32 s76, 71
    s_cmp_eq_u32 s69, 3
    s_cselect_b32 s76, 167, s76
    v_min_u32 v8, s76, v1
    v_add_u32 v9, 64, v1
    v_min_u32 v9, s76, v9
    v_add_u32 v10, 0x80, v1
    v_min_u32 v10, s76, v10
    v_lshlrev_b32 v8, 7, v8
    v_lshlrev_b32 v9, 7, v9
    v_lshlrev_b32 v10, 7, v10
    s_mul_i32 s74, s69, 9216
    s_add_u32 s74, s74, 9863168
    s_mov_b32 s25, 0x40000
    s_waitcnt vmcnt(0)
    s_barrier
parallel_sum__ssm_conv_s4d__dense_activation_silu__prompt_kernel_p3:
    buffer_load_dword v12, v8, s[12:15], s74 offen sc1
    buffer_load_dword v13, v9, s[12:15], s74 offen sc1
    buffer_load_dword v14, v10, s[12:15], s74 offen sc1
    s_sub_u32 s25, s25, 1
    s_cbranch_scc1 parallel_sum__ssm_conv_s4d__dense_activation_silu__prompt_kernel_p3d
    s_waitcnt vmcnt(0)
    v_xor_b32 v12, v12, v69
    v_xor_b32 v13, v13, v69
    v_xor_b32 v14, v14, v69
    v_or3_b32 v12, v12, v13, v14
    v_cmp_ne_u32 vcc, 0, v12
    s_nop 4
    s_cbranch_vccnz parallel_sum__ssm_conv_s4d__dense_activation_silu__prompt_kernel_p3
parallel_sum__ssm_conv_s4d__dense_activation_silu__prompt_kernel_p3d:
    s_mov_b32 m0, 90112
    s_nop 0
    buffer_load_dwordx4 v217, s[12:15], s68 offen sc1 lds
    s_add_u32 s68, s68, 0x10000
    s_mov_b32 m0, 91136
    s_nop 0
    buffer_load_dwordx4 v217, s[12:15], s68 offen sc1 lds
    s_add_u32 s68, s68, 0x10000
    s_mov_b32 m0, 92160
    s_nop 0
    buffer_load_dwordx4 v217, s[12:15], s68 offen sc1 lds
    s_add_u32 s68, s68, 0x10000
    s_mov_b32 m0, 93184
    s_nop 0
    buffer_load_dwordx4 v217, s[12:15], s68 offen sc1 lds
    s_add_u32 s68, s68, 0x10000
    s_mov_b32 m0, 94208
    s_nop 0
    buffer_load_dwordx4 v217, s[12:15], s68 offen sc1 lds
    s_add_u32 s68, s68, 0x10000
    s_mov_b32 m0, 95232
    s_nop 0
    buffer_load_dwordx4 v217, s[12:15], s68 offen sc1 lds
    s_add_u32 s68, s68, 0x10000
    s_mov_b32 m0, 96256
    s_nop 0
    buffer_load_dwordx4 v217, s[12:15], s68 offen sc1 lds
    s_add_u32 s68, s68, 0x10000
    s_mov_b32 m0, 97280
    s_nop 0
    buffer_load_dwordx4 v217, s[12:15], s68 offen sc1 lds
    s_add_u32 s68, s68, 0x10000
    s_mov_b32 m0, 98304
    s_nop 0
    buffer_load_dwordx4 v217, s[12:15], s68 offen sc1 lds
    s_waitcnt vmcnt(0)
    s_barrier
parallel_sum__ssm_conv_s4d__dense_activation_silu__prompt_kernel_fin:
parallel_sum__ssm_conv_s4d__dense_activation_silu__prompt_kernel_end:
    s_endpgm
.p2align 6
parallel_sum__ssm_conv_s4d__dense_activation_silu__prompt_kernel_k2:
    s_waitcnt vmcnt(12)
    s_mov_b32 s74, 0x3fb8aa3b
    s_mov_b32 s75, 0x32a5705f
    s_mov_b32 s76, 0x3f317218
    v_lshlrev_b32 v16, 16, v196
    v_lshlrev_b32 v17, 16, v197
    v_lshlrev_b32 v18, 16, v198
    v_lshlrev_b32 v19, 16, v199
    v_lshlrev_b32 v20, 16, v200
    v_lshlrev_b32 v21, 16, v201
    v_mul_f32 v22, s74, v20
    v_fma_f32 v24, v20, s74, -v22
    v_fma_f32 v24, v20, s75, v24
    v_exp_f32 v22, v22
    v_mul_f32 v24, s76, v24
    v_fma_f32 v22, v22, v24, v22
    v_mul_f32 v23, s74, v16
    v_fma_f32 v25, v16, s74, -v23
    v_fma_f32 v25, v16, s75, v25
    v_exp_f32 v23, v23
    v_mul_f32 v25, s76, v25
    v_fma_f32 v23, v23, v25, v23
    v_cvt_pk_bf16_f32 v22, v22, v22
    v_and_b32 v22, 0xffff0000, v22
    v_cvt_pk_bf16_f32 v23, v23, v23
    v_and_b32 v23, 0xffff0000, v23
    v_mul_f32 v23, v23, v22
    v_mul_f32 v17, v17, v22
    v_mul_f32 v18, v18, v22
    v_mul_f32 v19, v19, v22
    v_mul_f32 v23, 0xbfb8aa3b, v23
    v_mul_f32 v17, 0.15915494, v17
    v_mul_f32 v18, 0x3fb17218, v18
    v_mul_f32 v19, 0x3fb17218, v19
    v_mul_f32 v21, s76, v21
    v_mul_f32 v24, 1.0, v23
    v_mul_f32 v25, 1.0, v17
    v_exp_f32 v24, v24
    v_fract_f32 v25, v25
    v_cos_f32 v28, v25
    v_sin_f32 v29, v25
    s_nop 0
    v_pk_mul_f32 v[28:29], v[28:29], v[24:25] op_sel_hi:[1,0]
    v_mul_f32 v24, 0x41000000, v23
    v_mul_f32 v25, 0x41000000, v17
    v_exp_f32 v24, v24
    v_fract_f32 v25, v25
    v_cos_f32 v30, v25
    v_sin_f32 v31, v25
    s_nop 0
    v_pk_mul_f32 v[30:31], v[30:31], v[24:25] op_sel_hi:[1,0]
    v_mul_f32 v24, 0x43800000, v23
    v_mul_f32 v25, 0x43800000, v17
    v_exp_f32 v24, v24
    v_fract_f32 v25, v25
    v_cos_f32 v32, v25
    v_sin_f32 v33, v25
    s_nop 0
    v_pk_mul_f32 v[32:33], v[32:33], v[24:25] op_sel_hi:[1,0]
    v_pk_mul_f32 v[24:25], v[30:31], v[30:31] op_sel:[1,1] op_sel_hi:[1,0] neg_lo:[1,0]
    v_pk_fma_f32 v[34:35], v[30:31], v[30:31], v[24:25] op_sel_hi:[0,1,1]
    v_mov_b32 v36, 1.0
    v_mov_b32 v37, 0
    v_cvt_pk_bf16_f32 v50, v36, v37
    v_cvt_pk_bf16_f32 v51, v30, v31
    v_cvt_pk_bf16_f32 v52, v34, v35
    v_pk_mul_f32 v[24:25], v[30:31], v[34:35] op_sel:[1,1] op_sel_hi:[1,0] neg_lo:[1,0]
    v_pk_fma_f32 v[40:41], v[30:31], v[34:35], v[24:25] op_sel_hi:[0,1,1]
    v_cvt_pk_bf16_f32 v53, v40, v41
    ds_write2_b32 v56, v50, v51 offset0:128 offset1:132
    ds_write2_b32 v56, v52, v53 offset0:136 offset1:140
    v_pk_mul_f32 v[24:25], v[34:35], v[34:35] op_sel:[1,1] op_sel_hi:[1,0] neg_lo:[1,0]
    v_pk_fma_f32 v[36:37], v[34:35], v[34:35], v[24:25] op_sel_hi:[0,1,1]
    v_cvt_pk_bf16_f32 v50, v36, v37
    v_pk_mul_f32 v[24:25], v[40:41], v[34:35] op_sel:[1,1] op_sel_hi:[1,0] neg_lo:[1,0]
    v_pk_fma_f32 v[40:41], v[40:41], v[34:35], v[24:25] op_sel_hi:[0,1,1]
    v_cvt_pk_bf16_f32 v51, v40, v41
    v_pk_mul_f32 v[24:25], v[36:37], v[34:35] op_sel:[1,1] op_sel_hi:[1,0] neg_lo:[1,0]
    v_pk_fma_f32 v[36:37], v[36:37], v[34:35], v[24:25] op_sel_hi:[0,1,1]
    v_cvt_pk_bf16_f32 v52, v36, v37
    v_pk_mul_f32 v[24:25], v[40:41], v[34:35] op_sel:[1,1] op_sel_hi:[1,0] neg_lo:[1,0]
    v_pk_fma_f32 v[40:41], v[40:41], v[34:35], v[24:25] op_sel_hi:[0,1,1]
    v_cvt_pk_bf16_f32 v53, v40, v41
    ds_write2_b32 v56, v50, v51 offset0:144 offset1:148
    ds_write2_b32 v56, v52, v53 offset0:152 offset1:156
    v_pk_mul_f32 v[24:25], v[36:37], v[34:35] op_sel:[1,1] op_sel_hi:[1,0] neg_lo:[1,0]
    v_pk_fma_f32 v[36:37], v[36:37], v[34:35], v[24:25] op_sel_hi:[0,1,1]
    v_cvt_pk_bf16_f32 v50, v36, v37
    v_pk_mul_f32 v[24:25], v[40:41], v[34:35] op_sel:[1,1] op_sel_hi:[1,0] neg_lo:[1,0]
    v_pk_fma_f32 v[40:41], v[40:41], v[34:35], v[24:25] op_sel_hi:[0,1,1]
    v_cvt_pk_bf16_f32 v51, v40, v41
    v_pk_mul_f32 v[24:25], v[36:37], v[34:35] op_sel:[1,1] op_sel_hi:[1,0] neg_lo:[1,0]
    v_pk_fma_f32 v[36:37], v[36:37], v[34:35], v[24:25] op_sel_hi:[0,1,1]
    v_cvt_pk_bf16_f32 v52, v36, v37
    v_pk_mul_f32 v[24:25], v[40:41], v[34:35] op_sel:[1,1] op_sel_hi:[1,0] neg_lo:[1,0]
    v_pk_fma_f32 v[40:41], v[40:41], v[34:35], v[24:25] op_sel_hi:[0,1,1]
    v_cvt_pk_bf16_f32 v53, v40, v41
    ds_write2_b32 v56, v50, v51 offset0:160 offset1:164
    ds_write2_b32 v56, v52, v53 offset0:168 offset1:172
    v_pk_mul_f32 v[24:25], v[36:37], v[34:35] op_sel:[1,1] op_sel_hi:[1,0] neg_lo:[1,0]
    v_pk_fma_f32 v[36:37], v[36:37], v[34:35], v[24:25] op_sel_hi:[0,1,1]
    v_cvt_pk_bf16_f32 v50, v36, v37
    v_pk_mul_f32 v[24:25], v[40:41], v[34:35] op_sel:[1,1] op_sel_hi:[1,0] neg_lo:[1,0]
    v_pk_fma_f32 v[40:41], v[40:41], v[34:35], v[24:25] op_sel_hi:[0,1,1]
    v_cvt_pk_bf16_f32 v51, v40, v41
    v_pk_mul_f32 v[24:25], v[36:37], v[34:35] op_sel:[1,1] op_sel_hi:[1,0] neg_lo:[1,0]
    v_pk_fma_f32 v[36:37], v[36:37], v[34:35], v[24:25] op_sel_hi:[0,1,1]
    v_cvt_pk_bf16_f32 v52, v36, v37
    v_pk_mul_f32 v[24:25], v[40:41], v[34:35] op_sel:[1,1] op_sel_hi:[1,0] neg_lo:[1,0]
    v_pk_fma_f32 v[40:41], v[40:41], v[34:35], v[24:25] op_sel_hi:[0,1,1]
    v_cvt_pk_bf16_f32 v53, v40, v41
    ds_write2_b32 v56, v50, v51 offset0:176 offset1:180
    ds_write2_b32 v56, v52, v53 offset0:184 offset1:188
    v_pk_mul_f32 v[24:25], v[36:37], v[34:35] op_sel:[1,1] op_sel_hi:[1,0] neg_lo:[1,0]
    v_pk_fma_f32 v[36:37], v[36:37], v[34:35], v[24:25] op_sel_hi:[0,1,1]
    v_cvt_pk_bf16_f32 v50, v36, v37
    v_pk_mul_f32 v[24:25], v[40:41], v[34:35] op_sel:[1,1] op_sel_hi:[1,0] neg_lo:[1,0]
    v_pk_fma_f32 v[40:41], v[40:41], v[34:35], v[24:25] op_sel_hi:[0,1,1]
    v_cvt_pk_bf16_f32 v51, v40, v41
    v_pk_mul_f32 v[24:25], v[36:37], v[34:35] op_sel:[1,1] op_sel_hi:[1,0] neg_lo:[1,0]
    v_pk_fma_f32 v[36:37], v[36:37], v[34:35], v[24:25] op_sel_hi:[0,1,1]
    v_cvt_pk_bf16_f32 v52, v36, v37
    v_pk_mul_f32 v[24:25], v[40:41], v[34:35] op_sel:[1,1] op_sel_hi:[1,0] neg_lo:[1,0]
    v_pk_fma_f32 v[40:41], v[40:41], v[34:35], v[24:25] op_sel_hi:[0,1,1]
    v_cvt_pk_bf16_f32 v53, v40, v41
    ds_write2_b32 v56, v50, v51 offset0:192 offset1:196
    ds_write2_b32 v56, v52, v53 offset0:200 offset1:204
    v_pk_mul_f32 v[24:25], v[36:37], v[34:35] op_sel:[1,1] op_sel_hi:[1,0] neg_lo:[1,0]
    v_pk_fma_f32 v[36:37], v[36:37], v[34:35], v[24:25] op_sel_hi:[0,1,1]
    v_cvt_pk_bf16_f32 v50, v36, v37
    v_pk_mul_f32 v[24:25], v[40:41], v[34:35] op_sel:[1,1] op_sel_hi:[1,0] neg_lo:[1,0]
    v_pk_fma_f32 v[40:41], v[40:41], v[34:35], v[24:25] op_sel_hi:[0,1,1]
    v_cvt_pk_bf16_f32 v51, v40, v41
    v_pk_mul_f32 v[24:25], v[36:37], v[34:35] op_sel:[1,1] op_sel_hi:[1,0] neg_lo:[1,0]
    v_pk_fma_f32 v[36:37], v[36:37], v[34:35], v[24:25] op_sel_hi:[0,1,1]
    v_cvt_pk_bf16_f32 v52, v36, v37
    v_pk_mul_f32 v[24:25], v[40:41], v[34:35] op_sel:[1,1] op_sel_hi:[1,0] neg_lo:[1,0]
    v_pk_fma_f32 v[40:41], v[40:41], v[34:35], v[24:25] op_sel_hi:[0,1,1]
    v_cvt_pk_bf16_f32 v53, v40, v41
    ds_write2_b32 v56, v50, v51 offset0:208 offset1:212
    ds_write2_b32 v56, v52, v53 offset0:216 offset1:220
    v_pk_mul_f32 v[24:25], v[36:37], v[34:35] op_sel:[1,1] op_sel_hi:[1,0] neg_lo:[1,0]
    v_pk_fma_f32 v[36:37], v[36:37], v[34:35], v[24:25] op_sel_hi:[0,1,1]
    v_cvt_pk_bf16_f32 v50, v36, v37
    v_pk_mul_f32 v[24:25], v[40:41], v[34:35] op_sel:[1,1] op_sel_hi:[1,0] neg_lo:[1,0]
    v_pk_fma_f32 v[40:41], v[40:41], v[34:35], v[24:25] op_sel_hi:[0,1,1]
    v_cvt_pk_bf16_f32 v51, v40, v41
    v_pk_mul_f32 v[24:25], v[36:37], v[34:35] op_sel:[1,1] op_sel_hi:[1,0] neg_lo:[1,0]
    v_pk_fma_f32 v[36:37], v[36:37], v[34:35], v[24:25] op_sel_hi:[0,1,1]
    v_cvt_pk_bf16_f32 v52, v36, v37
    v_pk_mul_f32 v[24:25], v[40:41], v[34:35] op_sel:[1,1] op_sel_hi:[1,0] neg_lo:[1,0]
    v_pk_fma_f32 v[40:41], v[40:41], v[34:35], v[24:25] op_sel_hi:[0,1,1]
    v_cvt_pk_bf16_f32 v53, v40, v41
    ds_write2_b32 v56, v50, v51 offset0:224 offset1:228
    ds_write2_b32 v56, v52, v53 offset0:232 offset1:236
    v_pk_mul_f32 v[24:25], v[36:37], v[34:35] op_sel:[1,1] op_sel_hi:[1,0] neg_lo:[1,0]
    v_pk_fma_f32 v[36:37], v[36:37], v[34:35], v[24:25] op_sel_hi:[0,1,1]
    v_cvt_pk_bf16_f32 v50, v36, v37
    v_pk_mul_f32 v[24:25], v[40:41], v[34:35] op_sel:[1,1] op_sel_hi:[1,0] neg_lo:[1,0]
    v_pk_fma_f32 v[40:41], v[40:41], v[34:35], v[24:25] op_sel_hi:[0,1,1]
    v_cvt_pk_bf16_f32 v51, v40, v41
    v_pk_mul_f32 v[24:25], v[36:37], v[34:35] op_sel:[1,1] op_sel_hi:[1,0] neg_lo:[1,0]
    v_pk_fma_f32 v[36:37], v[36:37], v[34:35], v[24:25] op_sel_hi:[0,1,1]
    v_cvt_pk_bf16_f32 v52, v36, v37
    v_pk_mul_f32 v[24:25], v[40:41], v[34:35] op_sel:[1,1] op_sel_hi:[1,0] neg_lo:[1,0]
    v_pk_fma_f32 v[40:41], v[40:41], v[34:35], v[24:25] op_sel_hi:[0,1,1]
    v_cvt_pk_bf16_f32 v53, v40, v41
    ds_write2_b32 v56, v50, v51 offset0:240 offset1:244
    s_waitcnt lgkmcnt(9)
    ds_write2_b32 v56, v52, v53 offset0:248 offset1:252
    v_cvt_pk_bf16_f32 v50, v18, -v19
    v_pk_mul_f32 v[24:25], v[18:19], v[28:29] op_sel:[1,1] op_sel_hi:[1,0] neg_lo:[1,0]
    v_pk_fma_f32 v[36:37], v[18:19], v[28:29], v[24:25] op_sel_hi:[0,1,1]
    v_cvt_pk_bf16_f32 v51, v36, -v37
    v_pk_mul_f32 v[24:25], v[36:37], v[28:29] op_sel:[1,1] op_sel_hi:[1,0] neg_lo:[1,0]
    v_pk_fma_f32 v[44:45], v[36:37], v[28:29], v[24:25] op_sel_hi:[0,1,1]
    v_cvt_pk_bf16_f32 v52, v44, -v45
    v_pk_mul_f32 v[24:25], v[44:45], v[28:29] op_sel:[1,1] op_sel_hi:[1,0] neg_lo:[1,0]
    v_pk_fma_f32 v[36:37], v[44:45], v[28:29], v[24:25] op_sel_hi:[0,1,1]
    v_cvt_pk_bf16_f32 v53, v36, -v37
    ds_write2_b32 v56, v50, v51 offset0:0 offset1:4
    ds_write2_b32 v56, v52, v53 offset0:8 offset1:12
    v_pk_mul_f32 v[24:25], v[36:37], v[28:29] op_sel:[1,1] op_sel_hi:[1,0] neg_lo:[1,0]
    v_pk_fma_f32 v[46:47], v[36:37], v[28:29], v[24:25] op_sel_hi:[0,1,1]
    v_cvt_pk_bf16_f32 v50, v46, -v47
    v_pk_mul_f32 v[24:25], v[46:47], v[28:29] op_sel:[1,1] op_sel_hi:[1,0] neg_lo:[1,0]
    v_pk_fma_f32 v[36:37], v[46:47], v[28:29], v[24:25] op_sel_hi:[0,1,1]
    v_cvt_pk_bf16_f32 v51, v36, -v37
    v_pk_mul_f32 v[24:25], v[36:37], v[28:29] op_sel:[1,1] op_sel_hi:[1,0] neg_lo:[1,0]
    v_pk_fma_f32 v[48:49], v[36:37], v[28:29], v[24:25] op_sel_hi:[0,1,1]
    v_cvt_pk_bf16_f32 v52, v48, -v49
    v_pk_mul_f32 v[24:25], v[48:49], v[28:29] op_sel:[1,1] op_sel_hi:[1,0] neg_lo:[1,0]
    v_pk_fma_f32 v[36:37], v[48:49], v[28:29], v[24:25] op_sel_hi:[0,1,1]
    v_cvt_pk_bf16_f32 v53, v36, -v37
    ds_write2_b32 v56, v50, v51 offset0:16 offset1:20
    ds_write2_b32 v56, v52, v53 offset0:24 offset1:28
    v_pk_mul_f32 v[24:25], v[18:19], v[32:33] op_sel:[1,1] op_sel_hi:[1,0] neg_lo:[1,0]
    v_pk_fma_f32 v[36:37], v[18:19], v[32:33], v[24:25] op_sel_hi:[0,1,1]
    v_cvt_pk_bf16_f32 v50, v36, -v37
    v_pk_mul_f32 v[24:25], v[44:45], v[32:33] op_sel:[1,1] op_sel_hi:[1,0] neg_lo:[1,0]
    v_pk_fma_f32 v[40:41], v[44:45], v[32:33], v[24:25] op_sel_hi:[0,1,1]
    v_cvt_pk_bf16_f32 v51, v40, -v41
    v_pk_mul_f32 v[24:25], v[36:37], v[32:33] op_sel:[1,1] op_sel_hi:[1,0] neg_lo:[1,0]
    v_pk_fma_f32 v[36:37], v[36:37], v[32:33], v[24:25] op_sel_hi:[0,1,1]
    v_cvt_pk_bf16_f32 v52, v36, -v37
    v_pk_mul_f32 v[24:25], v[46:47], v[32:33] op_sel:[1,1] op_sel_hi:[1,0] neg_lo:[1,0]
    v_pk_fma_f32 v[42:43], v[46:47], v[32:33], v[24:25] op_sel_hi:[0,1,1]
    v_cvt_pk_bf16_f32 v53, v42, -v43
    ds_write2_b32 v56, v50, v51 offset0:32 offset1:36
    s_waitcnt lgkmcnt(9)
    ds_write2_b32 v56, v52, v53 offset0:48 offset1:40
    v_pk_mul_f32 v[24:25], v[36:37], v[32:33] op_sel:[1,1] op_sel_hi:[1,0] neg_lo:[1,0]
    v_pk_fma_f32 v[36:37], v[36:37], v[32:33], v[24:25] op_sel_hi:[0,1,1]
    v_cvt_pk_bf16_f32 v50, v36, -v37
    v_pk_mul_f32 v[24:25], v[48:49], v[32:33] op_sel:[1,1] op_sel_hi:[1,0] neg_lo:[1,0]
    v_pk_fma_f32 v[40:41], v[48:49], v[32:33], v[24:25] op_sel_hi:[0,1,1]
    v_cvt_pk_bf16_f32 v51, v40, -v41
    v_pk_mul_f32 v[24:25], v[36:37], v[32:33] op_sel:[1,1] op_sel_hi:[1,0] neg_lo:[1,0]
    v_pk_fma_f32 v[36:37], v[36:37], v[32:33], v[24:25] op_sel_hi:[0,1,1]
    v_cvt_pk_bf16_f32 v52, v36, -v37
    v_pk_mul_f32 v[24:25], v[42:43], v[32:33] op_sel:[1,1] op_sel_hi:[1,0] neg_lo:[1,0]
    v_pk_fma_f32 v[42:43], v[42:43], v[32:33], v[24:25] op_sel_hi:[0,1,1]
    v_cvt_pk_bf16_f32 v53, v42, -v43
    ds_write2_b32 v56, v50, v51 offset0:56 offset1:44
    ds_write2_b32 v56, v52, v53 offset0:64 offset1:52
    v_pk_mul_f32 v[24:25], v[36:37], v[32:33] op_sel:[1,1] op_sel_hi:[1,0] neg_lo:[1,0]
    v_pk_fma_f32 v[36:37], v[36:37], v[32:33], v[24:25] op_sel_hi:[0,1,1]
    v_cvt_pk_bf16_f32 v50, v36, -v37
    v_pk_mul_f32 v[24:25], v[42:43], v[32:33] op_sel:[1,1] op_sel_hi:[1,0] neg_lo:[1,0]
    v_pk_fma_f32 v[42:43], v[42:43], v[32:33], v[24:25] op_sel_hi:[0,1,1]
    v_cvt_pk_bf16_f32 v51, v42, -v43
    v_pk_mul_f32 v[24:25], v[36:37], v[32:33] op_sel:[1,1] op_sel_hi:[1,0] neg_lo:[1,0]
    v_pk_fma_f32 v[36:37], v[36:37], v[32:33], v[24:25] op_sel_hi:[0,1,1]
    v_cvt_pk_bf16_f32 v52, v36, -v37
    v_pk_mul_f32 v[24:25], v[36:37], v[32:33] op_sel:[1,1] op_sel_hi:[1,0] neg_lo:[1,0]
    v_pk_fma_f32 v[36:37], v[36:37], v[32:33], v[24:25] op_sel_hi:[0,1,1]
    v_cvt_pk_bf16_f32 v53, v36, -v37
    ds_write2_b32 v56, v50, v51 offset0:68 offset1:60
    ds_write2_b32 v56, v52, v53 offset0:72 offset1:76
    v_pk_mul_f32 v[24:25], v[36:37], v[32:33] op_sel:[1,1] op_sel_hi:[1,0] neg_lo:[1,0]
    v_pk_fma_f32 v[36:37], v[36:37], v[32:33], v[24:25] op_sel_hi:[0,1,1]
    v_cvt_pk_bf16_f32 v50, v36, -v37
    ds_write_b32 v56, v50 offset:320
    s_waitcnt lgkmcnt(0)
    s_barrier
    ds_read_b128 a[0:3], v57 offset:0
    ds_read_b128 a[4:7], v57 offset:256
    ds_read_b128 a[8:11], v58 offset:0
    ds_read_b128 a[12:15], v57 offset:4160
    ds_read_b128 a[16:19], v57 offset:4416
    ds_read_b128 a[20:23], v58 offset:4160
    ds_read_b128 a[24:27], v57 offset:8320
    ds_read_b128 a[28:31], v57 offset:8576
    ds_read_b128 a[32:35], v58 offset:8320
    ds_read_b128 a[36:39], v57 offset:12480
    ds_read_b128 a[40:43], v57 offset:12736
    ds_read_b128 a[44:47], v58 offset:12480
    s_waitcnt lgkmcnt(9)
    v_mfma_f32_16x16x32_bf16 v[28:31], a[0:3], a[8:11], 0
    v_mfma_f32_16x16x32_bf16 v[32:35], a[4:7], a[8:11], 0
    ds_read_b128 a[48:51], v57 offset:16640
    ds_read_b128 a[52:55], v57 offset:16896
    ds_read_b128 a[56:59], v58 offset:16640
    s_waitcnt lgkmcnt(9)
    v_mfma_f32_16x16x32_bf16 v[28:31], a[12:15], a[20:23], v[28:31]
    v_mfma_f32_16x16x32_bf16 v[32:35], a[16:19], a[20:23], v[32:35]
    ds_read_b128 a[60:63], v57 offset:20800
    ds_read_b128 a[64:67], v57 offset:21056
    ds_read_b128 a[68:71], v58 offset:20800
    s_waitcnt lgkmcnt(9)
    v_mfma_f32_16x16x32_bf16 v[28:31], a[24:27], a[32:35], v[28:31]
    v_mfma_f32_16x16x32_bf16 v[32:35], a[28:31], a[32:35], v[32:35]
    ds_read_b128 a[72:75], v57 offset:24960
    ds_read_b128 a[76:79], v57 offset:25216
    ds_read_b128 a[80:83], v58 offset:24960
    s_waitcnt lgkmcnt(9)
    v_mfma_f32_16x16x32_bf16 v[28:31], a[36:39], a[44:47], v[28:31]
    v_mfma_f32_16x16x32_bf16 v[32:35], a[40:43], a[44:47], v[32:35]
    ds_read_b128 a[84:87], v57 offset:29120
    ds_read_b128 a[88:91], v57 offset:29376
    ds_read_b128 a[92:95], v58 offset:29120
    s_waitcnt lgkmcnt(9)
    v_mfma_f32_16x16x32_bf16 v[28:31], a[48:51], a[56:59], v[28:31]
    v_mfma_f32_16x16x32_bf16 v[32:35], a[52:55], a[56:59], v[32:35]
    s_waitcnt lgkmcnt(6)
    v_mfma_f32_16x16x32_bf16 v[28:31], a[60:63], a[68:71], v[28:31]
    v_mfma_f32_16x16x32_bf16 v[32:35], a[64:67], a[68:71], v[32:35]
    s_waitcnt lgkmcnt(3)
    v_mfma_f32_16x16x32_bf16 v[28:31], a[72:75], a[80:83], v[28:31]
    v_mfma_f32_16x16x32_bf16 v[32:35], a[76:79], a[80:83], v[32:35]
    s_waitcnt lgkmcnt(0)
    v_mfma_f32_16x16x32_bf16 v[28:31], a[84:87], a[92:95], v[28:31]
    v_mfma_f32_16x16x32_bf16 v[32:35], a[88:91], a[92:95], v[32:35]
    s_add_u32 s77, s67, s25
    s_and_b32 s31, s3, 1
    s_lshl_b32 s31, s31, 10
    s_add_u32 s31, s31, s77
    v_and_b32 v21, v21, v63
    s_mov_b32 s74, 0x01000100
    s_mov_b32 s75, 0x03020302
    s_nop 0
    v_add_f32 v28, v28, v21
    v_cvt_pk_bf16_f32 v28, v28, v29
    v_cvt_pk_bf16_f32 v29, v30, v31
    v_cvt_pk_bf16_f32 v32, v32, v33
    v_cvt_pk_bf16_f32 v33, v34, v35
    ds_write_b32 v59, v28
    ds_write_b32 v60, v29
    ds_write_b16 v61, v32
    ds_write_b16_d16_hi v61, v32 offset:64
    ds_write_b16 v61, v33 offset:128
    ds_write_b16_d16_hi v61, v33 offset:192
    s_waitcnt lgkmcnt(0)
    s_barrier
    ds_read2_b32 v[28:29], v62 offset0:0 offset1:1
    ds_read2_b32 v[32:33], v64 offset0:0 offset1:1
    ds_read2_b32 v[34:35], v64 offset0:2 offset1:3
    v_add_u32 v30, -4, v64
    ds_read_b32 v30, v30
    s_waitcnt lgkmcnt(0)
    s_bitcmp1_b32 s3, 0
    s_cbranch_scc1 parallel_sum__ssm_conv_s4d__dense_activation_silu__prompt_kernel_r2_segc
    v_mov_b32 v52, 0
    v_mov_b32 v53, 0
    v_mov_b32 v54, 0
    v_mov_b32 v55, 0
    v_cmp_gt_u32 vcc, 32, v1
    s_mov_b64 exec, 1
    buffer_store_dwordx4 v[52:55], v99, s[12:15], s77 offen offset:48 sc1
    s_add_u32 s77, s77, 4160
    buffer_store_dwordx4 v[52:55], v99, s[12:15], s77 offen offset:48 sc1
    s_mov_b64 exec, -1
    v_perm_b32 v36, v32, v32, s74
    v_alignbit_b32 v37, v33, v32, 16
    v_perm_b32 v38, v33, v33, s74
    v_alignbit_b32 v39, v34, v33, 16
    v_cndmask_b32 v36, v36, v32, vcc
    v_cndmask_b32 v37, v37, v33, vcc
    v_cndmask_b32 v38, v38, v34, vcc
    v_cndmask_b32 v39, v39, v35, vcc
    v_cmp_lt_u32 vcc, 32, v1
    v_bfi_b32 v30, v63, 0, v30
    s_nop 0
    v_cndmask_b32 v30, v30, v36, vcc
    v_alignbit_b32 v44, v36, v30, 16
    s_branch parallel_sum__ssm_conv_s4d__dense_activation_silu__prompt_kernel_r2_segd
parallel_sum__ssm_conv_s4d__dense_activation_silu__prompt_kernel_r2_segc:
    v_perm_b32 v36, v32, v32, s74
    v_mov_b32 v37, v32
    v_perm_b32 v38, v32, v32, s75
    v_perm_b32 v39, v33, v33, s74
    v_mov_b32 v44, v36
parallel_sum__ssm_conv_s4d__dense_activation_silu__prompt_kernel_r2_segd:
    buffer_store_dwordx4 v[36:39], v99, s[12:15], s31 offen offset:64 sc1
    s_add_u32 s77, s31, 4160
    v_alignbit_b32 v45, v37, v36, 16
    v_alignbit_b32 v46, v38, v37, 16
    v_alignbit_b32 v47, v39, v38, 16
    v_perm_b32 v40, v29, v28, v65
    v_perm_b32 v42, v29, v28, v66
    v_perm_b32 v43, v29, v28, v67
    buffer_store_dwordx4 v[44:47], v99, s[12:15], s77 offen offset:64 sc1
    v_mov_b32 v41, v40
    v_mov_b32 v48, v40
    v_mov_b32 v49, v40
    v_alignbit_b32 v50, v42, v40, 16
    v_alignbit_b32 v51, v43, v42, 16
    buffer_store_dwordx4 v[40:43], v99, s[12:15], s31 offen offset:2112 sc1
    buffer_store_dwordx4 v[48:51], v99, s[12:15], s77 offen offset:2112 sc1
    s_branch parallel_sum__ssm_conv_s4d__dense_activation_silu__prompt_kernel_k2done
code_end:
.fill 64, 4, 0xbf800000
.section .rodata,"a"
.p2align 6
.amdhsa_kernel parallel_sum__ssm_conv_s4d__dense_activation_silu__prompt_kernel
  .amdhsa_next_free_vgpr 512
  .amdhsa_next_free_sgpr 102
  .amdhsa_accum_offset 256
  .amdhsa_group_segment_fixed_size 0
  .amdhsa_kernarg_size 104
  .amdhsa_user_sgpr_count 2
  .amdhsa_user_sgpr_kernarg_segment_ptr 1
  .amdhsa_system_sgpr_workgroup_id_x 1
  .amdhsa_float_denorm_mode_32 3
.end_amdhsa_kernel
```
